```python
import torch

def _softmax(x, axis=-1):
    return torch.softmax(x, dim=axis)
def _gelu(x):
    return torch.nn.functional.gelu(x, approximate="tanh")
def _silu(x):
    return torch.nn.functional.silu(x)
def _sigmoid(x):
    return torch.sigmoid(x)
def _layernorm(x, axis=-1, eps=1e-5):
    m = x.mean(dim=axis, keepdim=True)
    v = x.var(dim=axis, keepdim=True, unbiased=False)
    return (x - m) / torch.sqrt(v + eps)
def _scatter_add(tgt, idx, src, axis=0):
    return tgt.clone().index_add_(axis, idx, src)
def _segment_sum(src, seg, n):
    out = torch.zeros((n,) + src.shape[1:], dtype=src.dtype)
    return out.index_add_(0, seg, src)
def _pad(x, pw):
    flat = tuple(v for pair in reversed(pw) for v in pair)
    return torch.nn.functional.pad(x, flat)

kernel_name = 'concat_heads__gqa_block_cached__mha_block_cached__near_ridge'

def setup_inputs():

    _w = (lambda a: (lambda t: t.to(torch.bfloat16) if t.is_floating_point() else t)(torch.as_tensor(a)))
    def _A_setup():
        B, Sq, D = 8, 48, 512
        Hq, Hkv, Sk, Dh = 32, 8, 2048, 128
        assert Hq % Hkv == 0, (Hq, Hkv)
        return {
            "x": _w((lambda *s: torch.randn(*s, dtype=torch.bfloat16) * 0.8)(B, Sq, D)),
            "k_cache": _w((lambda *s: torch.randn(*s, dtype=torch.bfloat16) * 0.8)(B, Hkv, Sk, Dh)),
            "v_cache": _w((lambda *s: torch.randn(*s, dtype=torch.bfloat16) * 0.05)(B, Hkv, Sk, Dh)),
            "wq": _w((lambda *s: torch.randn(*s, dtype=torch.bfloat16) * 0.8)(D, Hq * Dh) * (D ** -0.5)),
            "wo": _w((lambda *s: torch.randn(*s, dtype=torch.bfloat16) * 0.05)(Hq * Dh, D) * ((Hq * Dh) ** -0.5)),
        }
    _A_in = _A_setup()

    def _B_setup():
        B, Sq, D = 8, 48, 512
        H, Sk, Dh = 32, 2048, 128
        return {
            "x": _w((lambda *s: torch.randn(*s, dtype=torch.bfloat16) * 0.8)(B, Sq, D)),
            "k_cache": _w((lambda *s: torch.randn(*s, dtype=torch.bfloat16) * 0.8)(B, H, Sk, Dh)),
            "v_cache": _w((lambda *s: torch.randn(*s, dtype=torch.bfloat16) * 0.05)(B, H, Sk, Dh)),
            "wq": _w((lambda *s: torch.randn(*s, dtype=torch.bfloat16) * 0.8)(D, H * Dh) * (D ** -0.5)),
            "wo": _w((lambda *s: torch.randn(*s, dtype=torch.bfloat16) * 0.05)(H * Dh, D) * ((H * Dh) ** -0.5)),
        }
    _B_in = _B_setup()

    return {
        "A_x": _A_in["x"],
        "A_k_cache": _A_in["k_cache"],
        "A_v_cache": _A_in["v_cache"],
        "A_wq": _A_in["wq"],
        "A_wo": _A_in["wo"],
        "B_x": _B_in["x"],
        "B_k_cache": _B_in["k_cache"],
        "B_v_cache": _B_in["v_cache"],
        "B_wq": _B_in["wq"],
        "B_wo": _B_in["wo"],
    }

def reference(A_x, A_k_cache, A_v_cache, A_wq, A_wo, B_x, B_k_cache, B_v_cache, B_wq, B_wo):
    def _A_ref(x, k_cache, v_cache, wq, wo):
        B, Sq, D = x.shape
        Hq, Dh = 32, 128
        Hkv = k_cache.shape[1]
        rep = Hq // Hkv
        q = (lambda x, *d: x.permute(*d))((x @ wq).reshape(B, Sq, Hq, Dh), 0, 2, 1, 3)
        k = (lambda x, n, axis: torch.repeat_interleave(x, n, dim=axis))(k_cache, rep, axis=1)
        v = (lambda x, n, axis: torch.repeat_interleave(x, n, dim=axis))(v_cache, rep, axis=1)
        scores = torch.einsum("bhqd,bhkd->bhqk", q, k) * (Dh ** -0.5)
        p = _softmax(scores, axis=-1)
        o = torch.einsum("bhqk,bhkd->bhqd", p, v)
        return (lambda x, *d: x.permute(*d))(o, 0, 2, 1, 3).reshape(B, Sq, Hq * Dh) @ wo

    def _B_ref(x, k_cache, v_cache, wq, wo):
        B, Sq, D = x.shape
        H, Dh = 32, 128
        q = (lambda x, *d: x.permute(*d))((x @ wq).reshape(B, Sq, H, Dh), 0, 2, 1, 3)
        scores = torch.einsum("bhqd,bhkd->bhqk", q, k_cache) * (Dh ** -0.5)
        p = _softmax(scores, axis=-1)
        o = torch.einsum("bhqk,bhkd->bhqd", p, v_cache)
        return (lambda x, *d: x.permute(*d))(o, 0, 2, 1, 3).reshape(B, Sq, H * Dh) @ wo

    a = _A_ref(A_x, A_k_cache, A_v_cache, A_wq, A_wo)
    b = _B_ref(B_x, B_k_cache, B_v_cache, B_wq, B_wo)
    return torch.concatenate([a, b], axis=-1)
```

```asm
; @launch grid=(256,1,1) block=(256,1,1) lds=163840
.amdgcn_target "amdgcn-amd-amdhsa--gfx950"
.text
.globl concat_heads__gqa_block_cached__mha_block_cached__near_ridge_kernel
.p2align 8
.type concat_heads__gqa_block_cached__mha_block_cached__near_ridge_kernel,@function
concat_heads__gqa_block_cached__mha_block_cached__near_ridge_kernel:
s_cmp_ge_u32 s2, 256
s_cbranch_scc1 L_end
s_load_dwordx16 s[12:27], s[0:1], 0
s_load_dwordx4 s[84:87], s[0:1], 64
s_load_dwordx4 s[88:91], s[0:1], 88
v_lshrrev_b32 v1, 6, v0
v_and_b32 v0, 63, v0
v_readfirstlane_b32 s76, v1
v_and_b32 v2, 15, v0
v_lshrrev_b32 v3, 4, v0
v_lshlrev_b32 v220, 4, v0
s_lshl_b32 s77, s76, 15
v_lshlrev_b32 v4, 1, v3
v_xor_b32 v4, v2, v4
v_lshlrev_b32 v4, 4, v4
v_lshl_add_u32 v28, v3, 8, v4
v_xor_b32 v29, 0x80, v28
v_lshl_add_u32 v216, v3, 13, v4
v_xor_b32 v217, 0x80, v216
v_lshl_add_u32 v218, v3, 10, v4
v_xor_b32 v219, 0x80, v218
v_and_b32 v5, 7, v2
v_lshlrev_b32 v5, 1, v5
v_xor_b32 v6, v3, v5
v_lshlrev_b32 v6, 4, v6
v_lshl_add_u32 v6, v2, 8, v6
v_add_u32 v24, s77, v6
v_xor_b32 v25, 64, v24
v_xor_b32 v26, 128, v24
v_xor_b32 v27, 192, v24
v_lshrrev_b32 v6, 1, v3
v_xor_b32 v6, v6, v5
v_lshlrev_b32 v6, 4, v6
v_and_b32 v7, 1, v3
v_lshl_add_u32 v6, v7, 3, v6
v_lshl_add_u32 v6, v2, 8, v6
v_add_u32 v221, s77, v6
v_lshrrev_b32 v6, 2, v2
v_lshl_add_u32 v6, v3, 2, v6
v_and_b32 v7, 7, v6
v_lshlrev_b32 v7, 1, v7
v_bfe_u32 v8, v2, 1, 1
v_xor_b32 v7, v8, v7
v_lshlrev_b32 v7, 4, v7
v_and_b32 v8, 1, v2
v_lshl_add_u32 v7, v8, 3, v7
v_lshl_add_u32 v7, v6, 8, v7
v_add_u32 v7, s77, v7
s_lshl_b32 s79, s76, 1
s_add_u32 s80, s79, 0
s_and_b32 s80, s80, 7
s_lshl_b32 s80, s80, 5
v_xor_b32 v16, s80, v7
s_add_u32 s80, s79, 1
s_and_b32 s80, s80, 7
s_lshl_b32 s80, s80, 5
v_xor_b32 v17, s80, v7
s_add_u32 s80, s79, 2
s_and_b32 s80, s80, 7
s_lshl_b32 s80, s80, 5
v_xor_b32 v18, s80, v7
s_add_u32 s80, s79, 3
s_and_b32 s80, s80, 7
s_lshl_b32 s80, s80, 5
v_xor_b32 v19, s80, v7
s_add_u32 s80, s79, 4
s_and_b32 s80, s80, 7
s_lshl_b32 s80, s80, 5
v_xor_b32 v20, s80, v7
s_add_u32 s80, s79, 5
s_and_b32 s80, s80, 7
s_lshl_b32 s80, s80, 5
v_xor_b32 v21, s80, v7
s_add_u32 s80, s79, 6
s_and_b32 s80, s80, 7
s_lshl_b32 s80, s80, 5
v_xor_b32 v22, s80, v7
s_add_u32 s80, s79, 7
s_and_b32 s80, s80, 7
s_lshl_b32 s80, s80, 5
v_xor_b32 v23, s80, v7
s_mul_i32 s79, s76, 12288
v_add_u32 v222, s79, v220
s_lshl_b32 s99, s76, 13
s_and_b32 s79, s2, 7
s_lshr_b32 s80, s2, 3
s_and_b32 s94, s80, 15
s_lshl_b32 s95, s79, 4
s_add_u32 s95, s95, s94
s_lshr_b32 s92, s94, 1
s_and_b32 s93, s94, 1
s_lshl_b32 s96, s79, 1
s_add_u32 s93, s93, s96
s_cmp_lt_u32 s80, 16
s_cselect_b32 s10, 1, 0
s_mov_b32 s11, s10
s_cbranch_scc0 L_idB
s_lshr_b32 s81, s80, 1
s_and_b32 s3, s80, 1
s_lshl_b32 s83, s79, 2
s_lshl_b32 s97, s3, 1
s_add_u32 s83, s83, s97
s_lshl_b32 s96, s81, 3
s_add_u32 s79, s96, s79
s_branch L_iddone
L_idB:
s_mov_b32 s81, s92
s_mov_b32 s83, s93
s_mov_b32 s3, 0
s_lshl_b32 s79, s81, 5
s_add_u32 s79, s79, s83
L_iddone:
s_and_b32 s2, s81, 3
s_waitcnt lgkmcnt(0)
s_cmp_eq_u32 s10, 1
s_cselect_b32 s40, s12, s22
s_cselect_b32 s41, s13, s23
s_cselect_b32 s28, s14, s24
s_cselect_b32 s29, s15, s25
s_cselect_b32 s32, s16, s26
s_cselect_b32 s33, s17, s27
s_cselect_b32 s36, s18, s84
s_cselect_b32 s37, s19, s85
s_cselect_b32 s44, s20, s86
s_cselect_b32 s45, s21, s87
s_mov_b32 s80, 0x800000
s_cselect_b32 s80, 0, s80
s_lshl_b32 s96, s79, 19
s_lshr_b32 s97, s79, 13
s_add_u32 s28, s28, s96
s_addc_u32 s29, s29, s97
s_mov_b32 s30, 0x80000
s_mov_b32 s31, 0x20000
s_add_u32 s32, s32, s96
s_addc_u32 s33, s33, s97
s_mov_b32 s34, 0x80000
s_mov_b32 s35, 0x20000
s_mul_i32 s96, s81, 49152
s_add_u32 s40, s40, s96
s_addc_u32 s41, s41, 0
s_mov_b32 s42, 49152
s_mov_b32 s43, 0x20000
s_lshl_b32 s96, s83, 8
s_add_u32 s36, s36, s96
s_addc_u32 s37, s37, 0
s_sub_u32 s38, 0x400000, s96
s_mov_b32 s39, 0x20000
s_lshl_b32 s96, s83, 17
s_add_u32 s44, s44, s96
s_addc_u32 s45, s45, 0
s_mov_b32 s46, 0x20000
s_mov_b32 s47, 0x20000
s_add_u32 s56, s32, s80
s_addc_u32 s57, s33, 0
s_mov_b32 s58, 0x80000
s_mov_b32 s59, 0x20000
s_cmp_eq_u32 s10, 1
s_mov_b32 s96, 0x200000
s_cselect_b32 s96, 0x20000, s96
s_add_u32 s68, s44, s96
s_addc_u32 s69, s45, 0
s_mov_b32 s70, 0x20000
s_mov_b32 s71, 0x20000
s_mov_b32 s48, s80
s_mul_i32 s96, s92, 49152
s_add_u32 s52, s22, s96
s_addc_u32 s53, s23, 0
s_mov_b32 s54, 49152
s_mov_b32 s55, 0x20000
s_add_u32 s96, s93, 16
s_lshl_b32 s96, s96, 8
s_add_u32 s60, s84, s96
s_addc_u32 s61, s85, 0
s_sub_u32 s62, 0x400000, s96
s_mov_b32 s63, 0x20000
s_and_b32 s49, s92, 3
s_mul_i32 s96, s95, 12288
s_add_u32 s96, s96, 0x2100000
s_add_u32 s64, s90, s96
s_addc_u32 s65, s91, 0
s_mov_b32 s66, 12288
s_mov_b32 s67, 0x20000
s_lshl_b32 s96, s95, 7
s_add_u32 s8, s96, 4096
s_lshr_b32 s97, s83, 1
s_cmp_eq_u32 s10, 1
s_cselect_b32 s94, 0, 8
s_cselect_b32 s83, s97, s83
s_add_u32 s94, s94, s81
s_lshl_b32 s93, s94, 4
s_add_u32 s93, s93, s83
s_mul_i32 s96, s93, 49152
s_add_u32 s72, s90, s96
s_addc_u32 s73, s91, 0
s_mov_b32 s74, 49152
s_mov_b32 s75, 0x20000
s_lshl_b32 s94, s94, 7
s_lshl_b32 s96, s83, 2
s_add_u32 s9, s94, s96
s_add_u32 s4, s90, 0x2000000
s_addc_u32 s5, s91, 0
s_mov_b32 s6, 36864
s_mov_b32 s7, 0x20000
s_lshl_b32 s92, s76, 20
s_lshl_b32 s93, s76, 8
s_mov_b32 s80, s88
s_mov_b32 s81, s89
s_mov_b32 s82, 256
s_mov_b32 s83, 0x20000
s_mov_b32 s50, s88
s_mov_b32 s51, s89
s_mov_b32 s89, 0x3e0293ee
s_cmp_lg_u32 s76, 0
s_cbranch_scc1 L_noclear
s_mov_b64 exec, 1
v_mov_b32 v1, 0
buffer_store_dword v1, v1, s[4:7], s9 offen sc1
s_cmp_eq_u32 s10, 0
s_cbranch_scc1 L_noclear2
buffer_store_dword v1, v1, s[4:7], s8 offen sc1
v_mov_b32 v2, 16384
buffer_store_dword v1, v2, s[4:7], s8 offen sc1
L_noclear2:
s_mov_b64 exec, -1
L_noclear:
s_cmp_eq_u32 s10, 0
s_cbranch_scc1 L_progB
s_add_u32 m0, s77, 0
s_add_u32 s94, s93, 0
buffer_load_dwordx4 v218, s[52:55], s94 offen offset:0 lds
s_add_u32 s94, s93, 3072
buffer_load_dwordx4 v219, s[52:55], s94 offen offset:1024 lds
s_add_u32 s94, s93, 6144
buffer_load_dwordx4 v218, s[52:55], s94 offen offset:2048 lds
s_add_u32 s94, s93, 9216
buffer_load_dwordx4 v219, s[52:55], s94 offen offset:3072 lds
s_add_u32 m0, s77, 4096
s_add_u32 s94, s93, 16384
buffer_load_dwordx4 v218, s[52:55], s94 offen offset:0 lds
s_add_u32 s94, s93, 19456
buffer_load_dwordx4 v219, s[52:55], s94 offen offset:1024 lds
s_add_u32 s94, s93, 22528
buffer_load_dwordx4 v218, s[52:55], s94 offen offset:2048 lds
s_add_u32 s94, s93, 25600
buffer_load_dwordx4 v219, s[52:55], s94 offen offset:3072 lds
s_add_u32 m0, s77, 8192
s_add_u32 s94, s93, 32768
buffer_load_dwordx4 v218, s[52:55], s94 offen offset:0 lds
s_add_u32 s94, s93, 35840
buffer_load_dwordx4 v219, s[52:55], s94 offen offset:1024 lds
s_add_u32 s94, s93, 38912
buffer_load_dwordx4 v218, s[52:55], s94 offen offset:2048 lds
s_add_u32 s94, s93, 41984
buffer_load_dwordx4 v219, s[52:55], s94 offen offset:3072 lds
s_add_u32 s85, s49, 0
s_and_b32 s85, s85, 3
s_lshl_b32 s85, s85, 18
s_add_u32 s85, s85, s92
s_add_u32 m0, s77, 16384
s_add_u32 s94, s85, 0
buffer_load_dwordx4 v216, s[60:63], s94 offen offset:0 lds
s_add_u32 s94, s85, 31744
buffer_load_dwordx4 v217, s[60:63], s94 offen offset:1024 lds
s_add_u32 s94, s85, 63488
buffer_load_dwordx4 v216, s[60:63], s94 offen offset:2048 lds
s_add_u32 s94, s85, 95232
buffer_load_dwordx4 v217, s[60:63], s94 offen offset:3072 lds
s_add_u32 m0, s77, 20480
s_add_u32 s94, s85, 131072
buffer_load_dwordx4 v216, s[60:63], s94 offen offset:0 lds
s_add_u32 s94, s85, 162816
buffer_load_dwordx4 v217, s[60:63], s94 offen offset:1024 lds
s_add_u32 s94, s85, 194560
buffer_load_dwordx4 v216, s[60:63], s94 offen offset:2048 lds
s_add_u32 s94, s85, 226304
buffer_load_dwordx4 v217, s[60:63], s94 offen offset:3072 lds
s_add_u32 s85, s49, 1
s_and_b32 s85, s85, 3
s_lshl_b32 s85, s85, 18
s_add_u32 s85, s85, s92
s_add_u32 m0, s77, 24576
s_add_u32 s94, s85, 0
buffer_load_dwordx4 v216, s[60:63], s94 offen offset:0 lds
s_add_u32 s94, s85, 31744
buffer_load_dwordx4 v217, s[60:63], s94 offen offset:1024 lds
s_add_u32 s94, s85, 63488
buffer_load_dwordx4 v216, s[60:63], s94 offen offset:2048 lds
s_add_u32 s94, s85, 95232
buffer_load_dwordx4 v217, s[60:63], s94 offen offset:3072 lds
s_add_u32 m0, s77, 28672
s_add_u32 s94, s85, 131072
buffer_load_dwordx4 v216, s[60:63], s94 offen offset:0 lds
s_add_u32 s94, s85, 162816
buffer_load_dwordx4 v217, s[60:63], s94 offen offset:1024 lds
s_add_u32 s94, s85, 194560
buffer_load_dwordx4 v216, s[60:63], s94 offen offset:2048 lds
s_add_u32 s94, s85, 226304
buffer_load_dwordx4 v217, s[60:63], s94 offen offset:3072 lds
s_load_dwordx4 s[12:15], s[0:1], 48
s_sub_u32 s16, s8, 4096
s_lshr_b32 s16, s16, 7
s_lshr_b32 s17, s16, 4
s_and_b32 s16, s16, 15
s_lshr_b32 s18, s16, 1
s_and_b32 s16, s16, 1
s_lshl_b32 s17, s17, 1
s_add_u32 s16, s16, s17
s_lshl_b32 s18, s18, 5
s_add_u32 s16, s16, s18
s_waitcnt lgkmcnt(0)
s_add_u32 s17, s16, 0
s_lshl_b32 s18, s17, 19
s_lshr_b32 s19, s17, 13
s_add_u32 s20, s12, s18
s_addc_u32 s21, s13, s19
s_mov_b32 s22, 0x80000
s_mov_b32 s23, 0x20000
s_add_u32 s24, s14, s18
s_addc_u32 s25, s15, s19
s_mov_b32 s26, 0x80000
s_mov_b32 s27, 0x20000
s_add_u32 s17, s99, 0
s_mov_b32 s18, 6
L_pfa0:
s_add_u32 s19, s17, 4096
buffer_load_dwordx4 v[4:7], v220, s[20:23], s17 offen offset:0
buffer_load_dwordx4 v[4:7], v220, s[20:23], s17 offen offset:1024
buffer_load_dwordx4 v[4:7], v220, s[20:23], s17 offen offset:2048
buffer_load_dwordx4 v[4:7], v220, s[20:23], s17 offen offset:3072
buffer_load_dwordx4 v[4:7], v220, s[20:23], s19 offen offset:0
buffer_load_dwordx4 v[4:7], v220, s[20:23], s19 offen offset:1024
buffer_load_dwordx4 v[4:7], v220, s[20:23], s19 offen offset:2048
buffer_load_dwordx4 v[4:7], v220, s[20:23], s19 offen offset:3072
buffer_load_dwordx4 v[4:7], v220, s[24:27], s17 offen offset:0
buffer_load_dwordx4 v[4:7], v220, s[24:27], s17 offen offset:1024
buffer_load_dwordx4 v[4:7], v220, s[24:27], s17 offen offset:2048
buffer_load_dwordx4 v[4:7], v220, s[24:27], s17 offen offset:3072
buffer_load_dwordx4 v[4:7], v220, s[24:27], s19 offen offset:0
buffer_load_dwordx4 v[4:7], v220, s[24:27], s19 offen offset:1024
buffer_load_dwordx4 v[4:7], v220, s[24:27], s19 offen offset:2048
buffer_load_dwordx4 v[4:7], v220, s[24:27], s19 offen offset:3072
s_waitcnt vmcnt(16)
s_add_u32 s17, s17, 32768
s_sub_u32 s18, s18, 1
s_cmp_lg_u32 s18, 0
s_cbranch_scc1 L_pfa0
s_load_dwordx4 s[12:15], s[0:1], 48
s_sub_u32 s16, s8, 4096
s_lshr_b32 s16, s16, 7
s_lshr_b32 s17, s16, 4
s_and_b32 s16, s16, 15
s_lshr_b32 s18, s16, 1
s_and_b32 s16, s16, 1
s_lshl_b32 s17, s17, 1
s_add_u32 s16, s16, s17
s_lshl_b32 s18, s18, 5
s_add_u32 s16, s16, s18
s_add_u32 s16, s16, 16
s_lshl_b32 s18, s16, 19
s_lshr_b32 s19, s16, 13
s_waitcnt lgkmcnt(0)
s_add_u32 s52, s12, s18
s_addc_u32 s53, s13, s19
s_mov_b32 s54, 0x80000
s_mov_b32 s55, 0x20000
s_add_u32 s56, s14, s18
s_addc_u32 s57, s15, s19
s_mov_b32 s58, 0x80000
s_mov_b32 s59, 0x20000
s_add_u32 s79, s49, 0
s_and_b32 s79, s79, 3
s_lshl_b32 s79, s79, 6
v_xor_b32 v36, s79, v221
v_xor_b32 v37, 32, v36
s_add_u32 s79, s49, 1
s_and_b32 s79, s79, 3
s_lshl_b32 s79, s79, 6
v_xor_b32 v38, s79, v221
v_xor_b32 v39, 32, v38
s_add_u32 s79, s49, 2
s_and_b32 s79, s79, 3
s_lshl_b32 s79, s79, 6
v_xor_b32 v40, s79, v221
v_xor_b32 v41, 32, v40
s_add_u32 s79, s49, 3
s_and_b32 s79, s79, 3
s_lshl_b32 s79, s79, 6
v_xor_b32 v42, s79, v221
v_xor_b32 v43, 32, v42
s_waitcnt vmcnt(16)
s_cmp_lg_u32 s76, 0
s_cbranch_scc1 L_nocountA
s_mov_b64 exec, 1
v_mov_b32 v1, 0
v_mov_b32 v2, 1
buffer_atomic_add v2, v1, s[80:83], 0 offen sc1
s_mov_b64 exec, -1
L_nocountA:
ds_read_b64 a[48:49], v36 offset:0
ds_read_b64 a[50:51], v37 offset:0
ds_read_b64 a[52:53], v38 offset:0
ds_read_b64 a[54:55], v39 offset:0
ds_read_b64 a[56:57], v40 offset:0
ds_read_b64 a[58:59], v41 offset:0
ds_read_b64 a[60:61], v42 offset:0
ds_read_b64 a[62:63], v43 offset:0
ds_read_b64 a[64:65], v36 offset:4096
ds_read_b64 a[66:67], v37 offset:4096
ds_read_b64 a[68:69], v38 offset:4096
ds_read_b64 a[70:71], v39 offset:4096
ds_read_b64 a[72:73], v40 offset:4096
ds_read_b64 a[74:75], v41 offset:4096
ds_read_b64 a[76:77], v42 offset:4096
ds_read_b64 a[78:79], v43 offset:4096
ds_read_b64 a[80:81], v36 offset:8192
ds_read_b64 a[82:83], v37 offset:8192
ds_read_b64 a[84:85], v38 offset:8192
ds_read_b64 a[86:87], v39 offset:8192
ds_read_b64 a[88:89], v40 offset:8192
ds_read_b64 a[90:91], v41 offset:8192
ds_read_b64 a[92:93], v42 offset:8192
ds_read_b64 a[94:95], v43 offset:8192
s_waitcnt lgkmcnt(0)
s_add_u32 s85, s49, 2
s_and_b32 s85, s85, 3
s_lshl_b32 s85, s85, 18
s_add_u32 s85, s85, s92
s_add_u32 m0, s77, 0
s_add_u32 s94, s85, 0
buffer_load_dwordx4 v216, s[60:63], s94 offen offset:0 lds
s_add_u32 s94, s85, 31744
buffer_load_dwordx4 v217, s[60:63], s94 offen offset:1024 lds
s_add_u32 s94, s85, 63488
buffer_load_dwordx4 v216, s[60:63], s94 offen offset:2048 lds
s_add_u32 s94, s85, 95232
buffer_load_dwordx4 v217, s[60:63], s94 offen offset:3072 lds
s_add_u32 m0, s77, 4096
s_add_u32 s94, s85, 131072
buffer_load_dwordx4 v216, s[60:63], s94 offen offset:0 lds
s_add_u32 s94, s85, 162816
buffer_load_dwordx4 v217, s[60:63], s94 offen offset:1024 lds
s_add_u32 s94, s85, 194560
buffer_load_dwordx4 v216, s[60:63], s94 offen offset:2048 lds
s_add_u32 s94, s85, 226304
buffer_load_dwordx4 v217, s[60:63], s94 offen offset:3072 lds
s_add_u32 s85, s49, 3
s_and_b32 s85, s85, 3
s_lshl_b32 s85, s85, 18
s_add_u32 s85, s85, s92
s_add_u32 m0, s77, 8192
s_add_u32 s94, s85, 0
buffer_load_dwordx4 v216, s[60:63], s94 offen offset:0 lds
s_add_u32 s94, s85, 31744
buffer_load_dwordx4 v217, s[60:63], s94 offen offset:1024 lds
s_add_u32 s94, s85, 63488
buffer_load_dwordx4 v216, s[60:63], s94 offen offset:2048 lds
s_add_u32 s94, s85, 95232
buffer_load_dwordx4 v217, s[60:63], s94 offen offset:3072 lds
s_add_u32 m0, s77, 12288
s_add_u32 s94, s85, 131072
buffer_load_dwordx4 v216, s[60:63], s94 offen offset:0 lds
s_add_u32 s94, s85, 162816
buffer_load_dwordx4 v217, s[60:63], s94 offen offset:1024 lds
s_add_u32 s94, s85, 194560
buffer_load_dwordx4 v216, s[60:63], s94 offen offset:2048 lds
s_add_u32 s94, s85, 226304
buffer_load_dwordx4 v217, s[60:63], s94 offen offset:3072 lds
s_waitcnt vmcnt(24)
ds_read_b64_tr_b16 a[128:129], v16 offset:16384
ds_read_b64_tr_b16 a[130:131], v16 offset:20480
ds_read_b64_tr_b16 a[132:133], v17 offset:16384
ds_read_b64_tr_b16 a[134:135], v17 offset:20480
ds_read_b64_tr_b16 a[136:137], v18 offset:16384
ds_read_b64_tr_b16 a[138:139], v18 offset:20480
ds_read_b64_tr_b16 a[140:141], v19 offset:16384
ds_read_b64_tr_b16 a[142:143], v19 offset:20480
ds_read_b64_tr_b16 a[144:145], v20 offset:16384
ds_read_b64_tr_b16 a[146:147], v20 offset:20480
ds_read_b64_tr_b16 a[148:149], v21 offset:16384
ds_read_b64_tr_b16 a[150:151], v21 offset:20480
ds_read_b64_tr_b16 a[152:153], v22 offset:16384
ds_read_b64_tr_b16 a[154:155], v22 offset:20480
ds_read_b64_tr_b16 a[156:157], v23 offset:16384
ds_read_b64_tr_b16 a[158:159], v23 offset:20480
s_waitcnt lgkmcnt(0)
v_mfma_f32_16x16x32_bf16 v[120:123], a[128:131], a[48:51], 0
v_mfma_f32_16x16x32_bf16 v[124:127], a[128:131], a[64:67], 0
v_mfma_f32_16x16x32_bf16 v[128:131], a[128:131], a[80:83], 0
s_add_u32 s85, s2, 0
s_and_b32 s85, s85, 3
s_lshl_b32 s85, s85, 18
s_add_u32 s85, s85, s92
s_add_u32 m0, s77, 16384
s_add_u32 s94, s85, 0
buffer_load_dwordx4 v216, s[36:39], s94 offen offset:0 lds
v_mfma_f32_16x16x32_bf16 v[132:135], a[132:135], a[48:51], 0
v_mfma_f32_16x16x32_bf16 v[136:139], a[132:135], a[64:67], 0
v_mfma_f32_16x16x32_bf16 v[140:143], a[132:135], a[80:83], 0
s_add_u32 s94, s85, 31744
buffer_load_dwordx4 v217, s[36:39], s94 offen offset:1024 lds
v_mfma_f32_16x16x32_bf16 v[144:147], a[136:139], a[48:51], 0
v_mfma_f32_16x16x32_bf16 v[148:151], a[136:139], a[64:67], 0
v_mfma_f32_16x16x32_bf16 v[152:155], a[136:139], a[80:83], 0
s_add_u32 s94, s85, 63488
buffer_load_dwordx4 v216, s[36:39], s94 offen offset:2048 lds
s_waitcnt vmcnt(19)
ds_read_b64_tr_b16 a[96:97], v16 offset:24576
ds_read_b64_tr_b16 a[98:99], v16 offset:28672
ds_read_b64_tr_b16 a[100:101], v17 offset:24576
ds_read_b64_tr_b16 a[102:103], v17 offset:28672
ds_read_b64_tr_b16 a[104:105], v18 offset:24576
ds_read_b64_tr_b16 a[106:107], v18 offset:28672
ds_read_b64_tr_b16 a[108:109], v19 offset:24576
ds_read_b64_tr_b16 a[110:111], v19 offset:28672
ds_read_b64_tr_b16 a[112:113], v20 offset:24576
ds_read_b64_tr_b16 a[114:115], v20 offset:28672
ds_read_b64_tr_b16 a[116:117], v21 offset:24576
ds_read_b64_tr_b16 a[118:119], v21 offset:28672
ds_read_b64_tr_b16 a[120:121], v22 offset:24576
ds_read_b64_tr_b16 a[122:123], v22 offset:28672
ds_read_b64_tr_b16 a[124:125], v23 offset:24576
ds_read_b64_tr_b16 a[126:127], v23 offset:28672
v_mfma_f32_16x16x32_bf16 v[156:159], a[140:143], a[48:51], 0
v_mfma_f32_16x16x32_bf16 v[160:163], a[140:143], a[64:67], 0
v_mfma_f32_16x16x32_bf16 v[164:167], a[140:143], a[80:83], 0
s_add_u32 s94, s85, 95232
buffer_load_dwordx4 v217, s[36:39], s94 offen offset:3072 lds
v_mfma_f32_16x16x32_bf16 v[168:171], a[144:147], a[48:51], 0
v_mfma_f32_16x16x32_bf16 v[172:175], a[144:147], a[64:67], 0
v_mfma_f32_16x16x32_bf16 v[176:179], a[144:147], a[80:83], 0
s_add_u32 m0, s77, 20480
s_add_u32 s94, s85, 131072
buffer_load_dwordx4 v216, s[36:39], s94 offen offset:0 lds
v_mfma_f32_16x16x32_bf16 v[180:183], a[148:151], a[48:51], 0
v_mfma_f32_16x16x32_bf16 v[184:187], a[148:151], a[64:67], 0
v_mfma_f32_16x16x32_bf16 v[188:191], a[148:151], a[80:83], 0
s_add_u32 s94, s85, 162816
buffer_load_dwordx4 v217, s[36:39], s94 offen offset:1024 lds
v_mfma_f32_16x16x32_bf16 v[192:195], a[152:155], a[48:51], 0
v_mfma_f32_16x16x32_bf16 v[196:199], a[152:155], a[64:67], 0
v_mfma_f32_16x16x32_bf16 v[200:203], a[152:155], a[80:83], 0
s_add_u32 s94, s85, 194560
buffer_load_dwordx4 v216, s[36:39], s94 offen offset:2048 lds
v_mfma_f32_16x16x32_bf16 v[204:207], a[156:159], a[48:51], 0
v_mfma_f32_16x16x32_bf16 v[208:211], a[156:159], a[64:67], 0
v_mfma_f32_16x16x32_bf16 v[212:215], a[156:159], a[80:83], 0
s_add_u32 s94, s85, 226304
buffer_load_dwordx4 v217, s[36:39], s94 offen offset:3072 lds
s_waitcnt lgkmcnt(0)
v_mfma_f32_16x16x32_bf16 v[120:123], a[96:99], a[52:55], v[120:123]
v_mfma_f32_16x16x32_bf16 v[124:127], a[96:99], a[68:71], v[124:127]
v_mfma_f32_16x16x32_bf16 v[128:131], a[96:99], a[84:87], v[128:131]
s_add_u32 s85, s2, 1
s_and_b32 s85, s85, 3
s_lshl_b32 s85, s85, 18
s_add_u32 s85, s85, s92
s_add_u32 m0, s77, 24576
s_add_u32 s94, s85, 0
buffer_load_dwordx4 v216, s[36:39], s94 offen offset:0 lds
v_mfma_f32_16x16x32_bf16 v[132:135], a[100:103], a[52:55], v[132:135]
v_mfma_f32_16x16x32_bf16 v[136:139], a[100:103], a[68:71], v[136:139]
v_mfma_f32_16x16x32_bf16 v[140:143], a[100:103], a[84:87], v[140:143]
s_add_u32 s94, s85, 31744
buffer_load_dwordx4 v217, s[36:39], s94 offen offset:1024 lds
v_mfma_f32_16x16x32_bf16 v[144:147], a[104:107], a[52:55], v[144:147]
v_mfma_f32_16x16x32_bf16 v[148:151], a[104:107], a[68:71], v[148:151]
v_mfma_f32_16x16x32_bf16 v[152:155], a[104:107], a[84:87], v[152:155]
s_add_u32 s94, s85, 63488
buffer_load_dwordx4 v216, s[36:39], s94 offen offset:2048 lds
s_waitcnt vmcnt(19)
ds_read_b64_tr_b16 a[128:129], v16 offset:0
ds_read_b64_tr_b16 a[130:131], v16 offset:4096
ds_read_b64_tr_b16 a[132:133], v17 offset:0
ds_read_b64_tr_b16 a[134:135], v17 offset:4096
ds_read_b64_tr_b16 a[136:137], v18 offset:0
ds_read_b64_tr_b16 a[138:139], v18 offset:4096
ds_read_b64_tr_b16 a[140:141], v19 offset:0
ds_read_b64_tr_b16 a[142:143], v19 offset:4096
ds_read_b64_tr_b16 a[144:145], v20 offset:0
ds_read_b64_tr_b16 a[146:147], v20 offset:4096
ds_read_b64_tr_b16 a[148:149], v21 offset:0
ds_read_b64_tr_b16 a[150:151], v21 offset:4096
ds_read_b64_tr_b16 a[152:153], v22 offset:0
ds_read_b64_tr_b16 a[154:155], v22 offset:4096
ds_read_b64_tr_b16 a[156:157], v23 offset:0
ds_read_b64_tr_b16 a[158:159], v23 offset:4096
v_mfma_f32_16x16x32_bf16 v[156:159], a[108:111], a[52:55], v[156:159]
v_mfma_f32_16x16x32_bf16 v[160:163], a[108:111], a[68:71], v[160:163]
v_mfma_f32_16x16x32_bf16 v[164:167], a[108:111], a[84:87], v[164:167]
s_add_u32 s94, s85, 95232
buffer_load_dwordx4 v217, s[36:39], s94 offen offset:3072 lds
v_mfma_f32_16x16x32_bf16 v[168:171], a[112:115], a[52:55], v[168:171]
v_mfma_f32_16x16x32_bf16 v[172:175], a[112:115], a[68:71], v[172:175]
v_mfma_f32_16x16x32_bf16 v[176:179], a[112:115], a[84:87], v[176:179]
s_add_u32 m0, s77, 28672
s_add_u32 s94, s85, 131072
buffer_load_dwordx4 v216, s[36:39], s94 offen offset:0 lds
v_mfma_f32_16x16x32_bf16 v[180:183], a[116:119], a[52:55], v[180:183]
v_mfma_f32_16x16x32_bf16 v[184:187], a[116:119], a[68:71], v[184:187]
v_mfma_f32_16x16x32_bf16 v[188:191], a[116:119], a[84:87], v[188:191]
s_add_u32 s94, s85, 162816
buffer_load_dwordx4 v217, s[36:39], s94 offen offset:1024 lds
v_mfma_f32_16x16x32_bf16 v[192:195], a[120:123], a[52:55], v[192:195]
v_mfma_f32_16x16x32_bf16 v[196:199], a[120:123], a[68:71], v[196:199]
v_mfma_f32_16x16x32_bf16 v[200:203], a[120:123], a[84:87], v[200:203]
s_add_u32 s94, s85, 194560
buffer_load_dwordx4 v216, s[36:39], s94 offen offset:2048 lds
v_mfma_f32_16x16x32_bf16 v[204:207], a[124:127], a[52:55], v[204:207]
v_mfma_f32_16x16x32_bf16 v[208:211], a[124:127], a[68:71], v[208:211]
v_mfma_f32_16x16x32_bf16 v[212:215], a[124:127], a[84:87], v[212:215]
s_add_u32 s94, s85, 226304
buffer_load_dwordx4 v217, s[36:39], s94 offen offset:3072 lds
s_waitcnt lgkmcnt(0)
v_mfma_f32_16x16x32_bf16 v[120:123], a[128:131], a[56:59], v[120:123]
v_mfma_f32_16x16x32_bf16 v[124:127], a[128:131], a[72:75], v[124:127]
v_mfma_f32_16x16x32_bf16 v[128:131], a[128:131], a[88:91], v[128:131]
v_mfma_f32_16x16x32_bf16 v[132:135], a[132:135], a[56:59], v[132:135]
v_mfma_f32_16x16x32_bf16 v[136:139], a[132:135], a[72:75], v[136:139]
v_mfma_f32_16x16x32_bf16 v[140:143], a[132:135], a[88:91], v[140:143]
v_mfma_f32_16x16x32_bf16 v[144:147], a[136:139], a[56:59], v[144:147]
v_mfma_f32_16x16x32_bf16 v[148:151], a[136:139], a[72:75], v[148:151]
v_mfma_f32_16x16x32_bf16 v[152:155], a[136:139], a[88:91], v[152:155]
s_waitcnt vmcnt(16)
ds_read_b64_tr_b16 a[96:97], v16 offset:8192
ds_read_b64_tr_b16 a[98:99], v16 offset:12288
ds_read_b64_tr_b16 a[100:101], v17 offset:8192
ds_read_b64_tr_b16 a[102:103], v17 offset:12288
ds_read_b64_tr_b16 a[104:105], v18 offset:8192
ds_read_b64_tr_b16 a[106:107], v18 offset:12288
ds_read_b64_tr_b16 a[108:109], v19 offset:8192
ds_read_b64_tr_b16 a[110:111], v19 offset:12288
ds_read_b64_tr_b16 a[112:113], v20 offset:8192
ds_read_b64_tr_b16 a[114:115], v20 offset:12288
ds_read_b64_tr_b16 a[116:117], v21 offset:8192
ds_read_b64_tr_b16 a[118:119], v21 offset:12288
ds_read_b64_tr_b16 a[120:121], v22 offset:8192
ds_read_b64_tr_b16 a[122:123], v22 offset:12288
ds_read_b64_tr_b16 a[124:125], v23 offset:8192
ds_read_b64_tr_b16 a[126:127], v23 offset:12288
v_mfma_f32_16x16x32_bf16 v[156:159], a[140:143], a[56:59], v[156:159]
v_mfma_f32_16x16x32_bf16 v[160:163], a[140:143], a[72:75], v[160:163]
v_mfma_f32_16x16x32_bf16 v[164:167], a[140:143], a[88:91], v[164:167]
v_mfma_f32_16x16x32_bf16 v[168:171], a[144:147], a[56:59], v[168:171]
v_mfma_f32_16x16x32_bf16 v[172:175], a[144:147], a[72:75], v[172:175]
v_mfma_f32_16x16x32_bf16 v[176:179], a[144:147], a[88:91], v[176:179]
v_mfma_f32_16x16x32_bf16 v[180:183], a[148:151], a[56:59], v[180:183]
v_mfma_f32_16x16x32_bf16 v[184:187], a[148:151], a[72:75], v[184:187]
v_mfma_f32_16x16x32_bf16 v[188:191], a[148:151], a[88:91], v[188:191]
v_mfma_f32_16x16x32_bf16 v[192:195], a[152:155], a[56:59], v[192:195]
v_mfma_f32_16x16x32_bf16 v[196:199], a[152:155], a[72:75], v[196:199]
v_mfma_f32_16x16x32_bf16 v[200:203], a[152:155], a[88:91], v[200:203]
v_mfma_f32_16x16x32_bf16 v[204:207], a[156:159], a[56:59], v[204:207]
v_mfma_f32_16x16x32_bf16 v[208:211], a[156:159], a[72:75], v[208:211]
v_mfma_f32_16x16x32_bf16 v[212:215], a[156:159], a[88:91], v[212:215]
s_waitcnt lgkmcnt(0)
v_mfma_f32_16x16x32_bf16 v[120:123], a[96:99], a[60:63], v[120:123]
v_mfma_f32_16x16x32_bf16 v[124:127], a[96:99], a[76:79], v[124:127]
v_mfma_f32_16x16x32_bf16 v[128:131], a[96:99], a[92:95], v[128:131]
v_mfma_f32_16x16x32_bf16 v[132:135], a[100:103], a[60:63], v[132:135]
v_mfma_f32_16x16x32_bf16 v[136:139], a[100:103], a[76:79], v[136:139]
v_mfma_f32_16x16x32_bf16 v[140:143], a[100:103], a[92:95], v[140:143]
v_mfma_f32_16x16x32_bf16 v[144:147], a[104:107], a[60:63], v[144:147]
v_mfma_f32_16x16x32_bf16 v[148:151], a[104:107], a[76:79], v[148:151]
v_mfma_f32_16x16x32_bf16 v[152:155], a[104:107], a[92:95], v[152:155]
v_mfma_f32_16x16x32_bf16 v[156:159], a[108:111], a[60:63], v[156:159]
v_mfma_f32_16x16x32_bf16 v[160:163], a[108:111], a[76:79], v[160:163]
v_mfma_f32_16x16x32_bf16 v[164:167], a[108:111], a[92:95], v[164:167]
v_mfma_f32_16x16x32_bf16 v[168:171], a[112:115], a[60:63], v[168:171]
v_mfma_f32_16x16x32_bf16 v[172:175], a[112:115], a[76:79], v[172:175]
v_mfma_f32_16x16x32_bf16 v[176:179], a[112:115], a[92:95], v[176:179]
v_mfma_f32_16x16x32_bf16 v[180:183], a[116:119], a[60:63], v[180:183]
v_mfma_f32_16x16x32_bf16 v[184:187], a[116:119], a[76:79], v[184:187]
v_mfma_f32_16x16x32_bf16 v[188:191], a[116:119], a[92:95], v[188:191]
v_mfma_f32_16x16x32_bf16 v[192:195], a[120:123], a[60:63], v[192:195]
v_mfma_f32_16x16x32_bf16 v[196:199], a[120:123], a[76:79], v[196:199]
v_mfma_f32_16x16x32_bf16 v[200:203], a[120:123], a[92:95], v[200:203]
v_mfma_f32_16x16x32_bf16 v[204:207], a[124:127], a[60:63], v[204:207]
v_mfma_f32_16x16x32_bf16 v[208:211], a[124:127], a[76:79], v[208:211]
v_mfma_f32_16x16x32_bf16 v[212:215], a[124:127], a[92:95], v[212:215]
s_nop 7
s_barrier
s_add_u32 s79, s76, 1
s_and_b32 s79, s79, 3
s_lshl_b32 s79, s79, 15
v_add_u32 v42, s79, v220
s_add_u32 s79, s76, 2
s_and_b32 s79, s79, 3
s_lshl_b32 s79, s79, 15
v_add_u32 v43, s79, v220
s_add_u32 s79, s76, 3
s_and_b32 s79, s79, 3
s_lshl_b32 s79, s79, 13
s_add_u32 s79, s79, 131072
v_add_u32 v44, s79, v220
ds_write_b128 v42, v[144:147] offset:0
ds_write_b128 v42, v[148:151] offset:1024
ds_write_b128 v42, v[152:155] offset:2048
ds_write_b128 v42, v[156:159] offset:3072
ds_write_b128 v42, v[160:163] offset:4096
ds_write_b128 v42, v[164:167] offset:5120
ds_write_b128 v43, v[168:171] offset:8192
ds_write_b128 v43, v[172:175] offset:9216
ds_write_b128 v43, v[176:179] offset:10240
ds_write_b128 v43, v[180:183] offset:11264
ds_write_b128 v43, v[184:187] offset:12288
ds_write_b128 v43, v[188:191] offset:13312
ds_write_b128 v44, v[192:195] offset:0
ds_write_b128 v44, v[196:199] offset:1024
ds_write_b128 v44, v[200:203] offset:2048
ds_write_b128 v44, v[204:207] offset:3072
ds_write_b128 v44, v[208:211] offset:4096
ds_write_b128 v44, v[212:215] offset:5120
v_add_u32 v38, s77, v220
s_lshl_b32 s79, s76, 13
s_add_u32 s79, s79, 131072
v_add_u32 v39, s79, v220
s_waitcnt lgkmcnt(0)
s_barrier
ds_read_b128 v[48:51], v38 offset:0
ds_read_b128 v[52:55], v38 offset:1024
ds_read_b128 v[56:59], v38 offset:2048
ds_read_b128 v[60:63], v38 offset:3072
ds_read_b128 v[64:67], v38 offset:4096
ds_read_b128 v[68:71], v38 offset:5120
ds_read_b128 v[72:75], v38 offset:8192
ds_read_b128 v[76:79], v38 offset:9216
ds_read_b128 v[80:83], v38 offset:10240
ds_read_b128 v[84:87], v38 offset:11264
ds_read_b128 v[88:91], v38 offset:12288
ds_read_b128 v[92:95], v38 offset:13312
ds_read_b128 v[96:99], v39 offset:0
ds_read_b128 v[100:103], v39 offset:1024
ds_read_b128 v[104:107], v39 offset:2048
ds_read_b128 v[108:111], v39 offset:3072
ds_read_b128 v[112:115], v39 offset:4096
ds_read_b128 v[116:119], v39 offset:5120
v_lshrrev_b32 v40, 5, v0
v_lshlrev_b32 v40, 8, v40
v_and_b32 v41, 15, v0
v_lshl_add_u32 v40, v41, 4, v40
v_bfe_u32 v41, v0, 4, 1
v_lshl_add_u32 v40, v41, 3, v40
v_add_u32 v40, s79, v40
s_waitcnt lgkmcnt(12)
v_add_f32 v120, v120, v48
v_add_f32 v121, v121, v49
v_add_f32 v122, v122, v50
v_add_f32 v123, v123, v51
v_add_f32 v124, v124, v52
v_add_f32 v125, v125, v53
v_add_f32 v126, v126, v54
v_add_f32 v127, v127, v55
v_add_f32 v128, v128, v56
v_add_f32 v129, v129, v57
v_add_f32 v130, v130, v58
v_add_f32 v131, v131, v59
v_add_f32 v132, v132, v60
v_add_f32 v133, v133, v61
v_add_f32 v134, v134, v62
v_add_f32 v135, v135, v63
v_add_f32 v136, v136, v64
v_add_f32 v137, v137, v65
v_add_f32 v138, v138, v66
v_add_f32 v139, v139, v67
v_add_f32 v140, v140, v68
v_add_f32 v141, v141, v69
v_add_f32 v142, v142, v70
v_add_f32 v143, v143, v71
s_waitcnt lgkmcnt(6)
v_add_f32 v120, v120, v72
v_add_f32 v121, v121, v73
v_add_f32 v122, v122, v74
v_add_f32 v123, v123, v75
v_add_f32 v124, v124, v76
v_add_f32 v125, v125, v77
v_add_f32 v126, v126, v78
v_add_f32 v127, v127, v79
v_add_f32 v128, v128, v80
v_add_f32 v129, v129, v81
v_add_f32 v130, v130, v82
v_add_f32 v131, v131, v83
v_add_f32 v132, v132, v84
v_add_f32 v133, v133, v85
v_add_f32 v134, v134, v86
v_add_f32 v135, v135, v87
v_add_f32 v136, v136, v88
v_add_f32 v137, v137, v89
v_add_f32 v138, v138, v90
v_add_f32 v139, v139, v91
v_add_f32 v140, v140, v92
v_add_f32 v141, v141, v93
v_add_f32 v142, v142, v94
v_add_f32 v143, v143, v95
s_waitcnt lgkmcnt(0)
v_add_f32 v120, v120, v96
v_add_f32 v121, v121, v97
v_add_f32 v122, v122, v98
v_add_f32 v123, v123, v99
v_add_f32 v124, v124, v100
v_add_f32 v125, v125, v101
v_add_f32 v126, v126, v102
v_add_f32 v127, v127, v103
v_add_f32 v128, v128, v104
v_add_f32 v129, v129, v105
v_add_f32 v130, v130, v106
v_add_f32 v131, v131, v107
v_add_f32 v132, v132, v108
v_add_f32 v133, v133, v109
v_add_f32 v134, v134, v110
v_add_f32 v135, v135, v111
v_add_f32 v136, v136, v112
v_add_f32 v137, v137, v113
v_add_f32 v138, v138, v114
v_add_f32 v139, v139, v115
v_add_f32 v140, v140, v116
v_add_f32 v141, v141, v117
v_add_f32 v142, v142, v118
v_add_f32 v143, v143, v119
v_cvt_pk_bf16_f32 v48, v120, v121
v_cvt_pk_bf16_f32 v49, v122, v123
v_cvt_pk_bf16_f32 v50, v124, v125
v_cvt_pk_bf16_f32 v51, v126, v127
v_cvt_pk_bf16_f32 v52, v128, v129
v_cvt_pk_bf16_f32 v53, v130, v131
v_cvt_pk_bf16_f32 v54, v132, v133
v_cvt_pk_bf16_f32 v55, v134, v135
v_cvt_pk_bf16_f32 v56, v136, v137
v_cvt_pk_bf16_f32 v57, v138, v139
v_cvt_pk_bf16_f32 v58, v140, v141
v_cvt_pk_bf16_f32 v59, v142, v143
ds_write_b64 v40, v[48:49] offset:0
ds_write_b64 v40, v[50:51] offset:1024
ds_write_b64 v40, v[52:53] offset:2048
ds_write_b64 v40, v[54:55] offset:512
ds_write_b64 v40, v[56:57] offset:1536
ds_write_b64 v40, v[58:59] offset:2560
s_add_u32 m0, s77, 0
s_add_u32 s94, s93, 0
buffer_load_dwordx4 v218, s[40:43], s94 offen offset:0 lds
s_add_u32 s94, s93, 3072
buffer_load_dwordx4 v219, s[40:43], s94 offen offset:1024 lds
s_add_u32 s94, s93, 6144
buffer_load_dwordx4 v218, s[40:43], s94 offen offset:2048 lds
s_add_u32 s94, s93, 9216
buffer_load_dwordx4 v219, s[40:43], s94 offen offset:3072 lds
v_add_u32 v41, 131072, v220
s_waitcnt lgkmcnt(0)
s_barrier
ds_read_b128 a[0:3], v41 offset:0
ds_read_b128 a[16:19], v41 offset:1024
ds_read_b128 a[32:35], v41 offset:2048
ds_read_b128 a[4:7], v41 offset:8192
ds_read_b128 a[20:23], v41 offset:9216
ds_read_b128 a[36:39], v41 offset:10240
ds_read_b128 a[8:11], v41 offset:16384
ds_read_b128 a[24:27], v41 offset:17408
ds_read_b128 a[40:43], v41 offset:18432
ds_read_b128 a[12:15], v41 offset:24576
ds_read_b128 a[28:31], v41 offset:25600
ds_read_b128 a[44:47], v41 offset:26624
s_add_u32 m0, s77, 4096
s_add_u32 s94, s93, 16384
buffer_load_dwordx4 v218, s[40:43], s94 offen offset:0 lds
s_add_u32 s94, s93, 19456
buffer_load_dwordx4 v219, s[40:43], s94 offen offset:1024 lds
s_add_u32 s94, s93, 22528
buffer_load_dwordx4 v218, s[40:43], s94 offen offset:2048 lds
s_add_u32 s94, s93, 25600
buffer_load_dwordx4 v219, s[40:43], s94 offen offset:3072 lds
s_waitcnt lgkmcnt(0)
s_add_u32 m0, s77, 8192
s_add_u32 s94, s93, 32768
buffer_load_dwordx4 v218, s[40:43], s94 offen offset:0 lds
s_add_u32 s94, s93, 35840
buffer_load_dwordx4 v219, s[40:43], s94 offen offset:1024 lds
s_add_u32 s94, s93, 38912
buffer_load_dwordx4 v218, s[40:43], s94 offen offset:2048 lds
s_add_u32 s94, s93, 41984
buffer_load_dwordx4 v219, s[40:43], s94 offen offset:3072 lds
s_add_u32 s60, s36, 256
s_addc_u32 s61, s37, 0
s_sub_u32 s62, s38, 256
s_mov_b32 s63, 0x20000
s_cmp_lg_u32 s76, 0
s_cbranch_scc1 L_nopub
s_mov_b32 s95, 0
buffer_store_dwordx4 a[0:3], v220, s[64:67], s95 offen offset:0 sc1
buffer_store_dwordx4 a[16:19], v220, s[64:67], s95 offen offset:1024 sc1
buffer_store_dwordx4 a[32:35], v220, s[64:67], s95 offen offset:2048 sc1
buffer_store_dwordx4 a[4:7], v220, s[64:67], s95 offen offset:3072 sc1
s_mov_b32 s95, 4096
buffer_store_dwordx4 a[20:23], v220, s[64:67], s95 offen offset:0 sc1
buffer_store_dwordx4 a[36:39], v220, s[64:67], s95 offen offset:1024 sc1
buffer_store_dwordx4 a[8:11], v220, s[64:67], s95 offen offset:2048 sc1
buffer_store_dwordx4 a[24:27], v220, s[64:67], s95 offen offset:3072 sc1
s_mov_b32 s95, 8192
buffer_store_dwordx4 a[40:43], v220, s[64:67], s95 offen offset:0 sc1
buffer_store_dwordx4 a[12:15], v220, s[64:67], s95 offen offset:1024 sc1
buffer_store_dwordx4 a[28:31], v220, s[64:67], s95 offen offset:2048 sc1
buffer_store_dwordx4 a[44:47], v220, s[64:67], s95 offen offset:3072 sc1
s_waitcnt vmcnt(0)
s_mov_b64 exec, 1
v_mov_b32 v1, 0
v_mov_b32 v2, 1
buffer_store_dword v2, v1, s[4:7], s8 offen sc1
s_mov_b64 exec, -1
L_nopub:
s_mov_b32 s97, 0
s_mov_b32 s96, 0
s_mov_b32 s84, 0
s_add_u32 s79, s2, 0
s_and_b32 s79, s79, 3
s_lshl_b32 s79, s79, 6
v_xor_b32 v36, s79, v221
v_xor_b32 v37, 32, v36
s_add_u32 s79, s2, 1
s_and_b32 s79, s79, 3
s_lshl_b32 s79, s79, 6
v_xor_b32 v38, s79, v221
v_xor_b32 v39, 32, v38
s_add_u32 s79, s2, 2
s_and_b32 s79, s79, 3
s_lshl_b32 s79, s79, 6
v_xor_b32 v40, s79, v221
v_xor_b32 v41, 32, v40
s_add_u32 s79, s2, 3
s_and_b32 s79, s79, 3
s_lshl_b32 s79, s79, 6
v_xor_b32 v42, s79, v221
v_xor_b32 v43, 32, v42
s_waitcnt vmcnt(0)
ds_read_b64 a[160:161], v36 offset:0
ds_read_b64 a[162:163], v37 offset:0
ds_read_b64 a[164:165], v38 offset:0
ds_read_b64 a[166:167], v39 offset:0
ds_read_b64 a[168:169], v40 offset:0
ds_read_b64 a[170:171], v41 offset:0
ds_read_b64 a[172:173], v42 offset:0
ds_read_b64 a[174:175], v43 offset:0
ds_read_b64 a[176:177], v36 offset:4096
ds_read_b64 a[178:179], v37 offset:4096
ds_read_b64 a[180:181], v38 offset:4096
ds_read_b64 a[182:183], v39 offset:4096
ds_read_b64 a[184:185], v40 offset:4096
ds_read_b64 a[186:187], v41 offset:4096
ds_read_b64 a[188:189], v42 offset:4096
ds_read_b64 a[190:191], v43 offset:4096
ds_read_b64 a[192:193], v36 offset:8192
ds_read_b64 a[194:195], v37 offset:8192
ds_read_b64 a[196:197], v38 offset:8192
ds_read_b64 a[198:199], v39 offset:8192
ds_read_b64 a[200:201], v40 offset:8192
ds_read_b64 a[202:203], v41 offset:8192
ds_read_b64 a[204:205], v42 offset:8192
ds_read_b64 a[206:207], v43 offset:8192
s_waitcnt lgkmcnt(0)
s_add_u32 s85, s2, 2
s_and_b32 s85, s85, 3
s_lshl_b32 s85, s85, 18
s_add_u32 s85, s85, s92
s_add_u32 m0, s77, 0
s_add_u32 s94, s85, 0
buffer_load_dwordx4 v216, s[36:39], s94 offen offset:0 lds
s_add_u32 s94, s85, 31744
buffer_load_dwordx4 v217, s[36:39], s94 offen offset:1024 lds
s_add_u32 s94, s85, 63488
buffer_load_dwordx4 v216, s[36:39], s94 offen offset:2048 lds
s_add_u32 s94, s85, 95232
buffer_load_dwordx4 v217, s[36:39], s94 offen offset:3072 lds
s_add_u32 m0, s77, 4096
s_add_u32 s94, s85, 131072
buffer_load_dwordx4 v216, s[36:39], s94 offen offset:0 lds
s_add_u32 s94, s85, 162816
buffer_load_dwordx4 v217, s[36:39], s94 offen offset:1024 lds
s_add_u32 s94, s85, 194560
buffer_load_dwordx4 v216, s[36:39], s94 offen offset:2048 lds
s_add_u32 s94, s85, 226304
buffer_load_dwordx4 v217, s[36:39], s94 offen offset:3072 lds
s_add_u32 s85, s2, 3
s_and_b32 s85, s85, 3
s_lshl_b32 s85, s85, 18
s_add_u32 s85, s85, s92
s_add_u32 m0, s77, 8192
s_add_u32 s94, s85, 0
buffer_load_dwordx4 v216, s[36:39], s94 offen offset:0 lds
s_add_u32 s94, s85, 31744
buffer_load_dwordx4 v217, s[36:39], s94 offen offset:1024 lds
s_add_u32 s94, s85, 63488
buffer_load_dwordx4 v216, s[36:39], s94 offen offset:2048 lds
s_add_u32 s94, s85, 95232
buffer_load_dwordx4 v217, s[36:39], s94 offen offset:3072 lds
s_add_u32 m0, s77, 12288
s_add_u32 s94, s85, 131072
buffer_load_dwordx4 v216, s[36:39], s94 offen offset:0 lds
s_add_u32 s94, s85, 162816
buffer_load_dwordx4 v217, s[36:39], s94 offen offset:1024 lds
s_add_u32 s94, s85, 194560
buffer_load_dwordx4 v216, s[36:39], s94 offen offset:2048 lds
s_add_u32 s94, s85, 226304
buffer_load_dwordx4 v217, s[36:39], s94 offen offset:3072 lds
ds_read_b64_tr_b16 a[128:129], v16 offset:16384
ds_read_b64_tr_b16 a[130:131], v16 offset:20480
ds_read_b64_tr_b16 a[132:133], v17 offset:16384
ds_read_b64_tr_b16 a[134:135], v17 offset:20480
ds_read_b64_tr_b16 a[136:137], v18 offset:16384
ds_read_b64_tr_b16 a[138:139], v18 offset:20480
ds_read_b64_tr_b16 a[140:141], v19 offset:16384
ds_read_b64_tr_b16 a[142:143], v19 offset:20480
ds_read_b64_tr_b16 a[144:145], v20 offset:16384
ds_read_b64_tr_b16 a[146:147], v20 offset:20480
ds_read_b64_tr_b16 a[148:149], v21 offset:16384
ds_read_b64_tr_b16 a[150:151], v21 offset:20480
ds_read_b64_tr_b16 a[152:153], v22 offset:16384
ds_read_b64_tr_b16 a[154:155], v22 offset:20480
ds_read_b64_tr_b16 a[156:157], v23 offset:16384
ds_read_b64_tr_b16 a[158:159], v23 offset:20480
s_waitcnt lgkmcnt(0)
v_mfma_f32_16x16x32_bf16 v[120:123], a[128:131], a[160:163], 0
v_mfma_f32_16x16x32_bf16 v[124:127], a[128:131], a[176:179], 0
v_mfma_f32_16x16x32_bf16 v[128:131], a[128:131], a[192:195], 0
s_add_u32 s85, s2, 0
s_and_b32 s85, s85, 3
s_lshl_b32 s85, s85, 18
s_add_u32 s85, s85, s92
s_add_u32 m0, s77, 16384
s_add_u32 s94, s85, 0
buffer_load_dwordx4 v216, s[60:63], s94 offen offset:0 lds
v_mfma_f32_16x16x32_bf16 v[132:135], a[132:135], a[160:163], 0
v_mfma_f32_16x16x32_bf16 v[136:139], a[132:135], a[176:179], 0
v_mfma_f32_16x16x32_bf16 v[140:143], a[132:135], a[192:195], 0
s_add_u32 s94, s85, 31744
buffer_load_dwordx4 v217, s[60:63], s94 offen offset:1024 lds
v_mfma_f32_16x16x32_bf16 v[144:147], a[136:139], a[160:163], 0
v_mfma_f32_16x16x32_bf16 v[148:151], a[136:139], a[176:179], 0
v_mfma_f32_16x16x32_bf16 v[152:155], a[136:139], a[192:195], 0
s_add_u32 s94, s85, 63488
buffer_load_dwordx4 v216, s[60:63], s94 offen offset:2048 lds
ds_read_b64_tr_b16 a[96:97], v16 offset:24576
ds_read_b64_tr_b16 a[98:99], v16 offset:28672
ds_read_b64_tr_b16 a[100:101], v17 offset:24576
ds_read_b64_tr_b16 a[102:103], v17 offset:28672
ds_read_b64_tr_b16 a[104:105], v18 offset:24576
ds_read_b64_tr_b16 a[106:107], v18 offset:28672
ds_read_b64_tr_b16 a[108:109], v19 offset:24576
ds_read_b64_tr_b16 a[110:111], v19 offset:28672
ds_read_b64_tr_b16 a[112:113], v20 offset:24576
ds_read_b64_tr_b16 a[114:115], v20 offset:28672
ds_read_b64_tr_b16 a[116:117], v21 offset:24576
ds_read_b64_tr_b16 a[118:119], v21 offset:28672
ds_read_b64_tr_b16 a[120:121], v22 offset:24576
ds_read_b64_tr_b16 a[122:123], v22 offset:28672
ds_read_b64_tr_b16 a[124:125], v23 offset:24576
ds_read_b64_tr_b16 a[126:127], v23 offset:28672
v_mfma_f32_16x16x32_bf16 v[156:159], a[140:143], a[160:163], 0
v_mfma_f32_16x16x32_bf16 v[160:163], a[140:143], a[176:179], 0
v_mfma_f32_16x16x32_bf16 v[164:167], a[140:143], a[192:195], 0
s_add_u32 s94, s85, 95232
buffer_load_dwordx4 v217, s[60:63], s94 offen offset:3072 lds
v_mfma_f32_16x16x32_bf16 v[168:171], a[144:147], a[160:163], 0
v_mfma_f32_16x16x32_bf16 v[172:175], a[144:147], a[176:179], 0
v_mfma_f32_16x16x32_bf16 v[176:179], a[144:147], a[192:195], 0
s_add_u32 m0, s77, 20480
s_add_u32 s94, s85, 131072
buffer_load_dwordx4 v216, s[60:63], s94 offen offset:0 lds
v_mfma_f32_16x16x32_bf16 v[180:183], a[148:151], a[160:163], 0
v_mfma_f32_16x16x32_bf16 v[184:187], a[148:151], a[176:179], 0
v_mfma_f32_16x16x32_bf16 v[188:191], a[148:151], a[192:195], 0
s_add_u32 s94, s85, 162816
buffer_load_dwordx4 v217, s[60:63], s94 offen offset:1024 lds
v_mfma_f32_16x16x32_bf16 v[192:195], a[152:155], a[160:163], 0
v_mfma_f32_16x16x32_bf16 v[196:199], a[152:155], a[176:179], 0
v_mfma_f32_16x16x32_bf16 v[200:203], a[152:155], a[192:195], 0
s_add_u32 s94, s85, 194560
buffer_load_dwordx4 v216, s[60:63], s94 offen offset:2048 lds
v_mfma_f32_16x16x32_bf16 v[204:207], a[156:159], a[160:163], 0
v_mfma_f32_16x16x32_bf16 v[208:211], a[156:159], a[176:179], 0
v_mfma_f32_16x16x32_bf16 v[212:215], a[156:159], a[192:195], 0
s_add_u32 s94, s85, 226304
buffer_load_dwordx4 v217, s[60:63], s94 offen offset:3072 lds
s_waitcnt lgkmcnt(0)
v_mfma_f32_16x16x32_bf16 v[120:123], a[96:99], a[164:167], v[120:123]
v_mfma_f32_16x16x32_bf16 v[124:127], a[96:99], a[180:183], v[124:127]
v_mfma_f32_16x16x32_bf16 v[128:131], a[96:99], a[196:199], v[128:131]
s_add_u32 s85, s2, 1
s_and_b32 s85, s85, 3
s_lshl_b32 s85, s85, 18
s_add_u32 s85, s85, s92
s_add_u32 m0, s77, 24576
s_add_u32 s94, s85, 0
buffer_load_dwordx4 v216, s[60:63], s94 offen offset:0 lds
v_mfma_f32_16x16x32_bf16 v[132:135], a[100:103], a[164:167], v[132:135]
v_mfma_f32_16x16x32_bf16 v[136:139], a[100:103], a[180:183], v[136:139]
v_mfma_f32_16x16x32_bf16 v[140:143], a[100:103], a[196:199], v[140:143]
s_add_u32 s94, s85, 31744
buffer_load_dwordx4 v217, s[60:63], s94 offen offset:1024 lds
v_mfma_f32_16x16x32_bf16 v[144:147], a[104:107], a[164:167], v[144:147]
v_mfma_f32_16x16x32_bf16 v[148:151], a[104:107], a[180:183], v[148:151]
v_mfma_f32_16x16x32_bf16 v[152:155], a[104:107], a[196:199], v[152:155]
s_add_u32 s94, s85, 63488
buffer_load_dwordx4 v216, s[60:63], s94 offen offset:2048 lds
s_waitcnt vmcnt(19)
ds_read_b64_tr_b16 a[128:129], v16 offset:0
ds_read_b64_tr_b16 a[130:131], v16 offset:4096
ds_read_b64_tr_b16 a[132:133], v17 offset:0
ds_read_b64_tr_b16 a[134:135], v17 offset:4096
ds_read_b64_tr_b16 a[136:137], v18 offset:0
ds_read_b64_tr_b16 a[138:139], v18 offset:4096
ds_read_b64_tr_b16 a[140:141], v19 offset:0
ds_read_b64_tr_b16 a[142:143], v19 offset:4096
ds_read_b64_tr_b16 a[144:145], v20 offset:0
ds_read_b64_tr_b16 a[146:147], v20 offset:4096
ds_read_b64_tr_b16 a[148:149], v21 offset:0
ds_read_b64_tr_b16 a[150:151], v21 offset:4096
ds_read_b64_tr_b16 a[152:153], v22 offset:0
ds_read_b64_tr_b16 a[154:155], v22 offset:4096
ds_read_b64_tr_b16 a[156:157], v23 offset:0
ds_read_b64_tr_b16 a[158:159], v23 offset:4096
v_mfma_f32_16x16x32_bf16 v[156:159], a[108:111], a[164:167], v[156:159]
v_mfma_f32_16x16x32_bf16 v[160:163], a[108:111], a[180:183], v[160:163]
v_mfma_f32_16x16x32_bf16 v[164:167], a[108:111], a[196:199], v[164:167]
s_add_u32 s94, s85, 95232
buffer_load_dwordx4 v217, s[60:63], s94 offen offset:3072 lds
v_mfma_f32_16x16x32_bf16 v[168:171], a[112:115], a[164:167], v[168:171]
v_mfma_f32_16x16x32_bf16 v[172:175], a[112:115], a[180:183], v[172:175]
v_mfma_f32_16x16x32_bf16 v[176:179], a[112:115], a[196:199], v[176:179]
s_add_u32 m0, s77, 28672
s_add_u32 s94, s85, 131072
buffer_load_dwordx4 v216, s[60:63], s94 offen offset:0 lds
v_mfma_f32_16x16x32_bf16 v[180:183], a[116:119], a[164:167], v[180:183]
v_mfma_f32_16x16x32_bf16 v[184:187], a[116:119], a[180:183], v[184:187]
v_mfma_f32_16x16x32_bf16 v[188:191], a[116:119], a[196:199], v[188:191]
s_add_u32 s94, s85, 162816
buffer_load_dwordx4 v217, s[60:63], s94 offen offset:1024 lds
v_mfma_f32_16x16x32_bf16 v[192:195], a[120:123], a[164:167], v[192:195]
v_mfma_f32_16x16x32_bf16 v[196:199], a[120:123], a[180:183], v[196:199]
v_mfma_f32_16x16x32_bf16 v[200:203], a[120:123], a[196:199], v[200:203]
s_add_u32 s94, s85, 194560
buffer_load_dwordx4 v216, s[60:63], s94 offen offset:2048 lds
v_mfma_f32_16x16x32_bf16 v[204:207], a[124:127], a[164:167], v[204:207]
v_mfma_f32_16x16x32_bf16 v[208:211], a[124:127], a[180:183], v[208:211]
v_mfma_f32_16x16x32_bf16 v[212:215], a[124:127], a[196:199], v[212:215]
s_add_u32 s94, s85, 226304
buffer_load_dwordx4 v217, s[60:63], s94 offen offset:3072 lds
s_waitcnt lgkmcnt(0)
v_mfma_f32_16x16x32_bf16 v[120:123], a[128:131], a[168:171], v[120:123]
v_mfma_f32_16x16x32_bf16 v[124:127], a[128:131], a[184:187], v[124:127]
v_mfma_f32_16x16x32_bf16 v[128:131], a[128:131], a[200:203], v[128:131]
v_mfma_f32_16x16x32_bf16 v[132:135], a[132:135], a[168:171], v[132:135]
v_mfma_f32_16x16x32_bf16 v[136:139], a[132:135], a[184:187], v[136:139]
v_mfma_f32_16x16x32_bf16 v[140:143], a[132:135], a[200:203], v[140:143]
v_mfma_f32_16x16x32_bf16 v[144:147], a[136:139], a[168:171], v[144:147]
v_mfma_f32_16x16x32_bf16 v[148:151], a[136:139], a[184:187], v[148:151]
v_mfma_f32_16x16x32_bf16 v[152:155], a[136:139], a[200:203], v[152:155]
s_waitcnt vmcnt(16)
ds_read_b64_tr_b16 a[96:97], v16 offset:8192
ds_read_b64_tr_b16 a[98:99], v16 offset:12288
ds_read_b64_tr_b16 a[100:101], v17 offset:8192
ds_read_b64_tr_b16 a[102:103], v17 offset:12288
ds_read_b64_tr_b16 a[104:105], v18 offset:8192
ds_read_b64_tr_b16 a[106:107], v18 offset:12288
ds_read_b64_tr_b16 a[108:109], v19 offset:8192
ds_read_b64_tr_b16 a[110:111], v19 offset:12288
ds_read_b64_tr_b16 a[112:113], v20 offset:8192
ds_read_b64_tr_b16 a[114:115], v20 offset:12288
ds_read_b64_tr_b16 a[116:117], v21 offset:8192
ds_read_b64_tr_b16 a[118:119], v21 offset:12288
ds_read_b64_tr_b16 a[120:121], v22 offset:8192
ds_read_b64_tr_b16 a[122:123], v22 offset:12288
ds_read_b64_tr_b16 a[124:125], v23 offset:8192
ds_read_b64_tr_b16 a[126:127], v23 offset:12288
v_mfma_f32_16x16x32_bf16 v[156:159], a[140:143], a[168:171], v[156:159]
v_mfma_f32_16x16x32_bf16 v[160:163], a[140:143], a[184:187], v[160:163]
v_mfma_f32_16x16x32_bf16 v[164:167], a[140:143], a[200:203], v[164:167]
v_mfma_f32_16x16x32_bf16 v[168:171], a[144:147], a[168:171], v[168:171]
v_mfma_f32_16x16x32_bf16 v[172:175], a[144:147], a[184:187], v[172:175]
v_mfma_f32_16x16x32_bf16 v[176:179], a[144:147], a[200:203], v[176:179]
v_mfma_f32_16x16x32_bf16 v[180:183], a[148:151], a[168:171], v[180:183]
v_mfma_f32_16x16x32_bf16 v[184:187], a[148:151], a[184:187], v[184:187]
v_mfma_f32_16x16x32_bf16 v[188:191], a[148:151], a[200:203], v[188:191]
v_mfma_f32_16x16x32_bf16 v[192:195], a[152:155], a[168:171], v[192:195]
v_mfma_f32_16x16x32_bf16 v[196:199], a[152:155], a[184:187], v[196:199]
v_mfma_f32_16x16x32_bf16 v[200:203], a[152:155], a[200:203], v[200:203]
v_mfma_f32_16x16x32_bf16 v[204:207], a[156:159], a[168:171], v[204:207]
v_mfma_f32_16x16x32_bf16 v[208:211], a[156:159], a[184:187], v[208:211]
v_mfma_f32_16x16x32_bf16 v[212:215], a[156:159], a[200:203], v[212:215]
s_waitcnt lgkmcnt(0)
v_mfma_f32_16x16x32_bf16 v[120:123], a[96:99], a[172:175], v[120:123]
v_mfma_f32_16x16x32_bf16 v[124:127], a[96:99], a[188:191], v[124:127]
v_mfma_f32_16x16x32_bf16 v[128:131], a[96:99], a[204:207], v[128:131]
v_mfma_f32_16x16x32_bf16 v[132:135], a[100:103], a[172:175], v[132:135]
v_mfma_f32_16x16x32_bf16 v[136:139], a[100:103], a[188:191], v[136:139]
v_mfma_f32_16x16x32_bf16 v[140:143], a[100:103], a[204:207], v[140:143]
v_mfma_f32_16x16x32_bf16 v[144:147], a[104:107], a[172:175], v[144:147]
v_mfma_f32_16x16x32_bf16 v[148:151], a[104:107], a[188:191], v[148:151]
v_mfma_f32_16x16x32_bf16 v[152:155], a[104:107], a[204:207], v[152:155]
v_mfma_f32_16x16x32_bf16 v[156:159], a[108:111], a[172:175], v[156:159]
v_mfma_f32_16x16x32_bf16 v[160:163], a[108:111], a[188:191], v[160:163]
v_mfma_f32_16x16x32_bf16 v[164:167], a[108:111], a[204:207], v[164:167]
v_mfma_f32_16x16x32_bf16 v[168:171], a[112:115], a[172:175], v[168:171]
v_mfma_f32_16x16x32_bf16 v[172:175], a[112:115], a[188:191], v[172:175]
v_mfma_f32_16x16x32_bf16 v[176:179], a[112:115], a[204:207], v[176:179]
v_mfma_f32_16x16x32_bf16 v[180:183], a[116:119], a[172:175], v[180:183]
v_mfma_f32_16x16x32_bf16 v[184:187], a[116:119], a[188:191], v[184:187]
v_mfma_f32_16x16x32_bf16 v[188:191], a[116:119], a[204:207], v[188:191]
v_mfma_f32_16x16x32_bf16 v[192:195], a[120:123], a[172:175], v[192:195]
v_mfma_f32_16x16x32_bf16 v[196:199], a[120:123], a[188:191], v[196:199]
v_mfma_f32_16x16x32_bf16 v[200:203], a[120:123], a[204:207], v[200:203]
v_mfma_f32_16x16x32_bf16 v[204:207], a[124:127], a[172:175], v[204:207]
v_mfma_f32_16x16x32_bf16 v[208:211], a[124:127], a[188:191], v[208:211]
v_mfma_f32_16x16x32_bf16 v[212:215], a[124:127], a[204:207], v[212:215]
s_nop 7
s_barrier
s_add_u32 s79, s76, 1
s_and_b32 s79, s79, 3
s_lshl_b32 s79, s79, 15
v_add_u32 v42, s79, v220
s_add_u32 s79, s76, 2
s_and_b32 s79, s79, 3
s_lshl_b32 s79, s79, 15
v_add_u32 v43, s79, v220
s_add_u32 s79, s76, 3
s_and_b32 s79, s79, 3
s_lshl_b32 s79, s79, 13
s_add_u32 s79, s79, 131072
v_add_u32 v44, s79, v220
ds_write_b128 v42, v[144:147] offset:0
ds_write_b128 v42, v[148:151] offset:1024
ds_write_b128 v42, v[152:155] offset:2048
ds_write_b128 v42, v[156:159] offset:3072
ds_write_b128 v42, v[160:163] offset:4096
ds_write_b128 v42, v[164:167] offset:5120
ds_write_b128 v43, v[168:171] offset:8192
ds_write_b128 v43, v[172:175] offset:9216
ds_write_b128 v43, v[176:179] offset:10240
ds_write_b128 v43, v[180:183] offset:11264
ds_write_b128 v43, v[184:187] offset:12288
ds_write_b128 v43, v[188:191] offset:13312
ds_write_b128 v44, v[192:195] offset:0
ds_write_b128 v44, v[196:199] offset:1024
ds_write_b128 v44, v[200:203] offset:2048
ds_write_b128 v44, v[204:207] offset:3072
ds_write_b128 v44, v[208:211] offset:4096
ds_write_b128 v44, v[212:215] offset:5120
v_add_u32 v38, s77, v220
s_lshl_b32 s79, s76, 13
s_add_u32 s79, s79, 131072
v_add_u32 v39, s79, v220
s_waitcnt lgkmcnt(0)
s_barrier
ds_read_b128 v[48:51], v38 offset:0
ds_read_b128 v[52:55], v38 offset:1024
ds_read_b128 v[56:59], v38 offset:2048
ds_read_b128 v[60:63], v38 offset:3072
ds_read_b128 v[64:67], v38 offset:4096
ds_read_b128 v[68:71], v38 offset:5120
ds_read_b128 v[72:75], v38 offset:8192
ds_read_b128 v[76:79], v38 offset:9216
ds_read_b128 v[80:83], v38 offset:10240
ds_read_b128 v[84:87], v38 offset:11264
ds_read_b128 v[88:91], v38 offset:12288
ds_read_b128 v[92:95], v38 offset:13312
ds_read_b128 v[96:99], v39 offset:0
ds_read_b128 v[100:103], v39 offset:1024
ds_read_b128 v[104:107], v39 offset:2048
ds_read_b128 v[108:111], v39 offset:3072
ds_read_b128 v[112:115], v39 offset:4096
ds_read_b128 v[116:119], v39 offset:5120
v_lshrrev_b32 v40, 5, v0
v_lshlrev_b32 v40, 8, v40
v_and_b32 v41, 15, v0
v_lshl_add_u32 v40, v41, 4, v40
v_bfe_u32 v41, v0, 4, 1
v_lshl_add_u32 v40, v41, 3, v40
v_add_u32 v40, s79, v40
s_waitcnt lgkmcnt(12)
v_add_f32 v120, v120, v48
v_add_f32 v121, v121, v49
v_add_f32 v122, v122, v50
v_add_f32 v123, v123, v51
v_add_f32 v124, v124, v52
v_add_f32 v125, v125, v53
v_add_f32 v126, v126, v54
v_add_f32 v127, v127, v55
v_add_f32 v128, v128, v56
v_add_f32 v129, v129, v57
v_add_f32 v130, v130, v58
v_add_f32 v131, v131, v59
v_add_f32 v132, v132, v60
v_add_f32 v133, v133, v61
v_add_f32 v134, v134, v62
v_add_f32 v135, v135, v63
v_add_f32 v136, v136, v64
v_add_f32 v137, v137, v65
v_add_f32 v138, v138, v66
v_add_f32 v139, v139, v67
v_add_f32 v140, v140, v68
v_add_f32 v141, v141, v69
v_add_f32 v142, v142, v70
v_add_f32 v143, v143, v71
s_waitcnt lgkmcnt(6)
v_add_f32 v120, v120, v72
v_add_f32 v121, v121, v73
v_add_f32 v122, v122, v74
v_add_f32 v123, v123, v75
v_add_f32 v124, v124, v76
v_add_f32 v125, v125, v77
v_add_f32 v126, v126, v78
v_add_f32 v127, v127, v79
v_add_f32 v128, v128, v80
v_add_f32 v129, v129, v81
v_add_f32 v130, v130, v82
v_add_f32 v131, v131, v83
v_add_f32 v132, v132, v84
v_add_f32 v133, v133, v85
v_add_f32 v134, v134, v86
v_add_f32 v135, v135, v87
v_add_f32 v136, v136, v88
v_add_f32 v137, v137, v89
v_add_f32 v138, v138, v90
v_add_f32 v139, v139, v91
v_add_f32 v140, v140, v92
v_add_f32 v141, v141, v93
v_add_f32 v142, v142, v94
v_add_f32 v143, v143, v95
s_waitcnt lgkmcnt(0)
v_add_f32 v120, v120, v96
v_add_f32 v121, v121, v97
v_add_f32 v122, v122, v98
v_add_f32 v123, v123, v99
v_add_f32 v124, v124, v100
v_add_f32 v125, v125, v101
v_add_f32 v126, v126, v102
v_add_f32 v127, v127, v103
v_add_f32 v128, v128, v104
v_add_f32 v129, v129, v105
v_add_f32 v130, v130, v106
v_add_f32 v131, v131, v107
v_add_f32 v132, v132, v108
v_add_f32 v133, v133, v109
v_add_f32 v134, v134, v110
v_add_f32 v135, v135, v111
v_add_f32 v136, v136, v112
v_add_f32 v137, v137, v113
v_add_f32 v138, v138, v114
v_add_f32 v139, v139, v115
v_add_f32 v140, v140, v116
v_add_f32 v141, v141, v117
v_add_f32 v142, v142, v118
v_add_f32 v143, v143, v119
v_cvt_pk_bf16_f32 v48, v120, v121
v_cvt_pk_bf16_f32 v49, v122, v123
v_cvt_pk_bf16_f32 v50, v124, v125
v_cvt_pk_bf16_f32 v51, v126, v127
v_cvt_pk_bf16_f32 v52, v128, v129
v_cvt_pk_bf16_f32 v53, v130, v131
v_cvt_pk_bf16_f32 v54, v132, v133
v_cvt_pk_bf16_f32 v55, v134, v135
v_cvt_pk_bf16_f32 v56, v136, v137
v_cvt_pk_bf16_f32 v57, v138, v139
v_cvt_pk_bf16_f32 v58, v140, v141
v_cvt_pk_bf16_f32 v59, v142, v143
ds_write_b64 v40, v[48:49] offset:0
ds_write_b64 v40, v[50:51] offset:1024
ds_write_b64 v40, v[52:53] offset:2048
ds_write_b64 v40, v[54:55] offset:512
ds_write_b64 v40, v[56:57] offset:1536
ds_write_b64 v40, v[58:59] offset:2560
s_add_u32 s85, s2, 2
s_and_b32 s85, s85, 3
s_lshl_b32 s85, s85, 18
s_add_u32 s85, s85, s92
s_add_u32 m0, s77, 0
s_add_u32 s94, s85, 0
buffer_load_dwordx4 v216, s[60:63], s94 offen offset:0 lds
s_add_u32 s94, s85, 31744
buffer_load_dwordx4 v217, s[60:63], s94 offen offset:1024 lds
s_add_u32 s94, s85, 63488
buffer_load_dwordx4 v216, s[60:63], s94 offen offset:2048 lds
s_add_u32 s94, s85, 95232
buffer_load_dwordx4 v217, s[60:63], s94 offen offset:3072 lds
v_add_u32 v41, 131072, v220
s_waitcnt lgkmcnt(0)
s_barrier
ds_read_b128 a[0:3], v41 offset:0
ds_read_b128 a[16:19], v41 offset:1024
ds_read_b128 a[32:35], v41 offset:2048
ds_read_b128 a[4:7], v41 offset:8192
ds_read_b128 a[20:23], v41 offset:9216
ds_read_b128 a[36:39], v41 offset:10240
ds_read_b128 a[8:11], v41 offset:16384
ds_read_b128 a[24:27], v41 offset:17408
ds_read_b128 a[40:43], v41 offset:18432
ds_read_b128 a[12:15], v41 offset:24576
ds_read_b128 a[28:31], v41 offset:25600
ds_read_b128 a[44:47], v41 offset:26624
s_add_u32 m0, s77, 4096
s_add_u32 s94, s85, 131072
buffer_load_dwordx4 v216, s[60:63], s94 offen offset:0 lds
s_add_u32 s94, s85, 162816
buffer_load_dwordx4 v217, s[60:63], s94 offen offset:1024 lds
s_add_u32 s94, s85, 194560
buffer_load_dwordx4 v216, s[60:63], s94 offen offset:2048 lds
s_add_u32 s94, s85, 226304
buffer_load_dwordx4 v217, s[60:63], s94 offen offset:3072 lds
s_waitcnt lgkmcnt(0)
s_add_u32 s85, s2, 3
s_and_b32 s85, s85, 3
s_lshl_b32 s85, s85, 18
s_add_u32 s85, s85, s92
s_add_u32 m0, s77, 8192
s_add_u32 s94, s85, 0
buffer_load_dwordx4 v216, s[60:63], s94 offen offset:0 lds
s_add_u32 s94, s85, 31744
buffer_load_dwordx4 v217, s[60:63], s94 offen offset:1024 lds
s_add_u32 s94, s85, 63488
buffer_load_dwordx4 v216, s[60:63], s94 offen offset:2048 lds
s_add_u32 s94, s85, 95232
buffer_load_dwordx4 v217, s[60:63], s94 offen offset:3072 lds
s_add_u32 m0, s77, 12288
s_add_u32 s94, s85, 131072
buffer_load_dwordx4 v216, s[60:63], s94 offen offset:0 lds
s_add_u32 s94, s85, 162816
buffer_load_dwordx4 v217, s[60:63], s94 offen offset:1024 lds
s_add_u32 s94, s85, 194560
buffer_load_dwordx4 v216, s[60:63], s94 offen offset:2048 lds
s_add_u32 s94, s85, 226304
buffer_load_dwordx4 v217, s[60:63], s94 offen offset:3072 lds
s_waitcnt vmcnt(24)
ds_read_b64_tr_b16 a[128:129], v16 offset:16384
ds_read_b64_tr_b16 a[130:131], v16 offset:20480
ds_read_b64_tr_b16 a[132:133], v17 offset:16384
ds_read_b64_tr_b16 a[134:135], v17 offset:20480
ds_read_b64_tr_b16 a[136:137], v18 offset:16384
ds_read_b64_tr_b16 a[138:139], v18 offset:20480
ds_read_b64_tr_b16 a[140:141], v19 offset:16384
ds_read_b64_tr_b16 a[142:143], v19 offset:20480
ds_read_b64_tr_b16 a[144:145], v20 offset:16384
ds_read_b64_tr_b16 a[146:147], v20 offset:20480
ds_read_b64_tr_b16 a[148:149], v21 offset:16384
ds_read_b64_tr_b16 a[150:151], v21 offset:20480
ds_read_b64_tr_b16 a[152:153], v22 offset:16384
ds_read_b64_tr_b16 a[154:155], v22 offset:20480
ds_read_b64_tr_b16 a[156:157], v23 offset:16384
ds_read_b64_tr_b16 a[158:159], v23 offset:20480
s_waitcnt lgkmcnt(0)
v_mfma_f32_16x16x32_bf16 v[120:123], a[128:131], a[160:163], 0
v_mfma_f32_16x16x32_bf16 v[124:127], a[128:131], a[176:179], 0
v_mfma_f32_16x16x32_bf16 v[128:131], a[128:131], a[192:195], 0
v_mfma_f32_16x16x32_bf16 v[132:135], a[132:135], a[160:163], 0
v_mfma_f32_16x16x32_bf16 v[136:139], a[132:135], a[176:179], 0
v_mfma_f32_16x16x32_bf16 v[140:143], a[132:135], a[192:195], 0
v_mfma_f32_16x16x32_bf16 v[144:147], a[136:139], a[160:163], 0
v_mfma_f32_16x16x32_bf16 v[148:151], a[136:139], a[176:179], 0
v_mfma_f32_16x16x32_bf16 v[152:155], a[136:139], a[192:195], 0
s_waitcnt vmcnt(16)
ds_read_b64_tr_b16 a[96:97], v16 offset:24576
ds_read_b64_tr_b16 a[98:99], v16 offset:28672
ds_read_b64_tr_b16 a[100:101], v17 offset:24576
ds_read_b64_tr_b16 a[102:103], v17 offset:28672
ds_read_b64_tr_b16 a[104:105], v18 offset:24576
ds_read_b64_tr_b16 a[106:107], v18 offset:28672
ds_read_b64_tr_b16 a[108:109], v19 offset:24576
ds_read_b64_tr_b16 a[110:111], v19 offset:28672
ds_read_b64_tr_b16 a[112:113], v20 offset:24576
ds_read_b64_tr_b16 a[114:115], v20 offset:28672
ds_read_b64_tr_b16 a[116:117], v21 offset:24576
ds_read_b64_tr_b16 a[118:119], v21 offset:28672
ds_read_b64_tr_b16 a[120:121], v22 offset:24576
ds_read_b64_tr_b16 a[122:123], v22 offset:28672
ds_read_b64_tr_b16 a[124:125], v23 offset:24576
ds_read_b64_tr_b16 a[126:127], v23 offset:28672
v_mfma_f32_16x16x32_bf16 v[156:159], a[140:143], a[160:163], 0
v_mfma_f32_16x16x32_bf16 v[160:163], a[140:143], a[176:179], 0
v_mfma_f32_16x16x32_bf16 v[164:167], a[140:143], a[192:195], 0
v_mfma_f32_16x16x32_bf16 v[168:171], a[144:147], a[160:163], 0
v_mfma_f32_16x16x32_bf16 v[172:175], a[144:147], a[176:179], 0
v_mfma_f32_16x16x32_bf16 v[176:179], a[144:147], a[192:195], 0
v_mfma_f32_16x16x32_bf16 v[180:183], a[148:151], a[160:163], 0
v_mfma_f32_16x16x32_bf16 v[184:187], a[148:151], a[176:179], 0
v_mfma_f32_16x16x32_bf16 v[188:191], a[148:151], a[192:195], 0
v_mfma_f32_16x16x32_bf16 v[192:195], a[152:155], a[160:163], 0
v_mfma_f32_16x16x32_bf16 v[196:199], a[152:155], a[176:179], 0
v_mfma_f32_16x16x32_bf16 v[200:203], a[152:155], a[192:195], 0
v_mfma_f32_16x16x32_bf16 v[204:207], a[156:159], a[160:163], 0
v_mfma_f32_16x16x32_bf16 v[208:211], a[156:159], a[176:179], 0
v_mfma_f32_16x16x32_bf16 v[212:215], a[156:159], a[192:195], 0
s_waitcnt lgkmcnt(0)
v_mfma_f32_16x16x32_bf16 v[120:123], a[96:99], a[164:167], v[120:123]
v_mfma_f32_16x16x32_bf16 v[124:127], a[96:99], a[180:183], v[124:127]
v_mfma_f32_16x16x32_bf16 v[128:131], a[96:99], a[196:199], v[128:131]
v_mfma_f32_16x16x32_bf16 v[132:135], a[100:103], a[164:167], v[132:135]
v_mfma_f32_16x16x32_bf16 v[136:139], a[100:103], a[180:183], v[136:139]
v_mfma_f32_16x16x32_bf16 v[140:143], a[100:103], a[196:199], v[140:143]
v_mfma_f32_16x16x32_bf16 v[144:147], a[104:107], a[164:167], v[144:147]
v_mfma_f32_16x16x32_bf16 v[148:151], a[104:107], a[180:183], v[148:151]
v_mfma_f32_16x16x32_bf16 v[152:155], a[104:107], a[196:199], v[152:155]
s_waitcnt vmcnt(8)
ds_read_b64_tr_b16 a[128:129], v16 offset:0
ds_read_b64_tr_b16 a[130:131], v16 offset:4096
ds_read_b64_tr_b16 a[132:133], v17 offset:0
ds_read_b64_tr_b16 a[134:135], v17 offset:4096
ds_read_b64_tr_b16 a[136:137], v18 offset:0
ds_read_b64_tr_b16 a[138:139], v18 offset:4096
ds_read_b64_tr_b16 a[140:141], v19 offset:0
ds_read_b64_tr_b16 a[142:143], v19 offset:4096
ds_read_b64_tr_b16 a[144:145], v20 offset:0
ds_read_b64_tr_b16 a[146:147], v20 offset:4096
ds_read_b64_tr_b16 a[148:149], v21 offset:0
ds_read_b64_tr_b16 a[150:151], v21 offset:4096
ds_read_b64_tr_b16 a[152:153], v22 offset:0
ds_read_b64_tr_b16 a[154:155], v22 offset:4096
ds_read_b64_tr_b16 a[156:157], v23 offset:0
ds_read_b64_tr_b16 a[158:159], v23 offset:4096
v_mfma_f32_16x16x32_bf16 v[156:159], a[108:111], a[164:167], v[156:159]
v_mfma_f32_16x16x32_bf16 v[160:163], a[108:111], a[180:183], v[160:163]
v_mfma_f32_16x16x32_bf16 v[164:167], a[108:111], a[196:199], v[164:167]
v_mfma_f32_16x16x32_bf16 v[168:171], a[112:115], a[164:167], v[168:171]
v_mfma_f32_16x16x32_bf16 v[172:175], a[112:115], a[180:183], v[172:175]
v_mfma_f32_16x16x32_bf16 v[176:179], a[112:115], a[196:199], v[176:179]
v_mfma_f32_16x16x32_bf16 v[180:183], a[116:119], a[164:167], v[180:183]
v_mfma_f32_16x16x32_bf16 v[184:187], a[116:119], a[180:183], v[184:187]
v_mfma_f32_16x16x32_bf16 v[188:191], a[116:119], a[196:199], v[188:191]
v_mfma_f32_16x16x32_bf16 v[192:195], a[120:123], a[164:167], v[192:195]
v_mfma_f32_16x16x32_bf16 v[196:199], a[120:123], a[180:183], v[196:199]
v_mfma_f32_16x16x32_bf16 v[200:203], a[120:123], a[196:199], v[200:203]
v_mfma_f32_16x16x32_bf16 v[204:207], a[124:127], a[164:167], v[204:207]
v_mfma_f32_16x16x32_bf16 v[208:211], a[124:127], a[180:183], v[208:211]
v_mfma_f32_16x16x32_bf16 v[212:215], a[124:127], a[196:199], v[212:215]
s_waitcnt lgkmcnt(0)
v_mfma_f32_16x16x32_bf16 v[120:123], a[128:131], a[168:171], v[120:123]
v_mfma_f32_16x16x32_bf16 v[124:127], a[128:131], a[184:187], v[124:127]
v_mfma_f32_16x16x32_bf16 v[128:131], a[128:131], a[200:203], v[128:131]
s_add_u32 s98, s96, s97
s_and_b32 s98, s98, 3
s_and_b32 s78, s96, -4
s_or_b32 s78, s78, s98
s_lshl_b32 s78, s78, 15
s_add_u32 s78, s78, s99
s_add_u32 s96, s96, 1
s_add_u32 m0, s77, 16384
s_add_u32 s94, s78, 0
buffer_load_dwordx4 v28, s[28:31], s94 offen offset:0 nt lds
v_mfma_f32_16x16x32_bf16 v[132:135], a[132:135], a[168:171], v[132:135]
v_mfma_f32_16x16x32_bf16 v[136:139], a[132:135], a[184:187], v[136:139]
v_mfma_f32_16x16x32_bf16 v[140:143], a[132:135], a[200:203], v[140:143]
buffer_load_dwordx4 v29, s[28:31], s94 offen offset:1024 nt lds
v_mfma_f32_16x16x32_bf16 v[144:147], a[136:139], a[168:171], v[144:147]
v_mfma_f32_16x16x32_bf16 v[148:151], a[136:139], a[184:187], v[148:151]
v_mfma_f32_16x16x32_bf16 v[152:155], a[136:139], a[200:203], v[152:155]
buffer_load_dwordx4 v28, s[28:31], s94 offen offset:2048 nt lds
s_waitcnt vmcnt(3)
ds_read_b64_tr_b16 a[96:97], v16 offset:8192
ds_read_b64_tr_b16 a[98:99], v16 offset:12288
ds_read_b64_tr_b16 a[100:101], v17 offset:8192
ds_read_b64_tr_b16 a[102:103], v17 offset:12288
ds_read_b64_tr_b16 a[104:105], v18 offset:8192
ds_read_b64_tr_b16 a[106:107], v18 offset:12288
ds_read_b64_tr_b16 a[108:109], v19 offset:8192
ds_read_b64_tr_b16 a[110:111], v19 offset:12288
ds_read_b64_tr_b16 a[112:113], v20 offset:8192
ds_read_b64_tr_b16 a[114:115], v20 offset:12288
ds_read_b64_tr_b16 a[116:117], v21 offset:8192
ds_read_b64_tr_b16 a[118:119], v21 offset:12288
ds_read_b64_tr_b16 a[120:121], v22 offset:8192
ds_read_b64_tr_b16 a[122:123], v22 offset:12288
ds_read_b64_tr_b16 a[124:125], v23 offset:8192
ds_read_b64_tr_b16 a[126:127], v23 offset:12288
v_mfma_f32_16x16x32_bf16 v[156:159], a[140:143], a[168:171], v[156:159]
v_mfma_f32_16x16x32_bf16 v[160:163], a[140:143], a[184:187], v[160:163]
v_mfma_f32_16x16x32_bf16 v[164:167], a[140:143], a[200:203], v[164:167]
buffer_load_dwordx4 v29, s[28:31], s94 offen offset:3072 nt lds
v_mfma_f32_16x16x32_bf16 v[168:171], a[144:147], a[168:171], v[168:171]
v_mfma_f32_16x16x32_bf16 v[172:175], a[144:147], a[184:187], v[172:175]
v_mfma_f32_16x16x32_bf16 v[176:179], a[144:147], a[200:203], v[176:179]
s_add_u32 m0, s77, 20480
s_add_u32 s94, s78, 4096
buffer_load_dwordx4 v28, s[28:31], s94 offen offset:0 nt lds
v_mfma_f32_16x16x32_bf16 v[180:183], a[148:151], a[168:171], v[180:183]
v_mfma_f32_16x16x32_bf16 v[184:187], a[148:151], a[184:187], v[184:187]
v_mfma_f32_16x16x32_bf16 v[188:191], a[148:151], a[200:203], v[188:191]
buffer_load_dwordx4 v29, s[28:31], s94 offen offset:1024 nt lds
v_mfma_f32_16x16x32_bf16 v[192:195], a[152:155], a[168:171], v[192:195]
v_mfma_f32_16x16x32_bf16 v[196:199], a[152:155], a[184:187], v[196:199]
v_mfma_f32_16x16x32_bf16 v[200:203], a[152:155], a[200:203], v[200:203]
buffer_load_dwordx4 v28, s[28:31], s94 offen offset:2048 nt lds
v_mfma_f32_16x16x32_bf16 v[204:207], a[156:159], a[168:171], v[204:207]
v_mfma_f32_16x16x32_bf16 v[208:211], a[156:159], a[184:187], v[208:211]
v_mfma_f32_16x16x32_bf16 v[212:215], a[156:159], a[200:203], v[212:215]
buffer_load_dwordx4 v29, s[28:31], s94 offen offset:3072 nt lds
s_waitcnt lgkmcnt(0)
v_mfma_f32_16x16x32_bf16 v[120:123], a[96:99], a[172:175], v[120:123]
v_mfma_f32_16x16x32_bf16 v[124:127], a[96:99], a[188:191], v[124:127]
v_mfma_f32_16x16x32_bf16 v[128:131], a[96:99], a[204:207], v[128:131]
s_add_u32 s98, s84, s97
s_and_b32 s98, s98, 3
s_and_b32 s83, s84, -4
s_or_b32 s83, s83, s98
s_lshl_b32 s83, s83, 15
s_add_u32 s83, s83, s99
s_add_u32 s84, s84, 1
s_add_u32 m0, s77, 24576
s_add_u32 s94, s83, 0
buffer_load_dwordx4 v28, s[32:35], s94 offen offset:0 nt lds
v_mfma_f32_16x16x32_bf16 v[132:135], a[100:103], a[172:175], v[132:135]
v_mfma_f32_16x16x32_bf16 v[136:139], a[100:103], a[188:191], v[136:139]
v_mfma_f32_16x16x32_bf16 v[140:143], a[100:103], a[204:207], v[140:143]
buffer_load_dwordx4 v29, s[32:35], s94 offen offset:1024 nt lds
v_mfma_f32_16x16x32_bf16 v[144:147], a[104:107], a[172:175], v[144:147]
v_mfma_f32_16x16x32_bf16 v[148:151], a[104:107], a[188:191], v[148:151]
v_mfma_f32_16x16x32_bf16 v[152:155], a[104:107], a[204:207], v[152:155]
buffer_load_dwordx4 v28, s[32:35], s94 offen offset:2048 nt lds
v_mfma_f32_16x16x32_bf16 v[156:159], a[108:111], a[172:175], v[156:159]
v_mfma_f32_16x16x32_bf16 v[160:163], a[108:111], a[188:191], v[160:163]
v_mfma_f32_16x16x32_bf16 v[164:167], a[108:111], a[204:207], v[164:167]
buffer_load_dwordx4 v29, s[32:35], s94 offen offset:3072 nt lds
v_mfma_f32_16x16x32_bf16 v[168:171], a[112:115], a[172:175], v[168:171]
v_mfma_f32_16x16x32_bf16 v[172:175], a[112:115], a[188:191], v[172:175]
v_mfma_f32_16x16x32_bf16 v[176:179], a[112:115], a[204:207], v[176:179]
s_add_u32 m0, s77, 28672
s_add_u32 s94, s83, 4096
buffer_load_dwordx4 v28, s[32:35], s94 offen offset:0 nt lds
v_mfma_f32_16x16x32_bf16 v[180:183], a[116:119], a[172:175], v[180:183]
v_mfma_f32_16x16x32_bf16 v[184:187], a[116:119], a[188:191], v[184:187]
v_mfma_f32_16x16x32_bf16 v[188:191], a[116:119], a[204:207], v[188:191]
buffer_load_dwordx4 v29, s[32:35], s94 offen offset:1024 nt lds
v_mfma_f32_16x16x32_bf16 v[192:195], a[120:123], a[172:175], v[192:195]
v_mfma_f32_16x16x32_bf16 v[196:199], a[120:123], a[188:191], v[196:199]
v_mfma_f32_16x16x32_bf16 v[200:203], a[120:123], a[204:207], v[200:203]
buffer_load_dwordx4 v28, s[32:35], s94 offen offset:2048 nt lds
v_mfma_f32_16x16x32_bf16 v[204:207], a[124:127], a[172:175], v[204:207]
v_mfma_f32_16x16x32_bf16 v[208:211], a[124:127], a[188:191], v[208:211]
v_mfma_f32_16x16x32_bf16 v[212:215], a[124:127], a[204:207], v[212:215]
buffer_load_dwordx4 v29, s[32:35], s94 offen offset:3072 nt lds
s_nop 7
s_barrier
s_add_u32 s79, s76, 1
s_and_b32 s79, s79, 3
s_lshl_b32 s79, s79, 15
v_add_u32 v42, s79, v220
s_add_u32 s79, s76, 2
s_and_b32 s79, s79, 3
s_lshl_b32 s79, s79, 15
v_add_u32 v43, s79, v220
s_add_u32 s79, s76, 3
s_and_b32 s79, s79, 3
s_lshl_b32 s79, s79, 13
s_add_u32 s79, s79, 131072
v_add_u32 v44, s79, v220
ds_write_b128 v42, v[144:147] offset:0
ds_write_b128 v42, v[148:151] offset:1024
ds_write_b128 v42, v[152:155] offset:2048
ds_write_b128 v42, v[156:159] offset:3072
ds_write_b128 v42, v[160:163] offset:4096
ds_write_b128 v42, v[164:167] offset:5120
ds_write_b128 v43, v[168:171] offset:8192
ds_write_b128 v43, v[172:175] offset:9216
ds_write_b128 v43, v[176:179] offset:10240
ds_write_b128 v43, v[180:183] offset:11264
ds_write_b128 v43, v[184:187] offset:12288
ds_write_b128 v43, v[188:191] offset:13312
ds_write_b128 v44, v[192:195] offset:0
ds_write_b128 v44, v[196:199] offset:1024
ds_write_b128 v44, v[200:203] offset:2048
ds_write_b128 v44, v[204:207] offset:3072
ds_write_b128 v44, v[208:211] offset:4096
ds_write_b128 v44, v[212:215] offset:5120
v_add_u32 v38, s77, v220
s_lshl_b32 s79, s76, 13
s_add_u32 s79, s79, 131072
v_add_u32 v39, s79, v220
s_waitcnt lgkmcnt(0)
s_barrier
ds_read_b128 v[48:51], v38 offset:0
ds_read_b128 v[52:55], v38 offset:1024
ds_read_b128 v[56:59], v38 offset:2048
ds_read_b128 v[60:63], v38 offset:3072
ds_read_b128 v[64:67], v38 offset:4096
ds_read_b128 v[68:71], v38 offset:5120
ds_read_b128 v[72:75], v38 offset:8192
ds_read_b128 v[76:79], v38 offset:9216
ds_read_b128 v[80:83], v38 offset:10240
ds_read_b128 v[84:87], v38 offset:11264
ds_read_b128 v[88:91], v38 offset:12288
ds_read_b128 v[92:95], v38 offset:13312
ds_read_b128 v[96:99], v39 offset:0
ds_read_b128 v[100:103], v39 offset:1024
ds_read_b128 v[104:107], v39 offset:2048
ds_read_b128 v[108:111], v39 offset:3072
ds_read_b128 v[112:115], v39 offset:4096
ds_read_b128 v[116:119], v39 offset:5120
v_lshrrev_b32 v40, 5, v0
v_lshlrev_b32 v40, 8, v40
v_and_b32 v41, 15, v0
v_lshl_add_u32 v40, v41, 4, v40
v_bfe_u32 v41, v0, 4, 1
v_lshl_add_u32 v40, v41, 3, v40
v_add_u32 v40, s79, v40
s_waitcnt lgkmcnt(12)
v_add_f32 v120, v120, v48
v_add_f32 v121, v121, v49
v_add_f32 v122, v122, v50
v_add_f32 v123, v123, v51
v_add_f32 v124, v124, v52
v_add_f32 v125, v125, v53
v_add_f32 v126, v126, v54
v_add_f32 v127, v127, v55
v_add_f32 v128, v128, v56
v_add_f32 v129, v129, v57
v_add_f32 v130, v130, v58
v_add_f32 v131, v131, v59
v_add_f32 v132, v132, v60
v_add_f32 v133, v133, v61
v_add_f32 v134, v134, v62
v_add_f32 v135, v135, v63
v_add_f32 v136, v136, v64
v_add_f32 v137, v137, v65
v_add_f32 v138, v138, v66
v_add_f32 v139, v139, v67
v_add_f32 v140, v140, v68
v_add_f32 v141, v141, v69
v_add_f32 v142, v142, v70
v_add_f32 v143, v143, v71
s_waitcnt lgkmcnt(6)
v_add_f32 v120, v120, v72
v_add_f32 v121, v121, v73
v_add_f32 v122, v122, v74
v_add_f32 v123, v123, v75
v_add_f32 v124, v124, v76
v_add_f32 v125, v125, v77
v_add_f32 v126, v126, v78
v_add_f32 v127, v127, v79
v_add_f32 v128, v128, v80
v_add_f32 v129, v129, v81
v_add_f32 v130, v130, v82
v_add_f32 v131, v131, v83
v_add_f32 v132, v132, v84
v_add_f32 v133, v133, v85
v_add_f32 v134, v134, v86
v_add_f32 v135, v135, v87
v_add_f32 v136, v136, v88
v_add_f32 v137, v137, v89
v_add_f32 v138, v138, v90
v_add_f32 v139, v139, v91
v_add_f32 v140, v140, v92
v_add_f32 v141, v141, v93
v_add_f32 v142, v142, v94
v_add_f32 v143, v143, v95
s_waitcnt lgkmcnt(0)
v_add_f32 v120, v120, v96
v_add_f32 v121, v121, v97
v_add_f32 v122, v122, v98
v_add_f32 v123, v123, v99
v_add_f32 v124, v124, v100
v_add_f32 v125, v125, v101
v_add_f32 v126, v126, v102
v_add_f32 v127, v127, v103
v_add_f32 v128, v128, v104
v_add_f32 v129, v129, v105
v_add_f32 v130, v130, v106
v_add_f32 v131, v131, v107
v_add_f32 v132, v132, v108
v_add_f32 v133, v133, v109
v_add_f32 v134, v134, v110
v_add_f32 v135, v135, v111
v_add_f32 v136, v136, v112
v_add_f32 v137, v137, v113
v_add_f32 v138, v138, v114
v_add_f32 v139, v139, v115
v_add_f32 v140, v140, v116
v_add_f32 v141, v141, v117
v_add_f32 v142, v142, v118
v_add_f32 v143, v143, v119
v_cvt_pk_bf16_f32 v48, v120, v121
v_cvt_pk_bf16_f32 v49, v122, v123
v_cvt_pk_bf16_f32 v50, v124, v125
v_cvt_pk_bf16_f32 v51, v126, v127
v_cvt_pk_bf16_f32 v52, v128, v129
v_cvt_pk_bf16_f32 v53, v130, v131
v_cvt_pk_bf16_f32 v54, v132, v133
v_cvt_pk_bf16_f32 v55, v134, v135
v_cvt_pk_bf16_f32 v56, v136, v137
v_cvt_pk_bf16_f32 v57, v138, v139
v_cvt_pk_bf16_f32 v58, v140, v141
v_cvt_pk_bf16_f32 v59, v142, v143
ds_write_b64 v40, v[48:49] offset:0
ds_write_b64 v40, v[50:51] offset:1024
ds_write_b64 v40, v[52:53] offset:2048
ds_write_b64 v40, v[54:55] offset:512
ds_write_b64 v40, v[56:57] offset:1536
ds_write_b64 v40, v[58:59] offset:2560
s_add_u32 s98, s96, s97
s_and_b32 s98, s98, 3
s_and_b32 s78, s96, -4
s_or_b32 s78, s78, s98
s_lshl_b32 s78, s78, 15
s_add_u32 s78, s78, s99
s_add_u32 s96, s96, 1
s_add_u32 m0, s77, 0
s_add_u32 s94, s78, 0
buffer_load_dwordx4 v28, s[28:31], s94 offen offset:0 nt lds
buffer_load_dwordx4 v29, s[28:31], s94 offen offset:1024 nt lds
buffer_load_dwordx4 v28, s[28:31], s94 offen offset:2048 nt lds
buffer_load_dwordx4 v29, s[28:31], s94 offen offset:3072 nt lds
v_add_u32 v41, 131072, v220
s_waitcnt lgkmcnt(0)
s_barrier
ds_read_b128 a[48:51], v41 offset:0
ds_read_b128 a[64:67], v41 offset:1024
ds_read_b128 a[80:83], v41 offset:2048
ds_read_b128 a[52:55], v41 offset:8192
ds_read_b128 a[68:71], v41 offset:9216
ds_read_b128 a[84:87], v41 offset:10240
ds_read_b128 a[56:59], v41 offset:16384
ds_read_b128 a[72:75], v41 offset:17408
ds_read_b128 a[88:91], v41 offset:18432
ds_read_b128 a[60:63], v41 offset:24576
ds_read_b128 a[76:79], v41 offset:25600
ds_read_b128 a[92:95], v41 offset:26624
s_add_u32 m0, s77, 4096
s_add_u32 s94, s78, 4096
buffer_load_dwordx4 v28, s[28:31], s94 offen offset:0 nt lds
buffer_load_dwordx4 v29, s[28:31], s94 offen offset:1024 nt lds
buffer_load_dwordx4 v28, s[28:31], s94 offen offset:2048 nt lds
buffer_load_dwordx4 v29, s[28:31], s94 offen offset:3072 nt lds
s_waitcnt lgkmcnt(0)
s_add_u32 s98, s84, s97
s_and_b32 s98, s98, 3
s_and_b32 s83, s84, -4
s_or_b32 s83, s83, s98
s_lshl_b32 s83, s83, 15
s_add_u32 s83, s83, s99
s_add_u32 s84, s84, 1
s_add_u32 m0, s77, 8192
s_add_u32 s94, s83, 0
buffer_load_dwordx4 v28, s[32:35], s94 offen offset:0 nt lds
buffer_load_dwordx4 v29, s[32:35], s94 offen offset:1024 nt lds
buffer_load_dwordx4 v28, s[32:35], s94 offen offset:2048 nt lds
buffer_load_dwordx4 v29, s[32:35], s94 offen offset:3072 nt lds
s_add_u32 m0, s77, 12288
s_add_u32 s94, s83, 4096
buffer_load_dwordx4 v28, s[32:35], s94 offen offset:0 nt lds
buffer_load_dwordx4 v29, s[32:35], s94 offen offset:1024 nt lds
buffer_load_dwordx4 v28, s[32:35], s94 offen offset:2048 nt lds
buffer_load_dwordx4 v29, s[32:35], s94 offen offset:3072 nt lds
s_waitcnt vmcnt(24)
ds_read_b128 a[96:99], v24 offset:16384
ds_read_b128 a[100:103], v24 offset:20480
ds_read_b128 a[104:107], v25 offset:16384
ds_read_b128 a[108:111], v25 offset:20480
ds_read_b128 a[112:115], v26 offset:16384
ds_read_b128 a[116:119], v26 offset:20480
ds_read_b128 a[120:123], v27 offset:16384
ds_read_b128 a[124:127], v27 offset:20480
v_mov_b32 v120, 0
v_mov_b32 v121, 0
v_mov_b32 v122, 0
v_mov_b32 v123, 0
v_mov_b32 v124, 0
v_mov_b32 v125, 0
v_mov_b32 v126, 0
v_mov_b32 v127, 0
v_mov_b32 v128, 0
v_mov_b32 v129, 0
v_mov_b32 v130, 0
v_mov_b32 v131, 0
v_mov_b32 v132, 0
v_mov_b32 v133, 0
v_mov_b32 v134, 0
v_mov_b32 v135, 0
v_mov_b32 v136, 0
v_mov_b32 v137, 0
v_mov_b32 v138, 0
v_mov_b32 v139, 0
v_mov_b32 v140, 0
v_mov_b32 v141, 0
v_mov_b32 v142, 0
v_mov_b32 v143, 0
v_mov_b32 v144, 0
v_mov_b32 v145, 0
v_mov_b32 v146, 0
v_mov_b32 v147, 0
v_mov_b32 v148, 0
v_mov_b32 v149, 0
v_mov_b32 v150, 0
v_mov_b32 v151, 0
v_mov_b32 v152, 0
v_mov_b32 v153, 0
v_mov_b32 v154, 0
v_mov_b32 v155, 0
v_mov_b32 v156, 0
v_mov_b32 v157, 0
v_mov_b32 v158, 0
v_mov_b32 v159, 0
v_mov_b32 v160, 0
v_mov_b32 v161, 0
v_mov_b32 v162, 0
v_mov_b32 v163, 0
v_mov_b32 v164, 0
v_mov_b32 v165, 0
v_mov_b32 v166, 0
v_mov_b32 v167, 0
v_mov_b32 v168, 0
v_mov_b32 v169, 0
v_mov_b32 v170, 0
v_mov_b32 v171, 0
v_mov_b32 v172, 0
v_mov_b32 v173, 0
v_mov_b32 v174, 0
v_mov_b32 v175, 0
v_mov_b32 v176, 0
v_mov_b32 v177, 0
v_mov_b32 v178, 0
v_mov_b32 v179, 0
v_mov_b32 v180, 0
v_mov_b32 v181, 0
v_mov_b32 v182, 0
v_mov_b32 v183, 0
v_mov_b32 v184, 0
v_mov_b32 v185, 0
v_mov_b32 v186, 0
v_mov_b32 v187, 0
v_mov_b32 v188, 0
v_mov_b32 v189, 0
v_mov_b32 v190, 0
v_mov_b32 v191, 0
v_mov_b32 v192, 0
v_mov_b32 v193, 0
v_mov_b32 v194, 0
v_mov_b32 v195, 0
v_mov_b32 v196, 0
v_mov_b32 v197, 0
v_mov_b32 v198, 0
v_mov_b32 v199, 0
v_mov_b32 v200, 0
v_mov_b32 v201, 0
v_mov_b32 v202, 0
v_mov_b32 v203, 0
v_mov_b32 v204, 0
v_mov_b32 v205, 0
v_mov_b32 v206, 0
v_mov_b32 v207, 0
v_mov_b32 v208, 0
v_mov_b32 v209, 0
v_mov_b32 v210, 0
v_mov_b32 v211, 0
v_mov_b32 v212, 0
v_mov_b32 v213, 0
v_mov_b32 v214, 0
v_mov_b32 v215, 0
v_accvgpr_write_b32 a160, 0
v_accvgpr_write_b32 a161, 0
v_accvgpr_write_b32 a162, 0
v_accvgpr_write_b32 a163, 0
v_accvgpr_write_b32 a164, 0
v_accvgpr_write_b32 a165, 0
v_accvgpr_write_b32 a166, 0
v_accvgpr_write_b32 a167, 0
v_accvgpr_write_b32 a168, 0
v_accvgpr_write_b32 a169, 0
v_accvgpr_write_b32 a170, 0
v_accvgpr_write_b32 a171, 0
v_accvgpr_write_b32 a172, 0
v_accvgpr_write_b32 a173, 0
v_accvgpr_write_b32 a174, 0
v_accvgpr_write_b32 a175, 0
v_accvgpr_write_b32 a176, 0
v_accvgpr_write_b32 a177, 0
v_accvgpr_write_b32 a178, 0
v_accvgpr_write_b32 a179, 0
v_accvgpr_write_b32 a180, 0
v_accvgpr_write_b32 a181, 0
v_accvgpr_write_b32 a182, 0
v_accvgpr_write_b32 a183, 0
v_accvgpr_write_b32 a184, 0
v_accvgpr_write_b32 a185, 0
v_accvgpr_write_b32 a186, 0
v_accvgpr_write_b32 a187, 0
v_accvgpr_write_b32 a188, 0
v_accvgpr_write_b32 a189, 0
v_accvgpr_write_b32 a190, 0
v_accvgpr_write_b32 a191, 0
v_accvgpr_write_b32 a192, 0
v_accvgpr_write_b32 a193, 0
v_accvgpr_write_b32 a194, 0
v_accvgpr_write_b32 a195, 0
v_accvgpr_write_b32 a196, 0
v_accvgpr_write_b32 a197, 0
v_accvgpr_write_b32 a198, 0
v_accvgpr_write_b32 a199, 0
v_accvgpr_write_b32 a200, 0
v_accvgpr_write_b32 a201, 0
v_accvgpr_write_b32 a202, 0
v_accvgpr_write_b32 a203, 0
v_accvgpr_write_b32 a204, 0
v_accvgpr_write_b32 a205, 0
v_accvgpr_write_b32 a206, 0
v_accvgpr_write_b32 a207, 0
v_accvgpr_write_b32 a208, 0
v_accvgpr_write_b32 a209, 0
v_accvgpr_write_b32 a210, 0
v_accvgpr_write_b32 a211, 0
v_accvgpr_write_b32 a212, 0
v_accvgpr_write_b32 a213, 0
v_accvgpr_write_b32 a214, 0
v_accvgpr_write_b32 a215, 0
v_accvgpr_write_b32 a216, 0
v_accvgpr_write_b32 a217, 0
v_accvgpr_write_b32 a218, 0
v_accvgpr_write_b32 a219, 0
v_accvgpr_write_b32 a220, 0
v_accvgpr_write_b32 a221, 0
v_accvgpr_write_b32 a222, 0
v_accvgpr_write_b32 a223, 0
v_accvgpr_write_b32 a224, 0
v_accvgpr_write_b32 a225, 0
v_accvgpr_write_b32 a226, 0
v_accvgpr_write_b32 a227, 0
v_accvgpr_write_b32 a228, 0
v_accvgpr_write_b32 a229, 0
v_accvgpr_write_b32 a230, 0
v_accvgpr_write_b32 a231, 0
v_accvgpr_write_b32 a232, 0
v_accvgpr_write_b32 a233, 0
v_accvgpr_write_b32 a234, 0
v_accvgpr_write_b32 a235, 0
v_accvgpr_write_b32 a236, 0
v_accvgpr_write_b32 a237, 0
v_accvgpr_write_b32 a238, 0
v_accvgpr_write_b32 a239, 0
v_accvgpr_write_b32 a240, 0
v_accvgpr_write_b32 a241, 0
v_accvgpr_write_b32 a242, 0
v_accvgpr_write_b32 a243, 0
v_accvgpr_write_b32 a244, 0
v_accvgpr_write_b32 a245, 0
v_accvgpr_write_b32 a246, 0
v_accvgpr_write_b32 a247, 0
v_accvgpr_write_b32 a248, 0
v_accvgpr_write_b32 a249, 0
v_accvgpr_write_b32 a250, 0
v_accvgpr_write_b32 a251, 0
v_accvgpr_write_b32 a252, 0
v_accvgpr_write_b32 a253, 0
v_accvgpr_write_b32 a254, 0
v_accvgpr_write_b32 a255, 0
v_mov_b32 v30, 0
v_mov_b32 v31, 0
v_mov_b32 v224, 0
v_mov_b32 v225, 0
v_mov_b32 v32, 0
v_mov_b32 v33, 0
v_mov_b32 v226, 0
v_mov_b32 v227, 0
v_mov_b32 v34, 0
v_mov_b32 v35, 0
v_mov_b32 v228, 0
v_mov_b32 v229, 0
s_mov_b32 s87, 0xff800000
s_mov_b32 s88, 0xff800000
s_mov_b32 s11, 0xff800000
s_mov_b32 s48, 0xff800000
s_waitcnt lgkmcnt(0)
v_mfma_f32_16x16x32_bf16 v[48:51], a[96:99], a[0:3], 0
v_mfma_f32_16x16x32_bf16 v[52:55], a[96:99], a[16:19], 0
v_mfma_f32_16x16x32_bf16 v[56:59], a[96:99], a[32:35], 0
v_mfma_f32_16x16x32_bf16 v[60:63], a[100:103], a[0:3], 0
s_add_u32 s98, s96, s97
s_and_b32 s98, s98, 3
s_and_b32 s78, s96, -4
s_or_b32 s78, s78, s98
s_lshl_b32 s78, s78, 15
s_add_u32 s78, s78, s99
s_add_u32 s96, s96, 1
s_add_u32 m0, s77, 16384
s_add_u32 s94, s78, 0
buffer_load_dwordx4 v28, s[28:31], s94 offen offset:0 nt lds
v_mfma_f32_16x16x32_bf16 v[64:67], a[100:103], a[16:19], 0
v_mfma_f32_16x16x32_bf16 v[68:71], a[100:103], a[32:35], 0
v_mfma_f32_16x16x32_bf16 v[48:51], a[104:107], a[4:7], v[48:51]
v_mfma_f32_16x16x32_bf16 v[52:55], a[104:107], a[20:23], v[52:55]
v_mfma_f32_16x16x32_bf16 v[56:59], a[104:107], a[36:39], v[56:59]
v_mfma_f32_16x16x32_bf16 v[60:63], a[108:111], a[4:7], v[60:63]
buffer_load_dwordx4 v29, s[28:31], s94 offen offset:1024 nt lds
v_mfma_f32_16x16x32_bf16 v[64:67], a[108:111], a[20:23], v[64:67]
v_mfma_f32_16x16x32_bf16 v[68:71], a[108:111], a[36:39], v[68:71]
v_mfma_f32_16x16x32_bf16 v[48:51], a[112:115], a[8:11], v[48:51]
v_mfma_f32_16x16x32_bf16 v[52:55], a[112:115], a[24:27], v[52:55]
v_mfma_f32_16x16x32_bf16 v[56:59], a[112:115], a[40:43], v[56:59]
v_mfma_f32_16x16x32_bf16 v[60:63], a[116:119], a[8:11], v[60:63]
buffer_load_dwordx4 v28, s[28:31], s94 offen offset:2048 nt lds
v_mfma_f32_16x16x32_bf16 v[64:67], a[116:119], a[24:27], v[64:67]
v_mfma_f32_16x16x32_bf16 v[68:71], a[116:119], a[40:43], v[68:71]
v_mfma_f32_16x16x32_bf16 v[48:51], a[120:123], a[12:15], v[48:51]
v_mfma_f32_16x16x32_bf16 v[52:55], a[120:123], a[28:31], v[52:55]
v_mfma_f32_16x16x32_bf16 v[56:59], a[120:123], a[44:47], v[56:59]
v_mfma_f32_16x16x32_bf16 v[60:63], a[124:127], a[12:15], v[60:63]
buffer_load_dwordx4 v29, s[28:31], s94 offen offset:3072 nt lds
v_mfma_f32_16x16x32_bf16 v[64:67], a[124:127], a[28:31], v[64:67]
v_mfma_f32_16x16x32_bf16 v[68:71], a[124:127], a[44:47], v[68:71]
s_nop 7
v_fma_f32 v48, v48, s89, -v30
v_fma_f32 v49, v49, s89, -v30
v_fma_f32 v50, v50, s89, -v30
v_fma_f32 v51, v51, s89, -v30
v_fma_f32 v52, v52, s89, -v32
v_fma_f32 v53, v53, s89, -v32
v_fma_f32 v54, v54, s89, -v32
v_fma_f32 v55, v55, s89, -v32
v_fma_f32 v56, v56, s89, -v34
v_fma_f32 v57, v57, s89, -v34
v_fma_f32 v58, v58, s89, -v34
v_fma_f32 v59, v59, s89, -v34
v_fma_f32 v60, v60, s89, -v30
v_fma_f32 v61, v61, s89, -v30
v_fma_f32 v62, v62, s89, -v30
v_fma_f32 v63, v63, s89, -v30
v_fma_f32 v64, v64, s89, -v32
v_fma_f32 v65, v65, s89, -v32
v_fma_f32 v66, v66, s89, -v32
v_fma_f32 v67, v67, s89, -v32
v_fma_f32 v68, v68, s89, -v34
v_fma_f32 v69, v69, s89, -v34
v_fma_f32 v70, v70, s89, -v34
v_fma_f32 v71, v71, s89, -v34
v_max3_f32 v36, v48, v49, v50
v_max3_f32 v37, v52, v53, v54
v_max3_f32 v38, v56, v57, v58
v_max3_f32 v36, v36, v51, v60
v_max3_f32 v37, v37, v55, v64
v_max3_f32 v38, v38, v59, v68
v_max3_f32 v36, v36, v61, v62
v_max3_f32 v37, v37, v65, v66
v_max3_f32 v38, v38, v69, v70
v_max_f32 v36, v36, v63
v_max_f32 v37, v37, v67
v_max_f32 v38, v38, v71
v_max3_f32 v39, v36, v37, v38
v_cmp_lt_f32 vcc, s87, v39
s_cbranch_vccz L_fast0
s_call_b64 s[90:91], L_rescale0
L_fast0:
s_mov_b32 s86, 6
L_loopJ:
s_cmp_eq_u32 s86, 5
s_cbranch_scc0 L_nopf2
s_mov_b32 s79, s99
s_mov_b32 s80, 3
L_pf2:
s_add_u32 s81, s79, 4096
buffer_load_dwordx4 v[4:7], v220, s[52:55], s79 offen offset:0
buffer_load_dwordx4 v[4:7], v220, s[52:55], s79 offen offset:1024
buffer_load_dwordx4 v[4:7], v220, s[52:55], s79 offen offset:2048
buffer_load_dwordx4 v[4:7], v220, s[52:55], s79 offen offset:3072
buffer_load_dwordx4 v[4:7], v220, s[52:55], s81 offen offset:0
buffer_load_dwordx4 v[4:7], v220, s[52:55], s81 offen offset:1024
buffer_load_dwordx4 v[4:7], v220, s[52:55], s81 offen offset:2048
buffer_load_dwordx4 v[4:7], v220, s[52:55], s81 offen offset:3072
buffer_load_dwordx4 v[4:7], v220, s[56:59], s79 offen offset:0
buffer_load_dwordx4 v[4:7], v220, s[56:59], s79 offen offset:1024
buffer_load_dwordx4 v[4:7], v220, s[56:59], s79 offen offset:2048
buffer_load_dwordx4 v[4:7], v220, s[56:59], s79 offen offset:3072
buffer_load_dwordx4 v[4:7], v220, s[56:59], s81 offen offset:0
buffer_load_dwordx4 v[4:7], v220, s[56:59], s81 offen offset:1024
buffer_load_dwordx4 v[4:7], v220, s[56:59], s81 offen offset:2048
buffer_load_dwordx4 v[4:7], v220, s[56:59], s81 offen offset:3072
s_waitcnt vmcnt(16)
s_add_u32 s79, s79, 32768
s_sub_u32 s80, s80, 1
s_cmp_lg_u32 s80, 0
s_cbranch_scc1 L_pf2
L_nopf2:
v_mfma_f32_16x16x32_bf16 v[72:75], a[96:99], a[48:51], 0
v_exp_f32 v48, v48
v_mfma_f32_16x16x32_bf16 v[76:79], a[96:99], a[64:67], 0
v_exp_f32 v49, v49
v_exp_f32 v50, v50
v_mfma_f32_16x16x32_bf16 v[80:83], a[96:99], a[80:83], 0
v_exp_f32 v51, v51
v_mfma_f32_16x16x32_bf16 v[84:87], a[100:103], a[48:51], 0
v_exp_f32 v60, v60
s_add_u32 m0, s77, 20480
s_add_u32 s94, s78, 4096
buffer_load_dwordx4 v28, s[28:31], s94 offen offset:0 nt lds
v_mfma_f32_16x16x32_bf16 v[88:91], a[100:103], a[64:67], 0
v_exp_f32 v61, v61
v_mfma_f32_16x16x32_bf16 v[92:95], a[100:103], a[80:83], 0
v_exp_f32 v62, v62
v_exp_f32 v63, v63
v_mfma_f32_16x16x32_bf16 v[72:75], a[104:107], a[52:55], v[72:75]
v_exp_f32 v52, v52
v_mfma_f32_16x16x32_bf16 v[76:79], a[104:107], a[68:71], v[76:79]
v_exp_f32 v53, v53
v_mfma_f32_16x16x32_bf16 v[80:83], a[104:107], a[84:87], v[80:83]
v_exp_f32 v54, v54
v_mfma_f32_16x16x32_bf16 v[84:87], a[108:111], a[52:55], v[84:87]
v_exp_f32 v55, v55
v_exp_f32 v64, v64
buffer_load_dwordx4 v29, s[28:31], s94 offen offset:1024 nt lds
v_mfma_f32_16x16x32_bf16 v[88:91], a[108:111], a[68:71], v[88:91]
v_exp_f32 v65, v65
v_mfma_f32_16x16x32_bf16 v[92:95], a[108:111], a[84:87], v[92:95]
v_exp_f32 v66, v66
s_waitcnt vmcnt(22)
ds_read_b64_tr_b16 a[128:129], v16 offset:24576
ds_read_b64_tr_b16 a[130:131], v16 offset:28672
ds_read_b64_tr_b16 a[132:133], v17 offset:24576
ds_read_b64_tr_b16 a[134:135], v17 offset:28672
ds_read_b64_tr_b16 a[136:137], v18 offset:24576
ds_read_b64_tr_b16 a[138:139], v18 offset:28672
ds_read_b64_tr_b16 a[140:141], v19 offset:24576
ds_read_b64_tr_b16 a[142:143], v19 offset:28672
ds_read_b64_tr_b16 a[144:145], v20 offset:24576
ds_read_b64_tr_b16 a[146:147], v20 offset:28672
ds_read_b64_tr_b16 a[148:149], v21 offset:24576
ds_read_b64_tr_b16 a[150:151], v21 offset:28672
ds_read_b64_tr_b16 a[152:153], v22 offset:24576
ds_read_b64_tr_b16 a[154:155], v22 offset:28672
ds_read_b64_tr_b16 a[156:157], v23 offset:24576
ds_read_b64_tr_b16 a[158:159], v23 offset:28672
v_mfma_f32_16x16x32_bf16 v[72:75], a[112:115], a[56:59], v[72:75]
v_exp_f32 v67, v67
v_cvt_pk_bf16_f32 v96, v48, v49
v_mfma_f32_16x16x32_bf16 v[76:79], a[112:115], a[72:75], v[76:79]
v_cvt_pk_bf16_f32 v97, v50, v51
v_cvt_pk_bf16_f32 v98, v60, v61
v_mfma_f32_16x16x32_bf16 v[80:83], a[112:115], a[88:91], v[80:83]
v_cvt_pk_bf16_f32 v99, v62, v63
v_exp_f32 v56, v56
v_mfma_f32_16x16x32_bf16 v[84:87], a[116:119], a[56:59], v[84:87]
v_exp_f32 v57, v57
buffer_load_dwordx4 v28, s[28:31], s94 offen offset:2048 nt lds
v_mfma_f32_16x16x32_bf16 v[88:91], a[116:119], a[72:75], v[88:91]
v_exp_f32 v58, v58
v_mfma_f32_16x16x32_bf16 v[92:95], a[116:119], a[88:91], v[92:95]
v_exp_f32 v59, v59
v_exp_f32 v68, v68
v_mfma_f32_16x16x32_bf16 v[72:75], a[120:123], a[60:63], v[72:75]
v_exp_f32 v69, v69
v_mfma_f32_16x16x32_bf16 v[76:79], a[120:123], a[76:79], v[76:79]
v_exp_f32 v70, v70
v_mfma_f32_16x16x32_bf16 v[80:83], a[120:123], a[92:95], v[80:83]
v_exp_f32 v71, v71
v_cvt_pk_bf16_f32 v100, v52, v53
v_mfma_f32_16x16x32_bf16 v[84:87], a[124:127], a[60:63], v[84:87]
v_cvt_pk_bf16_f32 v101, v54, v55
v_cvt_pk_bf16_f32 v102, v64, v65
buffer_load_dwordx4 v29, s[28:31], s94 offen offset:3072 nt lds
v_mfma_f32_16x16x32_bf16 v[88:91], a[124:127], a[76:79], v[88:91]
v_cvt_pk_bf16_f32 v103, v66, v67
v_cvt_pk_bf16_f32 v104, v56, v57
v_cvt_pk_bf16_f32 v105, v58, v59
v_mfma_f32_16x16x32_bf16 v[92:95], a[124:127], a[92:95], v[92:95]
v_cvt_pk_bf16_f32 v106, v68, v69
v_cvt_pk_bf16_f32 v107, v70, v71
s_waitcnt lgkmcnt(0)
v_mfma_f32_16x16x32_bf16 v[120:123], a[128:131], v[96:99], v[120:123]
v_add_f32 v31, v31, v48
v_add_f32 v33, v33, v52
v_add_f32 v35, v35, v56
v_mfma_f32_16x16x32_bf16 v[124:127], a[128:131], v[100:103], v[124:127]
v_add_f32 v31, v31, v49
v_add_f32 v33, v33, v53
v_mfma_f32_16x16x32_bf16 v[128:131], a[128:131], v[104:107], v[128:131]
v_add_f32 v35, v35, v57
v_add_f32 v31, v31, v50
v_add_f32 v33, v33, v54
v_mfma_f32_16x16x32_bf16 v[132:135], a[132:135], v[96:99], v[132:135]
v_add_f32 v35, v35, v58
v_add_f32 v31, v31, v51
s_add_u32 s98, s84, s97
s_and_b32 s98, s98, 3
s_and_b32 s83, s84, -4
s_or_b32 s83, s83, s98
s_lshl_b32 s83, s83, 15
s_add_u32 s83, s83, s99
s_add_u32 s84, s84, 1
s_add_u32 m0, s77, 24576
s_add_u32 s94, s83, 0
buffer_load_dwordx4 v28, s[32:35], s94 offen offset:0 nt lds
v_mfma_f32_16x16x32_bf16 v[136:139], a[132:135], v[100:103], v[136:139]
v_add_f32 v33, v33, v55
v_add_f32 v35, v35, v59
v_add_f32 v31, v31, v60
v_mfma_f32_16x16x32_bf16 v[140:143], a[132:135], v[104:107], v[140:143]
v_add_f32 v33, v33, v64
v_add_f32 v35, v35, v68
v_mfma_f32_16x16x32_bf16 v[144:147], a[136:139], v[96:99], v[144:147]
v_add_f32 v31, v31, v61
v_add_f32 v33, v33, v65
v_add_f32 v35, v35, v69
v_mfma_f32_16x16x32_bf16 v[148:151], a[136:139], v[100:103], v[148:151]
v_add_f32 v31, v31, v62
v_add_f32 v33, v33, v66
v_mfma_f32_16x16x32_bf16 v[152:155], a[136:139], v[104:107], v[152:155]
v_add_f32 v35, v35, v70
v_add_f32 v31, v31, v63
v_add_f32 v33, v33, v67
v_mfma_f32_16x16x32_bf16 v[156:159], a[140:143], v[96:99], v[156:159]
v_add_f32 v35, v35, v71
v_fma_f32 v72, v72, s89, -v224
buffer_load_dwordx4 v29, s[32:35], s94 offen offset:1024 nt lds
v_mfma_f32_16x16x32_bf16 v[160:163], a[140:143], v[100:103], v[160:163]
v_fma_f32 v73, v73, s89, -v224
v_fma_f32 v74, v74, s89, -v224
v_fma_f32 v75, v75, s89, -v224
v_mfma_f32_16x16x32_bf16 v[164:167], a[140:143], v[104:107], v[164:167]
v_fma_f32 v76, v76, s89, -v226
v_fma_f32 v77, v77, s89, -v226
v_fma_f32 v78, v78, s89, -v226
s_waitcnt vmcnt(18)
ds_read_b128 a[96:99], v24 offset:0
ds_read_b128 a[100:103], v24 offset:4096
ds_read_b128 a[104:107], v25 offset:0
ds_read_b128 a[108:111], v25 offset:4096
ds_read_b128 a[112:115], v26 offset:0
ds_read_b128 a[116:119], v26 offset:4096
ds_read_b128 a[120:123], v27 offset:0
ds_read_b128 a[124:127], v27 offset:4096
v_mfma_f32_16x16x32_bf16 v[168:171], a[144:147], v[96:99], v[168:171]
v_fma_f32 v79, v79, s89, -v226
v_fma_f32 v80, v80, s89, -v228
v_mfma_f32_16x16x32_bf16 v[172:175], a[144:147], v[100:103], v[172:175]
v_fma_f32 v81, v81, s89, -v228
v_fma_f32 v82, v82, s89, -v228
v_fma_f32 v83, v83, s89, -v228
v_mfma_f32_16x16x32_bf16 v[176:179], a[144:147], v[104:107], v[176:179]
v_fma_f32 v84, v84, s89, -v224
v_fma_f32 v85, v85, s89, -v224
v_mfma_f32_16x16x32_bf16 v[180:183], a[148:151], v[96:99], v[180:183]
v_fma_f32 v86, v86, s89, -v224
v_fma_f32 v87, v87, s89, -v224
v_fma_f32 v88, v88, s89, -v226
buffer_load_dwordx4 v28, s[32:35], s94 offen offset:2048 nt lds
v_mfma_f32_16x16x32_bf16 v[184:187], a[148:151], v[100:103], v[184:187]
v_fma_f32 v89, v89, s89, -v226
v_fma_f32 v90, v90, s89, -v226
v_mfma_f32_16x16x32_bf16 v[188:191], a[148:151], v[104:107], v[188:191]
v_fma_f32 v91, v91, s89, -v226
v_fma_f32 v92, v92, s89, -v228
v_fma_f32 v93, v93, s89, -v228
v_mfma_f32_16x16x32_bf16 v[192:195], a[152:155], v[96:99], v[192:195]
v_fma_f32 v94, v94, s89, -v228
v_fma_f32 v95, v95, s89, -v228
v_mfma_f32_16x16x32_bf16 v[196:199], a[152:155], v[100:103], v[196:199]
v_max3_f32 v36, v72, v73, v74
v_max3_f32 v37, v76, v77, v78
v_max3_f32 v38, v80, v81, v82
v_mfma_f32_16x16x32_bf16 v[200:203], a[152:155], v[104:107], v[200:203]
v_max3_f32 v36, v36, v75, v84
v_max3_f32 v37, v37, v79, v88
v_mfma_f32_16x16x32_bf16 v[204:207], a[156:159], v[96:99], v[204:207]
v_max3_f32 v38, v38, v83, v92
v_max3_f32 v36, v36, v85, v86
v_max3_f32 v37, v37, v89, v90
buffer_load_dwordx4 v29, s[32:35], s94 offen offset:3072 nt lds
v_mfma_f32_16x16x32_bf16 v[208:211], a[156:159], v[100:103], v[208:211]
v_max3_f32 v38, v38, v93, v94
v_max_f32 v36, v36, v87
v_mfma_f32_16x16x32_bf16 v[212:215], a[156:159], v[104:107], v[212:215]
v_max_f32 v37, v37, v91
v_max_f32 v38, v38, v95
v_max3_f32 v39, v36, v37, v38
v_cmp_lt_f32 vcc, s11, v39
s_cbranch_vccz L_fast1
s_call_b64 s[90:91], L_rescaleJ1
L_fast1:
s_waitcnt lgkmcnt(0)
v_mfma_f32_16x16x32_bf16 v[48:51], a[96:99], a[0:3], 0
v_exp_f32 v72, v72
v_mfma_f32_16x16x32_bf16 v[52:55], a[96:99], a[16:19], 0
v_exp_f32 v73, v73
v_exp_f32 v74, v74
v_mfma_f32_16x16x32_bf16 v[56:59], a[96:99], a[32:35], 0
v_exp_f32 v75, v75
v_mfma_f32_16x16x32_bf16 v[60:63], a[100:103], a[0:3], 0
v_exp_f32 v84, v84
s_add_u32 m0, s77, 28672
s_add_u32 s94, s83, 4096
buffer_load_dwordx4 v28, s[32:35], s94 offen offset:0 nt lds
v_mfma_f32_16x16x32_bf16 v[64:67], a[100:103], a[16:19], 0
v_exp_f32 v85, v85
v_mfma_f32_16x16x32_bf16 v[68:71], a[100:103], a[32:35], 0
v_exp_f32 v86, v86
v_exp_f32 v87, v87
v_mfma_f32_16x16x32_bf16 v[48:51], a[104:107], a[4:7], v[48:51]
v_exp_f32 v76, v76
v_mfma_f32_16x16x32_bf16 v[52:55], a[104:107], a[20:23], v[52:55]
v_exp_f32 v77, v77
v_mfma_f32_16x16x32_bf16 v[56:59], a[104:107], a[36:39], v[56:59]
v_exp_f32 v78, v78
v_mfma_f32_16x16x32_bf16 v[60:63], a[108:111], a[4:7], v[60:63]
v_exp_f32 v79, v79
v_exp_f32 v88, v88
buffer_load_dwordx4 v29, s[32:35], s94 offen offset:1024 nt lds
v_mfma_f32_16x16x32_bf16 v[64:67], a[108:111], a[20:23], v[64:67]
v_exp_f32 v89, v89
v_mfma_f32_16x16x32_bf16 v[68:71], a[108:111], a[36:39], v[68:71]
v_exp_f32 v90, v90
v_mfma_f32_16x16x32_bf16 v[48:51], a[112:115], a[8:11], v[48:51]
v_exp_f32 v91, v91
v_cvt_pk_bf16_f32 v96, v72, v73
v_mfma_f32_16x16x32_bf16 v[52:55], a[112:115], a[24:27], v[52:55]
v_cvt_pk_bf16_f32 v97, v74, v75
v_cvt_pk_bf16_f32 v98, v84, v85
v_mfma_f32_16x16x32_bf16 v[56:59], a[112:115], a[40:43], v[56:59]
v_cvt_pk_bf16_f32 v99, v86, v87
v_exp_f32 v80, v80
v_mfma_f32_16x16x32_bf16 v[60:63], a[116:119], a[8:11], v[60:63]
v_exp_f32 v81, v81
buffer_load_dwordx4 v28, s[32:35], s94 offen offset:2048 nt lds
v_mfma_f32_16x16x32_bf16 v[64:67], a[116:119], a[24:27], v[64:67]
v_exp_f32 v82, v82
v_mfma_f32_16x16x32_bf16 v[68:71], a[116:119], a[40:43], v[68:71]
v_exp_f32 v83, v83
v_exp_f32 v92, v92
v_mfma_f32_16x16x32_bf16 v[48:51], a[120:123], a[12:15], v[48:51]
v_exp_f32 v93, v93
v_mfma_f32_16x16x32_bf16 v[52:55], a[120:123], a[28:31], v[52:55]
v_exp_f32 v94, v94
v_mfma_f32_16x16x32_bf16 v[56:59], a[120:123], a[44:47], v[56:59]
v_exp_f32 v95, v95
v_cvt_pk_bf16_f32 v100, v76, v77
v_mfma_f32_16x16x32_bf16 v[60:63], a[124:127], a[12:15], v[60:63]
v_cvt_pk_bf16_f32 v101, v78, v79
v_cvt_pk_bf16_f32 v102, v88, v89
buffer_load_dwordx4 v29, s[32:35], s94 offen offset:3072 nt lds
v_mfma_f32_16x16x32_bf16 v[64:67], a[124:127], a[28:31], v[64:67]
v_cvt_pk_bf16_f32 v103, v90, v91
v_cvt_pk_bf16_f32 v104, v80, v81
v_cvt_pk_bf16_f32 v105, v82, v83
v_mfma_f32_16x16x32_bf16 v[68:71], a[124:127], a[44:47], v[68:71]
v_cvt_pk_bf16_f32 v106, v92, v93
v_cvt_pk_bf16_f32 v107, v94, v95
v_mfma_f32_16x16x32_bf16 a[160:163], a[128:131], v[96:99], a[160:163]
v_add_f32 v225, v225, v72
v_add_f32 v227, v227, v76
v_add_f32 v229, v229, v80
v_mfma_f32_16x16x32_bf16 a[164:167], a[128:131], v[100:103], a[164:167]
v_add_f32 v225, v225, v73
v_add_f32 v227, v227, v77
v_mfma_f32_16x16x32_bf16 a[168:171], a[128:131], v[104:107], a[168:171]
v_add_f32 v229, v229, v81
v_add_f32 v225, v225, v74
v_add_f32 v227, v227, v78
v_mfma_f32_16x16x32_bf16 a[172:175], a[132:135], v[96:99], a[172:175]
v_add_f32 v229, v229, v82
v_add_f32 v225, v225, v75
s_add_u32 s98, s96, s97
s_and_b32 s98, s98, 3
s_and_b32 s78, s96, -4
s_or_b32 s78, s78, s98
s_lshl_b32 s78, s78, 15
s_add_u32 s78, s78, s99
s_add_u32 s96, s96, 1
s_add_u32 m0, s77, 0
s_add_u32 s94, s78, 0
buffer_load_dwordx4 v28, s[28:31], s94 offen offset:0 nt lds
v_mfma_f32_16x16x32_bf16 a[176:179], a[132:135], v[100:103], a[176:179]
v_add_f32 v227, v227, v79
v_add_f32 v229, v229, v83
v_add_f32 v225, v225, v84
v_mfma_f32_16x16x32_bf16 a[180:183], a[132:135], v[104:107], a[180:183]
v_add_f32 v227, v227, v88
v_add_f32 v229, v229, v92
v_mfma_f32_16x16x32_bf16 a[184:187], a[136:139], v[96:99], a[184:187]
v_add_f32 v225, v225, v85
v_add_f32 v227, v227, v89
v_add_f32 v229, v229, v93
v_mfma_f32_16x16x32_bf16 a[188:191], a[136:139], v[100:103], a[188:191]
v_add_f32 v225, v225, v86
v_add_f32 v227, v227, v90
v_mfma_f32_16x16x32_bf16 a[192:195], a[136:139], v[104:107], a[192:195]
v_add_f32 v229, v229, v94
v_add_f32 v225, v225, v87
v_add_f32 v227, v227, v91
v_mfma_f32_16x16x32_bf16 a[196:199], a[140:143], v[96:99], a[196:199]
v_add_f32 v229, v229, v95
v_fma_f32 v48, v48, s89, -v30
buffer_load_dwordx4 v29, s[28:31], s94 offen offset:1024 nt lds
v_mfma_f32_16x16x32_bf16 a[200:203], a[140:143], v[100:103], a[200:203]
v_fma_f32 v49, v49, s89, -v30
v_fma_f32 v50, v50, s89, -v30
v_fma_f32 v51, v51, s89, -v30
v_mfma_f32_16x16x32_bf16 a[204:207], a[140:143], v[104:107], a[204:207]
v_fma_f32 v52, v52, s89, -v32
v_fma_f32 v53, v53, s89, -v32
v_fma_f32 v54, v54, s89, -v32
v_mfma_f32_16x16x32_bf16 a[208:211], a[144:147], v[96:99], a[208:211]
v_fma_f32 v55, v55, s89, -v32
v_fma_f32 v56, v56, s89, -v34
v_mfma_f32_16x16x32_bf16 a[212:215], a[144:147], v[100:103], a[212:215]
v_fma_f32 v57, v57, s89, -v34
v_fma_f32 v58, v58, s89, -v34
v_fma_f32 v59, v59, s89, -v34
v_mfma_f32_16x16x32_bf16 a[216:219], a[144:147], v[104:107], a[216:219]
v_fma_f32 v60, v60, s89, -v30
v_fma_f32 v61, v61, s89, -v30
v_mfma_f32_16x16x32_bf16 a[220:223], a[148:151], v[96:99], a[220:223]
v_fma_f32 v62, v62, s89, -v30
v_fma_f32 v63, v63, s89, -v30
v_fma_f32 v64, v64, s89, -v32
buffer_load_dwordx4 v28, s[28:31], s94 offen offset:2048 nt lds
v_mfma_f32_16x16x32_bf16 a[224:227], a[148:151], v[100:103], a[224:227]
v_fma_f32 v65, v65, s89, -v32
v_fma_f32 v66, v66, s89, -v32
v_mfma_f32_16x16x32_bf16 a[228:231], a[148:151], v[104:107], a[228:231]
v_fma_f32 v67, v67, s89, -v32
v_fma_f32 v68, v68, s89, -v34
v_fma_f32 v69, v69, s89, -v34
v_mfma_f32_16x16x32_bf16 a[232:235], a[152:155], v[96:99], a[232:235]
v_fma_f32 v70, v70, s89, -v34
v_fma_f32 v71, v71, s89, -v34
v_mfma_f32_16x16x32_bf16 a[236:239], a[152:155], v[100:103], a[236:239]
v_max3_f32 v36, v48, v49, v50
v_max3_f32 v37, v52, v53, v54
v_max3_f32 v38, v56, v57, v58
v_mfma_f32_16x16x32_bf16 a[240:243], a[152:155], v[104:107], a[240:243]
v_max3_f32 v36, v36, v51, v60
v_max3_f32 v37, v37, v55, v64
v_mfma_f32_16x16x32_bf16 a[244:247], a[156:159], v[96:99], a[244:247]
v_max3_f32 v38, v38, v59, v68
v_max3_f32 v36, v36, v61, v62
v_max3_f32 v37, v37, v65, v66
buffer_load_dwordx4 v29, s[28:31], s94 offen offset:3072 nt lds
v_mfma_f32_16x16x32_bf16 a[248:251], a[156:159], v[100:103], a[248:251]
v_max3_f32 v38, v38, v69, v70
v_max_f32 v36, v36, v63
v_mfma_f32_16x16x32_bf16 a[252:255], a[156:159], v[104:107], a[252:255]
v_max_f32 v37, v37, v67
v_max_f32 v38, v38, v71
v_max3_f32 v39, v36, v37, v38
v_cmp_lt_f32 vcc, s87, v39
s_cbranch_vccz L_fast2
s_call_b64 s[90:91], L_rescale0
L_fast2:
v_mfma_f32_16x16x32_bf16 v[72:75], a[96:99], a[48:51], 0
v_exp_f32 v48, v48
v_mfma_f32_16x16x32_bf16 v[76:79], a[96:99], a[64:67], 0
v_exp_f32 v49, v49
v_exp_f32 v50, v50
v_mfma_f32_16x16x32_bf16 v[80:83], a[96:99], a[80:83], 0
v_exp_f32 v51, v51
v_mfma_f32_16x16x32_bf16 v[84:87], a[100:103], a[48:51], 0
v_exp_f32 v60, v60
s_add_u32 m0, s77, 4096
s_add_u32 s94, s78, 4096
buffer_load_dwordx4 v28, s[28:31], s94 offen offset:0 nt lds
v_mfma_f32_16x16x32_bf16 v[88:91], a[100:103], a[64:67], 0
v_exp_f32 v61, v61
v_mfma_f32_16x16x32_bf16 v[92:95], a[100:103], a[80:83], 0
v_exp_f32 v62, v62
v_exp_f32 v63, v63
v_mfma_f32_16x16x32_bf16 v[72:75], a[104:107], a[52:55], v[72:75]
v_exp_f32 v52, v52
v_mfma_f32_16x16x32_bf16 v[76:79], a[104:107], a[68:71], v[76:79]
v_exp_f32 v53, v53
v_mfma_f32_16x16x32_bf16 v[80:83], a[104:107], a[84:87], v[80:83]
v_exp_f32 v54, v54
v_mfma_f32_16x16x32_bf16 v[84:87], a[108:111], a[52:55], v[84:87]
v_exp_f32 v55, v55
v_exp_f32 v64, v64
buffer_load_dwordx4 v29, s[28:31], s94 offen offset:1024 nt lds
v_mfma_f32_16x16x32_bf16 v[88:91], a[108:111], a[68:71], v[88:91]
v_exp_f32 v65, v65
v_mfma_f32_16x16x32_bf16 v[92:95], a[108:111], a[84:87], v[92:95]
v_exp_f32 v66, v66
s_waitcnt vmcnt(22)
ds_read_b64_tr_b16 a[128:129], v16 offset:8192
ds_read_b64_tr_b16 a[130:131], v16 offset:12288
ds_read_b64_tr_b16 a[132:133], v17 offset:8192
ds_read_b64_tr_b16 a[134:135], v17 offset:12288
ds_read_b64_tr_b16 a[136:137], v18 offset:8192
ds_read_b64_tr_b16 a[138:139], v18 offset:12288
ds_read_b64_tr_b16 a[140:141], v19 offset:8192
ds_read_b64_tr_b16 a[142:143], v19 offset:12288
ds_read_b64_tr_b16 a[144:145], v20 offset:8192
ds_read_b64_tr_b16 a[146:147], v20 offset:12288
ds_read_b64_tr_b16 a[148:149], v21 offset:8192
ds_read_b64_tr_b16 a[150:151], v21 offset:12288
ds_read_b64_tr_b16 a[152:153], v22 offset:8192
ds_read_b64_tr_b16 a[154:155], v22 offset:12288
ds_read_b64_tr_b16 a[156:157], v23 offset:8192
ds_read_b64_tr_b16 a[158:159], v23 offset:12288
v_mfma_f32_16x16x32_bf16 v[72:75], a[112:115], a[56:59], v[72:75]
v_exp_f32 v67, v67
v_cvt_pk_bf16_f32 v96, v48, v49
v_mfma_f32_16x16x32_bf16 v[76:79], a[112:115], a[72:75], v[76:79]
v_cvt_pk_bf16_f32 v97, v50, v51
v_cvt_pk_bf16_f32 v98, v60, v61
v_mfma_f32_16x16x32_bf16 v[80:83], a[112:115], a[88:91], v[80:83]
v_cvt_pk_bf16_f32 v99, v62, v63
v_exp_f32 v56, v56
v_mfma_f32_16x16x32_bf16 v[84:87], a[116:119], a[56:59], v[84:87]
v_exp_f32 v57, v57
buffer_load_dwordx4 v28, s[28:31], s94 offen offset:2048 nt lds
v_mfma_f32_16x16x32_bf16 v[88:91], a[116:119], a[72:75], v[88:91]
v_exp_f32 v58, v58
v_mfma_f32_16x16x32_bf16 v[92:95], a[116:119], a[88:91], v[92:95]
v_exp_f32 v59, v59
v_exp_f32 v68, v68
v_mfma_f32_16x16x32_bf16 v[72:75], a[120:123], a[60:63], v[72:75]
v_exp_f32 v69, v69
v_mfma_f32_16x16x32_bf16 v[76:79], a[120:123], a[76:79], v[76:79]
v_exp_f32 v70, v70
v_mfma_f32_16x16x32_bf16 v[80:83], a[120:123], a[92:95], v[80:83]
v_exp_f32 v71, v71
v_cvt_pk_bf16_f32 v100, v52, v53
v_mfma_f32_16x16x32_bf16 v[84:87], a[124:127], a[60:63], v[84:87]
v_cvt_pk_bf16_f32 v101, v54, v55
v_cvt_pk_bf16_f32 v102, v64, v65
buffer_load_dwordx4 v29, s[28:31], s94 offen offset:3072 nt lds
v_mfma_f32_16x16x32_bf16 v[88:91], a[124:127], a[76:79], v[88:91]
v_cvt_pk_bf16_f32 v103, v66, v67
v_cvt_pk_bf16_f32 v104, v56, v57
v_cvt_pk_bf16_f32 v105, v58, v59
v_mfma_f32_16x16x32_bf16 v[92:95], a[124:127], a[92:95], v[92:95]
v_cvt_pk_bf16_f32 v106, v68, v69
v_cvt_pk_bf16_f32 v107, v70, v71
s_waitcnt lgkmcnt(0)
v_mfma_f32_16x16x32_bf16 v[120:123], a[128:131], v[96:99], v[120:123]
v_add_f32 v31, v31, v48
v_add_f32 v33, v33, v52
v_add_f32 v35, v35, v56
v_mfma_f32_16x16x32_bf16 v[124:127], a[128:131], v[100:103], v[124:127]
v_add_f32 v31, v31, v49
v_add_f32 v33, v33, v53
v_mfma_f32_16x16x32_bf16 v[128:131], a[128:131], v[104:107], v[128:131]
v_add_f32 v35, v35, v57
v_add_f32 v31, v31, v50
v_add_f32 v33, v33, v54
v_mfma_f32_16x16x32_bf16 v[132:135], a[132:135], v[96:99], v[132:135]
v_add_f32 v35, v35, v58
v_add_f32 v31, v31, v51
s_add_u32 s98, s84, s97
s_and_b32 s98, s98, 3
s_and_b32 s83, s84, -4
s_or_b32 s83, s83, s98
s_lshl_b32 s83, s83, 15
s_add_u32 s83, s83, s99
s_add_u32 s84, s84, 1
s_add_u32 m0, s77, 8192
s_add_u32 s94, s83, 0
buffer_load_dwordx4 v28, s[32:35], s94 offen offset:0 nt lds
v_mfma_f32_16x16x32_bf16 v[136:139], a[132:135], v[100:103], v[136:139]
v_add_f32 v33, v33, v55
v_add_f32 v35, v35, v59
v_add_f32 v31, v31, v60
v_mfma_f32_16x16x32_bf16 v[140:143], a[132:135], v[104:107], v[140:143]
v_add_f32 v33, v33, v64
v_add_f32 v35, v35, v68
v_mfma_f32_16x16x32_bf16 v[144:147], a[136:139], v[96:99], v[144:147]
v_add_f32 v31, v31, v61
v_add_f32 v33, v33, v65
v_add_f32 v35, v35, v69
v_mfma_f32_16x16x32_bf16 v[148:151], a[136:139], v[100:103], v[148:151]
v_add_f32 v31, v31, v62
v_add_f32 v33, v33, v66
v_mfma_f32_16x16x32_bf16 v[152:155], a[136:139], v[104:107], v[152:155]
v_add_f32 v35, v35, v70
v_add_f32 v31, v31, v63
v_add_f32 v33, v33, v67
v_mfma_f32_16x16x32_bf16 v[156:159], a[140:143], v[96:99], v[156:159]
v_add_f32 v35, v35, v71
v_fma_f32 v72, v72, s89, -v224
buffer_load_dwordx4 v29, s[32:35], s94 offen offset:1024 nt lds
v_mfma_f32_16x16x32_bf16 v[160:163], a[140:143], v[100:103], v[160:163]
v_fma_f32 v73, v73, s89, -v224
v_fma_f32 v74, v74, s89, -v224
v_fma_f32 v75, v75, s89, -v224
v_mfma_f32_16x16x32_bf16 v[164:167], a[140:143], v[104:107], v[164:167]
v_fma_f32 v76, v76, s89, -v226
v_fma_f32 v77, v77, s89, -v226
v_fma_f32 v78, v78, s89, -v226
s_waitcnt vmcnt(18)
ds_read_b128 a[96:99], v24 offset:16384
ds_read_b128 a[100:103], v24 offset:20480
ds_read_b128 a[104:107], v25 offset:16384
ds_read_b128 a[108:111], v25 offset:20480
ds_read_b128 a[112:115], v26 offset:16384
ds_read_b128 a[116:119], v26 offset:20480
ds_read_b128 a[120:123], v27 offset:16384
ds_read_b128 a[124:127], v27 offset:20480
v_mfma_f32_16x16x32_bf16 v[168:171], a[144:147], v[96:99], v[168:171]
v_fma_f32 v79, v79, s89, -v226
v_fma_f32 v80, v80, s89, -v228
v_mfma_f32_16x16x32_bf16 v[172:175], a[144:147], v[100:103], v[172:175]
v_fma_f32 v81, v81, s89, -v228
v_fma_f32 v82, v82, s89, -v228
v_fma_f32 v83, v83, s89, -v228
v_mfma_f32_16x16x32_bf16 v[176:179], a[144:147], v[104:107], v[176:179]
v_fma_f32 v84, v84, s89, -v224
v_fma_f32 v85, v85, s89, -v224
v_mfma_f32_16x16x32_bf16 v[180:183], a[148:151], v[96:99], v[180:183]
v_fma_f32 v86, v86, s89, -v224
v_fma_f32 v87, v87, s89, -v224
v_fma_f32 v88, v88, s89, -v226
buffer_load_dwordx4 v28, s[32:35], s94 offen offset:2048 nt lds
v_mfma_f32_16x16x32_bf16 v[184:187], a[148:151], v[100:103], v[184:187]
v_fma_f32 v89, v89, s89, -v226
v_fma_f32 v90, v90, s89, -v226
v_mfma_f32_16x16x32_bf16 v[188:191], a[148:151], v[104:107], v[188:191]
v_fma_f32 v91, v91, s89, -v226
v_fma_f32 v92, v92, s89, -v228
v_fma_f32 v93, v93, s89, -v228
v_mfma_f32_16x16x32_bf16 v[192:195], a[152:155], v[96:99], v[192:195]
v_fma_f32 v94, v94, s89, -v228
v_fma_f32 v95, v95, s89, -v228
v_mfma_f32_16x16x32_bf16 v[196:199], a[152:155], v[100:103], v[196:199]
v_max3_f32 v36, v72, v73, v74
v_max3_f32 v37, v76, v77, v78
v_max3_f32 v38, v80, v81, v82
v_mfma_f32_16x16x32_bf16 v[200:203], a[152:155], v[104:107], v[200:203]
v_max3_f32 v36, v36, v75, v84
v_max3_f32 v37, v37, v79, v88
v_mfma_f32_16x16x32_bf16 v[204:207], a[156:159], v[96:99], v[204:207]
v_max3_f32 v38, v38, v83, v92
v_max3_f32 v36, v36, v85, v86
v_max3_f32 v37, v37, v89, v90
buffer_load_dwordx4 v29, s[32:35], s94 offen offset:3072 nt lds
v_mfma_f32_16x16x32_bf16 v[208:211], a[156:159], v[100:103], v[208:211]
v_max3_f32 v38, v38, v93, v94
v_max_f32 v36, v36, v87
v_mfma_f32_16x16x32_bf16 v[212:215], a[156:159], v[104:107], v[212:215]
v_max_f32 v37, v37, v91
v_max_f32 v38, v38, v95
v_max3_f32 v39, v36, v37, v38
v_cmp_lt_f32 vcc, s11, v39
s_cbranch_vccz L_fast3
s_call_b64 s[90:91], L_rescaleJ1
L_fast3:
s_waitcnt lgkmcnt(0)
v_mfma_f32_16x16x32_bf16 v[48:51], a[96:99], a[0:3], 0
v_exp_f32 v72, v72
v_mfma_f32_16x16x32_bf16 v[52:55], a[96:99], a[16:19], 0
v_exp_f32 v73, v73
v_exp_f32 v74, v74
v_mfma_f32_16x16x32_bf16 v[56:59], a[96:99], a[32:35], 0
v_exp_f32 v75, v75
v_mfma_f32_16x16x32_bf16 v[60:63], a[100:103], a[0:3], 0
v_exp_f32 v84, v84
s_add_u32 m0, s77, 12288
s_add_u32 s94, s83, 4096
buffer_load_dwordx4 v28, s[32:35], s94 offen offset:0 nt lds
v_mfma_f32_16x16x32_bf16 v[64:67], a[100:103], a[16:19], 0
v_exp_f32 v85, v85
v_mfma_f32_16x16x32_bf16 v[68:71], a[100:103], a[32:35], 0
v_exp_f32 v86, v86
v_exp_f32 v87, v87
v_mfma_f32_16x16x32_bf16 v[48:51], a[104:107], a[4:7], v[48:51]
v_exp_f32 v76, v76
v_mfma_f32_16x16x32_bf16 v[52:55], a[104:107], a[20:23], v[52:55]
v_exp_f32 v77, v77
v_mfma_f32_16x16x32_bf16 v[56:59], a[104:107], a[36:39], v[56:59]
v_exp_f32 v78, v78
v_mfma_f32_16x16x32_bf16 v[60:63], a[108:111], a[4:7], v[60:63]
v_exp_f32 v79, v79
v_exp_f32 v88, v88
buffer_load_dwordx4 v29, s[32:35], s94 offen offset:1024 nt lds
v_mfma_f32_16x16x32_bf16 v[64:67], a[108:111], a[20:23], v[64:67]
v_exp_f32 v89, v89
v_mfma_f32_16x16x32_bf16 v[68:71], a[108:111], a[36:39], v[68:71]
v_exp_f32 v90, v90
v_mfma_f32_16x16x32_bf16 v[48:51], a[112:115], a[8:11], v[48:51]
v_exp_f32 v91, v91
v_cvt_pk_bf16_f32 v96, v72, v73
v_mfma_f32_16x16x32_bf16 v[52:55], a[112:115], a[24:27], v[52:55]
v_cvt_pk_bf16_f32 v97, v74, v75
v_cvt_pk_bf16_f32 v98, v84, v85
v_mfma_f32_16x16x32_bf16 v[56:59], a[112:115], a[40:43], v[56:59]
v_cvt_pk_bf16_f32 v99, v86, v87
v_exp_f32 v80, v80
v_mfma_f32_16x16x32_bf16 v[60:63], a[116:119], a[8:11], v[60:63]
v_exp_f32 v81, v81
buffer_load_dwordx4 v28, s[32:35], s94 offen offset:2048 nt lds
v_mfma_f32_16x16x32_bf16 v[64:67], a[116:119], a[24:27], v[64:67]
v_exp_f32 v82, v82
v_mfma_f32_16x16x32_bf16 v[68:71], a[116:119], a[40:43], v[68:71]
v_exp_f32 v83, v83
v_exp_f32 v92, v92
v_mfma_f32_16x16x32_bf16 v[48:51], a[120:123], a[12:15], v[48:51]
v_exp_f32 v93, v93
v_mfma_f32_16x16x32_bf16 v[52:55], a[120:123], a[28:31], v[52:55]
v_exp_f32 v94, v94
v_mfma_f32_16x16x32_bf16 v[56:59], a[120:123], a[44:47], v[56:59]
v_exp_f32 v95, v95
v_cvt_pk_bf16_f32 v100, v76, v77
v_mfma_f32_16x16x32_bf16 v[60:63], a[124:127], a[12:15], v[60:63]
v_cvt_pk_bf16_f32 v101, v78, v79
v_cvt_pk_bf16_f32 v102, v88, v89
buffer_load_dwordx4 v29, s[32:35], s94 offen offset:3072 nt lds
v_mfma_f32_16x16x32_bf16 v[64:67], a[124:127], a[28:31], v[64:67]
v_cvt_pk_bf16_f32 v103, v90, v91
v_cvt_pk_bf16_f32 v104, v80, v81
v_cvt_pk_bf16_f32 v105, v82, v83
v_mfma_f32_16x16x32_bf16 v[68:71], a[124:127], a[44:47], v[68:71]
v_cvt_pk_bf16_f32 v106, v92, v93
v_cvt_pk_bf16_f32 v107, v94, v95
v_mfma_f32_16x16x32_bf16 a[160:163], a[128:131], v[96:99], a[160:163]
v_add_f32 v225, v225, v72
v_add_f32 v227, v227, v76
v_add_f32 v229, v229, v80
v_mfma_f32_16x16x32_bf16 a[164:167], a[128:131], v[100:103], a[164:167]
v_add_f32 v225, v225, v73
v_add_f32 v227, v227, v77
v_mfma_f32_16x16x32_bf16 a[168:171], a[128:131], v[104:107], a[168:171]
v_add_f32 v229, v229, v81
v_add_f32 v225, v225, v74
v_add_f32 v227, v227, v78
v_mfma_f32_16x16x32_bf16 a[172:175], a[132:135], v[96:99], a[172:175]
v_add_f32 v229, v229, v82
v_add_f32 v225, v225, v75
s_add_u32 s98, s96, s97
s_and_b32 s98, s98, 3
s_and_b32 s78, s96, -4
s_or_b32 s78, s78, s98
s_lshl_b32 s78, s78, 15
s_add_u32 s78, s78, s99
s_add_u32 s96, s96, 1
s_add_u32 m0, s77, 16384
s_add_u32 s94, s78, 0
buffer_load_dwordx4 v28, s[28:31], s94 offen offset:0 nt lds
v_mfma_f32_16x16x32_bf16 a[176:179], a[132:135], v[100:103], a[176:179]
v_add_f32 v227, v227, v79
v_add_f32 v229, v229, v83
v_add_f32 v225, v225, v84
v_mfma_f32_16x16x32_bf16 a[180:183], a[132:135], v[104:107], a[180:183]
v_add_f32 v227, v227, v88
v_add_f32 v229, v229, v92
v_mfma_f32_16x16x32_bf16 a[184:187], a[136:139], v[96:99], a[184:187]
v_add_f32 v225, v225, v85
v_add_f32 v227, v227, v89
v_add_f32 v229, v229, v93
v_mfma_f32_16x16x32_bf16 a[188:191], a[136:139], v[100:103], a[188:191]
v_add_f32 v225, v225, v86
v_add_f32 v227, v227, v90
v_mfma_f32_16x16x32_bf16 a[192:195], a[136:139], v[104:107], a[192:195]
v_add_f32 v229, v229, v94
v_add_f32 v225, v225, v87
v_add_f32 v227, v227, v91
v_mfma_f32_16x16x32_bf16 a[196:199], a[140:143], v[96:99], a[196:199]
v_add_f32 v229, v229, v95
v_fma_f32 v48, v48, s89, -v30
buffer_load_dwordx4 v29, s[28:31], s94 offen offset:1024 nt lds
v_mfma_f32_16x16x32_bf16 a[200:203], a[140:143], v[100:103], a[200:203]
v_fma_f32 v49, v49, s89, -v30
v_fma_f32 v50, v50, s89, -v30
v_fma_f32 v51, v51, s89, -v30
v_mfma_f32_16x16x32_bf16 a[204:207], a[140:143], v[104:107], a[204:207]
v_fma_f32 v52, v52, s89, -v32
v_fma_f32 v53, v53, s89, -v32
v_fma_f32 v54, v54, s89, -v32
v_mfma_f32_16x16x32_bf16 a[208:211], a[144:147], v[96:99], a[208:211]
v_fma_f32 v55, v55, s89, -v32
v_fma_f32 v56, v56, s89, -v34
v_mfma_f32_16x16x32_bf16 a[212:215], a[144:147], v[100:103], a[212:215]
v_fma_f32 v57, v57, s89, -v34
v_fma_f32 v58, v58, s89, -v34
v_fma_f32 v59, v59, s89, -v34
v_mfma_f32_16x16x32_bf16 a[216:219], a[144:147], v[104:107], a[216:219]
v_fma_f32 v60, v60, s89, -v30
v_fma_f32 v61, v61, s89, -v30
v_mfma_f32_16x16x32_bf16 a[220:223], a[148:151], v[96:99], a[220:223]
v_fma_f32 v62, v62, s89, -v30
v_fma_f32 v63, v63, s89, -v30
v_fma_f32 v64, v64, s89, -v32
buffer_load_dwordx4 v28, s[28:31], s94 offen offset:2048 nt lds
v_mfma_f32_16x16x32_bf16 a[224:227], a[148:151], v[100:103], a[224:227]
v_fma_f32 v65, v65, s89, -v32
v_fma_f32 v66, v66, s89, -v32
v_mfma_f32_16x16x32_bf16 a[228:231], a[148:151], v[104:107], a[228:231]
v_fma_f32 v67, v67, s89, -v32
v_fma_f32 v68, v68, s89, -v34
v_fma_f32 v69, v69, s89, -v34
v_mfma_f32_16x16x32_bf16 a[232:235], a[152:155], v[96:99], a[232:235]
v_fma_f32 v70, v70, s89, -v34
v_fma_f32 v71, v71, s89, -v34
v_mfma_f32_16x16x32_bf16 a[236:239], a[152:155], v[100:103], a[236:239]
v_max3_f32 v36, v48, v49, v50
v_max3_f32 v37, v52, v53, v54
v_max3_f32 v38, v56, v57, v58
v_mfma_f32_16x16x32_bf16 a[240:243], a[152:155], v[104:107], a[240:243]
v_max3_f32 v36, v36, v51, v60
v_max3_f32 v37, v37, v55, v64
v_mfma_f32_16x16x32_bf16 a[244:247], a[156:159], v[96:99], a[244:247]
v_max3_f32 v38, v38, v59, v68
v_max3_f32 v36, v36, v61, v62
v_max3_f32 v37, v37, v65, v66
buffer_load_dwordx4 v29, s[28:31], s94 offen offset:3072 nt lds
v_mfma_f32_16x16x32_bf16 a[248:251], a[156:159], v[100:103], a[248:251]
v_max3_f32 v38, v38, v69, v70
v_max_f32 v36, v36, v63
v_mfma_f32_16x16x32_bf16 a[252:255], a[156:159], v[104:107], a[252:255]
v_max_f32 v37, v37, v67
v_max_f32 v38, v38, v71
v_max3_f32 v39, v36, v37, v38
v_cmp_lt_f32 vcc, s87, v39
s_cbranch_vccz L_fast4
s_call_b64 s[90:91], L_rescale0
L_fast4:
s_sub_u32 s86, s86, 1
s_cmp_lg_u32 s86, 0
s_cbranch_scc1 L_loopJ
v_mfma_f32_16x16x32_bf16 v[72:75], a[96:99], a[48:51], 0
v_exp_f32 v48, v48
v_mfma_f32_16x16x32_bf16 v[76:79], a[96:99], a[64:67], 0
v_exp_f32 v49, v49
v_exp_f32 v50, v50
v_mfma_f32_16x16x32_bf16 v[80:83], a[96:99], a[80:83], 0
v_exp_f32 v51, v51
v_mfma_f32_16x16x32_bf16 v[84:87], a[100:103], a[48:51], 0
v_exp_f32 v60, v60
s_add_u32 m0, s77, 20480
s_add_u32 s94, s78, 4096
buffer_load_dwordx4 v28, s[28:31], s94 offen offset:0 nt lds
v_mfma_f32_16x16x32_bf16 v[88:91], a[100:103], a[64:67], 0
v_exp_f32 v61, v61
v_mfma_f32_16x16x32_bf16 v[92:95], a[100:103], a[80:83], 0
v_exp_f32 v62, v62
v_exp_f32 v63, v63
v_mfma_f32_16x16x32_bf16 v[72:75], a[104:107], a[52:55], v[72:75]
v_exp_f32 v52, v52
v_mfma_f32_16x16x32_bf16 v[76:79], a[104:107], a[68:71], v[76:79]
v_exp_f32 v53, v53
v_mfma_f32_16x16x32_bf16 v[80:83], a[104:107], a[84:87], v[80:83]
v_exp_f32 v54, v54
v_mfma_f32_16x16x32_bf16 v[84:87], a[108:111], a[52:55], v[84:87]
v_exp_f32 v55, v55
v_exp_f32 v64, v64
buffer_load_dwordx4 v29, s[28:31], s94 offen offset:1024 nt lds
v_mfma_f32_16x16x32_bf16 v[88:91], a[108:111], a[68:71], v[88:91]
v_exp_f32 v65, v65
v_mfma_f32_16x16x32_bf16 v[92:95], a[108:111], a[84:87], v[92:95]
v_exp_f32 v66, v66
s_waitcnt vmcnt(22)
ds_read_b64_tr_b16 a[128:129], v16 offset:24576
ds_read_b64_tr_b16 a[130:131], v16 offset:28672
ds_read_b64_tr_b16 a[132:133], v17 offset:24576
ds_read_b64_tr_b16 a[134:135], v17 offset:28672
ds_read_b64_tr_b16 a[136:137], v18 offset:24576
ds_read_b64_tr_b16 a[138:139], v18 offset:28672
ds_read_b64_tr_b16 a[140:141], v19 offset:24576
ds_read_b64_tr_b16 a[142:143], v19 offset:28672
ds_read_b64_tr_b16 a[144:145], v20 offset:24576
ds_read_b64_tr_b16 a[146:147], v20 offset:28672
ds_read_b64_tr_b16 a[148:149], v21 offset:24576
ds_read_b64_tr_b16 a[150:151], v21 offset:28672
ds_read_b64_tr_b16 a[152:153], v22 offset:24576
ds_read_b64_tr_b16 a[154:155], v22 offset:28672
ds_read_b64_tr_b16 a[156:157], v23 offset:24576
ds_read_b64_tr_b16 a[158:159], v23 offset:28672
v_mfma_f32_16x16x32_bf16 v[72:75], a[112:115], a[56:59], v[72:75]
v_exp_f32 v67, v67
v_cvt_pk_bf16_f32 v96, v48, v49
v_mfma_f32_16x16x32_bf16 v[76:79], a[112:115], a[72:75], v[76:79]
v_cvt_pk_bf16_f32 v97, v50, v51
v_cvt_pk_bf16_f32 v98, v60, v61
v_mfma_f32_16x16x32_bf16 v[80:83], a[112:115], a[88:91], v[80:83]
v_cvt_pk_bf16_f32 v99, v62, v63
v_exp_f32 v56, v56
v_mfma_f32_16x16x32_bf16 v[84:87], a[116:119], a[56:59], v[84:87]
v_exp_f32 v57, v57
buffer_load_dwordx4 v28, s[28:31], s94 offen offset:2048 nt lds
v_mfma_f32_16x16x32_bf16 v[88:91], a[116:119], a[72:75], v[88:91]
v_exp_f32 v58, v58
v_mfma_f32_16x16x32_bf16 v[92:95], a[116:119], a[88:91], v[92:95]
v_exp_f32 v59, v59
v_exp_f32 v68, v68
v_mfma_f32_16x16x32_bf16 v[72:75], a[120:123], a[60:63], v[72:75]
v_exp_f32 v69, v69
v_mfma_f32_16x16x32_bf16 v[76:79], a[120:123], a[76:79], v[76:79]
v_exp_f32 v70, v70
v_mfma_f32_16x16x32_bf16 v[80:83], a[120:123], a[92:95], v[80:83]
v_exp_f32 v71, v71
v_cvt_pk_bf16_f32 v100, v52, v53
v_mfma_f32_16x16x32_bf16 v[84:87], a[124:127], a[60:63], v[84:87]
v_cvt_pk_bf16_f32 v101, v54, v55
v_cvt_pk_bf16_f32 v102, v64, v65
buffer_load_dwordx4 v29, s[28:31], s94 offen offset:3072 nt lds
v_mfma_f32_16x16x32_bf16 v[88:91], a[124:127], a[76:79], v[88:91]
v_cvt_pk_bf16_f32 v103, v66, v67
v_cvt_pk_bf16_f32 v104, v56, v57
v_cvt_pk_bf16_f32 v105, v58, v59
v_mfma_f32_16x16x32_bf16 v[92:95], a[124:127], a[92:95], v[92:95]
v_cvt_pk_bf16_f32 v106, v68, v69
v_cvt_pk_bf16_f32 v107, v70, v71
s_waitcnt lgkmcnt(0)
v_mfma_f32_16x16x32_bf16 v[120:123], a[128:131], v[96:99], v[120:123]
v_add_f32 v31, v31, v48
v_add_f32 v33, v33, v52
v_add_f32 v35, v35, v56
v_mfma_f32_16x16x32_bf16 v[124:127], a[128:131], v[100:103], v[124:127]
v_add_f32 v31, v31, v49
v_add_f32 v33, v33, v53
v_mfma_f32_16x16x32_bf16 v[128:131], a[128:131], v[104:107], v[128:131]
v_add_f32 v35, v35, v57
v_add_f32 v31, v31, v50
v_add_f32 v33, v33, v54
v_mfma_f32_16x16x32_bf16 v[132:135], a[132:135], v[96:99], v[132:135]
v_add_f32 v35, v35, v58
v_add_f32 v31, v31, v51
s_add_u32 s98, s84, s97
s_and_b32 s98, s98, 3
s_and_b32 s83, s84, -4
s_or_b32 s83, s83, s98
s_lshl_b32 s83, s83, 15
s_add_u32 s83, s83, s99
s_add_u32 s84, s84, 1
s_add_u32 m0, s77, 24576
s_add_u32 s94, s83, 0
buffer_load_dwordx4 v28, s[32:35], s94 offen offset:0 nt lds
v_mfma_f32_16x16x32_bf16 v[136:139], a[132:135], v[100:103], v[136:139]
v_add_f32 v33, v33, v55
v_add_f32 v35, v35, v59
v_add_f32 v31, v31, v60
v_mfma_f32_16x16x32_bf16 v[140:143], a[132:135], v[104:107], v[140:143]
v_add_f32 v33, v33, v64
v_add_f32 v35, v35, v68
v_mfma_f32_16x16x32_bf16 v[144:147], a[136:139], v[96:99], v[144:147]
v_add_f32 v31, v31, v61
v_add_f32 v33, v33, v65
v_add_f32 v35, v35, v69
v_mfma_f32_16x16x32_bf16 v[148:151], a[136:139], v[100:103], v[148:151]
v_add_f32 v31, v31, v62
v_add_f32 v33, v33, v66
v_mfma_f32_16x16x32_bf16 v[152:155], a[136:139], v[104:107], v[152:155]
v_add_f32 v35, v35, v70
v_add_f32 v31, v31, v63
v_add_f32 v33, v33, v67
v_mfma_f32_16x16x32_bf16 v[156:159], a[140:143], v[96:99], v[156:159]
v_add_f32 v35, v35, v71
v_fma_f32 v72, v72, s89, -v224
buffer_load_dwordx4 v29, s[32:35], s94 offen offset:1024 nt lds
v_mfma_f32_16x16x32_bf16 v[160:163], a[140:143], v[100:103], v[160:163]
v_fma_f32 v73, v73, s89, -v224
v_fma_f32 v74, v74, s89, -v224
v_fma_f32 v75, v75, s89, -v224
v_mfma_f32_16x16x32_bf16 v[164:167], a[140:143], v[104:107], v[164:167]
v_fma_f32 v76, v76, s89, -v226
v_fma_f32 v77, v77, s89, -v226
v_fma_f32 v78, v78, s89, -v226
s_waitcnt vmcnt(18)
ds_read_b128 a[96:99], v24 offset:0
ds_read_b128 a[100:103], v24 offset:4096
ds_read_b128 a[104:107], v25 offset:0
ds_read_b128 a[108:111], v25 offset:4096
ds_read_b128 a[112:115], v26 offset:0
ds_read_b128 a[116:119], v26 offset:4096
ds_read_b128 a[120:123], v27 offset:0
ds_read_b128 a[124:127], v27 offset:4096
v_mfma_f32_16x16x32_bf16 v[168:171], a[144:147], v[96:99], v[168:171]
v_fma_f32 v79, v79, s89, -v226
v_fma_f32 v80, v80, s89, -v228
v_mfma_f32_16x16x32_bf16 v[172:175], a[144:147], v[100:103], v[172:175]
v_fma_f32 v81, v81, s89, -v228
v_fma_f32 v82, v82, s89, -v228
v_fma_f32 v83, v83, s89, -v228
v_mfma_f32_16x16x32_bf16 v[176:179], a[144:147], v[104:107], v[176:179]
v_fma_f32 v84, v84, s89, -v224
v_fma_f32 v85, v85, s89, -v224
v_mfma_f32_16x16x32_bf16 v[180:183], a[148:151], v[96:99], v[180:183]
v_fma_f32 v86, v86, s89, -v224
v_fma_f32 v87, v87, s89, -v224
v_fma_f32 v88, v88, s89, -v226
buffer_load_dwordx4 v28, s[32:35], s94 offen offset:2048 nt lds
v_mfma_f32_16x16x32_bf16 v[184:187], a[148:151], v[100:103], v[184:187]
v_fma_f32 v89, v89, s89, -v226
v_fma_f32 v90, v90, s89, -v226
v_mfma_f32_16x16x32_bf16 v[188:191], a[148:151], v[104:107], v[188:191]
v_fma_f32 v91, v91, s89, -v226
v_fma_f32 v92, v92, s89, -v228
v_fma_f32 v93, v93, s89, -v228
v_mfma_f32_16x16x32_bf16 v[192:195], a[152:155], v[96:99], v[192:195]
v_fma_f32 v94, v94, s89, -v228
v_fma_f32 v95, v95, s89, -v228
v_mfma_f32_16x16x32_bf16 v[196:199], a[152:155], v[100:103], v[196:199]
v_max3_f32 v36, v72, v73, v74
v_max3_f32 v37, v76, v77, v78
v_max3_f32 v38, v80, v81, v82
v_mfma_f32_16x16x32_bf16 v[200:203], a[152:155], v[104:107], v[200:203]
v_max3_f32 v36, v36, v75, v84
v_max3_f32 v37, v37, v79, v88
v_mfma_f32_16x16x32_bf16 v[204:207], a[156:159], v[96:99], v[204:207]
v_max3_f32 v38, v38, v83, v92
v_max3_f32 v36, v36, v85, v86
v_max3_f32 v37, v37, v89, v90
buffer_load_dwordx4 v29, s[32:35], s94 offen offset:3072 nt lds
v_mfma_f32_16x16x32_bf16 v[208:211], a[156:159], v[100:103], v[208:211]
v_max3_f32 v38, v38, v93, v94
v_max_f32 v36, v36, v87
v_mfma_f32_16x16x32_bf16 v[212:215], a[156:159], v[104:107], v[212:215]
v_max_f32 v37, v37, v91
v_max_f32 v38, v38, v95
v_max3_f32 v39, v36, v37, v38
v_cmp_lt_f32 vcc, s11, v39
s_cbranch_vccz L_fast5
s_call_b64 s[90:91], L_rescaleJ1
L_fast5:
s_waitcnt lgkmcnt(0)
v_mfma_f32_16x16x32_bf16 v[48:51], a[96:99], a[0:3], 0
v_exp_f32 v72, v72
v_mfma_f32_16x16x32_bf16 v[52:55], a[96:99], a[16:19], 0
v_exp_f32 v73, v73
v_exp_f32 v74, v74
v_mfma_f32_16x16x32_bf16 v[56:59], a[96:99], a[32:35], 0
v_exp_f32 v75, v75
v_mfma_f32_16x16x32_bf16 v[60:63], a[100:103], a[0:3], 0
v_exp_f32 v84, v84
s_add_u32 m0, s77, 28672
s_add_u32 s94, s83, 4096
buffer_load_dwordx4 v28, s[32:35], s94 offen offset:0 nt lds
v_mfma_f32_16x16x32_bf16 v[64:67], a[100:103], a[16:19], 0
v_exp_f32 v85, v85
v_mfma_f32_16x16x32_bf16 v[68:71], a[100:103], a[32:35], 0
v_exp_f32 v86, v86
v_exp_f32 v87, v87
v_mfma_f32_16x16x32_bf16 v[48:51], a[104:107], a[4:7], v[48:51]
v_exp_f32 v76, v76
v_mfma_f32_16x16x32_bf16 v[52:55], a[104:107], a[20:23], v[52:55]
v_exp_f32 v77, v77
v_mfma_f32_16x16x32_bf16 v[56:59], a[104:107], a[36:39], v[56:59]
v_exp_f32 v78, v78
v_mfma_f32_16x16x32_bf16 v[60:63], a[108:111], a[4:7], v[60:63]
v_exp_f32 v79, v79
v_exp_f32 v88, v88
buffer_load_dwordx4 v29, s[32:35], s94 offen offset:1024 nt lds
v_mfma_f32_16x16x32_bf16 v[64:67], a[108:111], a[20:23], v[64:67]
v_exp_f32 v89, v89
v_mfma_f32_16x16x32_bf16 v[68:71], a[108:111], a[36:39], v[68:71]
v_exp_f32 v90, v90
v_mfma_f32_16x16x32_bf16 v[48:51], a[112:115], a[8:11], v[48:51]
v_exp_f32 v91, v91
v_cvt_pk_bf16_f32 v96, v72, v73
v_mfma_f32_16x16x32_bf16 v[52:55], a[112:115], a[24:27], v[52:55]
v_cvt_pk_bf16_f32 v97, v74, v75
v_cvt_pk_bf16_f32 v98, v84, v85
v_mfma_f32_16x16x32_bf16 v[56:59], a[112:115], a[40:43], v[56:59]
v_cvt_pk_bf16_f32 v99, v86, v87
v_exp_f32 v80, v80
v_mfma_f32_16x16x32_bf16 v[60:63], a[116:119], a[8:11], v[60:63]
v_exp_f32 v81, v81
buffer_load_dwordx4 v28, s[32:35], s94 offen offset:2048 nt lds
v_mfma_f32_16x16x32_bf16 v[64:67], a[116:119], a[24:27], v[64:67]
v_exp_f32 v82, v82
v_mfma_f32_16x16x32_bf16 v[68:71], a[116:119], a[40:43], v[68:71]
v_exp_f32 v83, v83
v_exp_f32 v92, v92
v_mfma_f32_16x16x32_bf16 v[48:51], a[120:123], a[12:15], v[48:51]
v_exp_f32 v93, v93
v_mfma_f32_16x16x32_bf16 v[52:55], a[120:123], a[28:31], v[52:55]
v_exp_f32 v94, v94
v_mfma_f32_16x16x32_bf16 v[56:59], a[120:123], a[44:47], v[56:59]
v_exp_f32 v95, v95
v_cvt_pk_bf16_f32 v100, v76, v77
v_mfma_f32_16x16x32_bf16 v[60:63], a[124:127], a[12:15], v[60:63]
v_cvt_pk_bf16_f32 v101, v78, v79
v_cvt_pk_bf16_f32 v102, v88, v89
buffer_load_dwordx4 v29, s[32:35], s94 offen offset:3072 nt lds
v_mfma_f32_16x16x32_bf16 v[64:67], a[124:127], a[28:31], v[64:67]
v_cvt_pk_bf16_f32 v103, v90, v91
v_cvt_pk_bf16_f32 v104, v80, v81
v_cvt_pk_bf16_f32 v105, v82, v83
v_mfma_f32_16x16x32_bf16 v[68:71], a[124:127], a[44:47], v[68:71]
v_cvt_pk_bf16_f32 v106, v92, v93
v_cvt_pk_bf16_f32 v107, v94, v95
v_mfma_f32_16x16x32_bf16 a[160:163], a[128:131], v[96:99], a[160:163]
v_add_f32 v225, v225, v72
v_add_f32 v227, v227, v76
v_add_f32 v229, v229, v80
v_mfma_f32_16x16x32_bf16 a[164:167], a[128:131], v[100:103], a[164:167]
v_add_f32 v225, v225, v73
v_add_f32 v227, v227, v77
v_mfma_f32_16x16x32_bf16 a[168:171], a[128:131], v[104:107], a[168:171]
v_add_f32 v229, v229, v81
v_add_f32 v225, v225, v74
v_add_f32 v227, v227, v78
v_mfma_f32_16x16x32_bf16 a[172:175], a[132:135], v[96:99], a[172:175]
v_add_f32 v229, v229, v82
v_add_f32 v225, v225, v75
s_add_u32 s98, s96, s97
s_and_b32 s98, s98, 3
s_and_b32 s78, s96, -4
s_or_b32 s78, s78, s98
s_lshl_b32 s78, s78, 15
s_add_u32 s78, s78, s99
s_add_u32 s96, s96, 1
s_add_u32 m0, s77, 0
s_add_u32 s94, s78, 0
buffer_load_dwordx4 v28, s[28:31], s94 offen offset:0 nt lds
v_mfma_f32_16x16x32_bf16 a[176:179], a[132:135], v[100:103], a[176:179]
v_add_f32 v227, v227, v79
v_add_f32 v229, v229, v83
v_add_f32 v225, v225, v84
v_mfma_f32_16x16x32_bf16 a[180:183], a[132:135], v[104:107], a[180:183]
v_add_f32 v227, v227, v88
v_add_f32 v229, v229, v92
v_mfma_f32_16x16x32_bf16 a[184:187], a[136:139], v[96:99], a[184:187]
v_add_f32 v225, v225, v85
v_add_f32 v227, v227, v89
v_add_f32 v229, v229, v93
v_mfma_f32_16x16x32_bf16 a[188:191], a[136:139], v[100:103], a[188:191]
v_add_f32 v225, v225, v86
v_add_f32 v227, v227, v90
v_mfma_f32_16x16x32_bf16 a[192:195], a[136:139], v[104:107], a[192:195]
v_add_f32 v229, v229, v94
v_add_f32 v225, v225, v87
v_add_f32 v227, v227, v91
v_mfma_f32_16x16x32_bf16 a[196:199], a[140:143], v[96:99], a[196:199]
v_add_f32 v229, v229, v95
v_fma_f32 v48, v48, s89, -v30
buffer_load_dwordx4 v29, s[28:31], s94 offen offset:1024 nt lds
v_mfma_f32_16x16x32_bf16 a[200:203], a[140:143], v[100:103], a[200:203]
v_fma_f32 v49, v49, s89, -v30
v_fma_f32 v50, v50, s89, -v30
v_fma_f32 v51, v51, s89, -v30
v_mfma_f32_16x16x32_bf16 a[204:207], a[140:143], v[104:107], a[204:207]
v_fma_f32 v52, v52, s89, -v32
v_fma_f32 v53, v53, s89, -v32
v_fma_f32 v54, v54, s89, -v32
v_mfma_f32_16x16x32_bf16 a[208:211], a[144:147], v[96:99], a[208:211]
v_fma_f32 v55, v55, s89, -v32
v_fma_f32 v56, v56, s89, -v34
v_mfma_f32_16x16x32_bf16 a[212:215], a[144:147], v[100:103], a[212:215]
v_fma_f32 v57, v57, s89, -v34
v_fma_f32 v58, v58, s89, -v34
v_fma_f32 v59, v59, s89, -v34
v_mfma_f32_16x16x32_bf16 a[216:219], a[144:147], v[104:107], a[216:219]
v_fma_f32 v60, v60, s89, -v30
v_fma_f32 v61, v61, s89, -v30
v_mfma_f32_16x16x32_bf16 a[220:223], a[148:151], v[96:99], a[220:223]
v_fma_f32 v62, v62, s89, -v30
v_fma_f32 v63, v63, s89, -v30
v_fma_f32 v64, v64, s89, -v32
buffer_load_dwordx4 v28, s[28:31], s94 offen offset:2048 nt lds
v_mfma_f32_16x16x32_bf16 a[224:227], a[148:151], v[100:103], a[224:227]
v_fma_f32 v65, v65, s89, -v32
v_fma_f32 v66, v66, s89, -v32
v_mfma_f32_16x16x32_bf16 a[228:231], a[148:151], v[104:107], a[228:231]
v_fma_f32 v67, v67, s89, -v32
v_fma_f32 v68, v68, s89, -v34
v_fma_f32 v69, v69, s89, -v34
v_mfma_f32_16x16x32_bf16 a[232:235], a[152:155], v[96:99], a[232:235]
v_fma_f32 v70, v70, s89, -v34
v_fma_f32 v71, v71, s89, -v34
v_mfma_f32_16x16x32_bf16 a[236:239], a[152:155], v[100:103], a[236:239]
v_max3_f32 v36, v48, v49, v50
v_max3_f32 v37, v52, v53, v54
v_max3_f32 v38, v56, v57, v58
v_mfma_f32_16x16x32_bf16 a[240:243], a[152:155], v[104:107], a[240:243]
v_max3_f32 v36, v36, v51, v60
v_max3_f32 v37, v37, v55, v64
v_mfma_f32_16x16x32_bf16 a[244:247], a[156:159], v[96:99], a[244:247]
v_max3_f32 v38, v38, v59, v68
v_max3_f32 v36, v36, v61, v62
v_max3_f32 v37, v37, v65, v66
buffer_load_dwordx4 v29, s[28:31], s94 offen offset:3072 nt lds
v_mfma_f32_16x16x32_bf16 a[248:251], a[156:159], v[100:103], a[248:251]
v_max3_f32 v38, v38, v69, v70
v_max_f32 v36, v36, v63
v_mfma_f32_16x16x32_bf16 a[252:255], a[156:159], v[104:107], a[252:255]
v_max_f32 v37, v37, v67
v_max_f32 v38, v38, v71
v_max3_f32 v39, v36, v37, v38
v_cmp_lt_f32 vcc, s87, v39
s_cbranch_vccz L_fast6
s_call_b64 s[90:91], L_rescale0
L_fast6:
v_mfma_f32_16x16x32_bf16 v[72:75], a[96:99], a[48:51], 0
v_exp_f32 v48, v48
v_mfma_f32_16x16x32_bf16 v[76:79], a[96:99], a[64:67], 0
v_exp_f32 v49, v49
v_exp_f32 v50, v50
v_mfma_f32_16x16x32_bf16 v[80:83], a[96:99], a[80:83], 0
v_exp_f32 v51, v51
v_mfma_f32_16x16x32_bf16 v[84:87], a[100:103], a[48:51], 0
v_exp_f32 v60, v60
s_add_u32 m0, s77, 4096
s_add_u32 s94, s78, 4096
buffer_load_dwordx4 v28, s[28:31], s94 offen offset:0 nt lds
v_mfma_f32_16x16x32_bf16 v[88:91], a[100:103], a[64:67], 0
v_exp_f32 v61, v61
v_mfma_f32_16x16x32_bf16 v[92:95], a[100:103], a[80:83], 0
v_exp_f32 v62, v62
v_exp_f32 v63, v63
v_mfma_f32_16x16x32_bf16 v[72:75], a[104:107], a[52:55], v[72:75]
v_exp_f32 v52, v52
v_mfma_f32_16x16x32_bf16 v[76:79], a[104:107], a[68:71], v[76:79]
v_exp_f32 v53, v53
v_mfma_f32_16x16x32_bf16 v[80:83], a[104:107], a[84:87], v[80:83]
v_exp_f32 v54, v54
v_mfma_f32_16x16x32_bf16 v[84:87], a[108:111], a[52:55], v[84:87]
v_exp_f32 v55, v55
v_exp_f32 v64, v64
buffer_load_dwordx4 v29, s[28:31], s94 offen offset:1024 nt lds
v_mfma_f32_16x16x32_bf16 v[88:91], a[108:111], a[68:71], v[88:91]
v_exp_f32 v65, v65
v_mfma_f32_16x16x32_bf16 v[92:95], a[108:111], a[84:87], v[92:95]
v_exp_f32 v66, v66
s_waitcnt vmcnt(22)
ds_read_b64_tr_b16 a[128:129], v16 offset:8192
ds_read_b64_tr_b16 a[130:131], v16 offset:12288
ds_read_b64_tr_b16 a[132:133], v17 offset:8192
ds_read_b64_tr_b16 a[134:135], v17 offset:12288
ds_read_b64_tr_b16 a[136:137], v18 offset:8192
ds_read_b64_tr_b16 a[138:139], v18 offset:12288
ds_read_b64_tr_b16 a[140:141], v19 offset:8192
ds_read_b64_tr_b16 a[142:143], v19 offset:12288
ds_read_b64_tr_b16 a[144:145], v20 offset:8192
ds_read_b64_tr_b16 a[146:147], v20 offset:12288
ds_read_b64_tr_b16 a[148:149], v21 offset:8192
ds_read_b64_tr_b16 a[150:151], v21 offset:12288
ds_read_b64_tr_b16 a[152:153], v22 offset:8192
ds_read_b64_tr_b16 a[154:155], v22 offset:12288
ds_read_b64_tr_b16 a[156:157], v23 offset:8192
ds_read_b64_tr_b16 a[158:159], v23 offset:12288
v_mfma_f32_16x16x32_bf16 v[72:75], a[112:115], a[56:59], v[72:75]
v_exp_f32 v67, v67
v_cvt_pk_bf16_f32 v96, v48, v49
v_mfma_f32_16x16x32_bf16 v[76:79], a[112:115], a[72:75], v[76:79]
v_cvt_pk_bf16_f32 v97, v50, v51
v_cvt_pk_bf16_f32 v98, v60, v61
v_mfma_f32_16x16x32_bf16 v[80:83], a[112:115], a[88:91], v[80:83]
v_cvt_pk_bf16_f32 v99, v62, v63
v_exp_f32 v56, v56
v_mfma_f32_16x16x32_bf16 v[84:87], a[116:119], a[56:59], v[84:87]
v_exp_f32 v57, v57
buffer_load_dwordx4 v28, s[28:31], s94 offen offset:2048 nt lds
v_mfma_f32_16x16x32_bf16 v[88:91], a[116:119], a[72:75], v[88:91]
v_exp_f32 v58, v58
v_mfma_f32_16x16x32_bf16 v[92:95], a[116:119], a[88:91], v[92:95]
v_exp_f32 v59, v59
v_exp_f32 v68, v68
v_mfma_f32_16x16x32_bf16 v[72:75], a[120:123], a[60:63], v[72:75]
v_exp_f32 v69, v69
v_mfma_f32_16x16x32_bf16 v[76:79], a[120:123], a[76:79], v[76:79]
v_exp_f32 v70, v70
v_mfma_f32_16x16x32_bf16 v[80:83], a[120:123], a[92:95], v[80:83]
v_exp_f32 v71, v71
v_cvt_pk_bf16_f32 v100, v52, v53
v_mfma_f32_16x16x32_bf16 v[84:87], a[124:127], a[60:63], v[84:87]
v_cvt_pk_bf16_f32 v101, v54, v55
v_cvt_pk_bf16_f32 v102, v64, v65
buffer_load_dwordx4 v29, s[28:31], s94 offen offset:3072 nt lds
v_mfma_f32_16x16x32_bf16 v[88:91], a[124:127], a[76:79], v[88:91]
v_cvt_pk_bf16_f32 v103, v66, v67
v_cvt_pk_bf16_f32 v104, v56, v57
v_cvt_pk_bf16_f32 v105, v58, v59
v_mfma_f32_16x16x32_bf16 v[92:95], a[124:127], a[92:95], v[92:95]
v_cvt_pk_bf16_f32 v106, v68, v69
v_cvt_pk_bf16_f32 v107, v70, v71
s_waitcnt lgkmcnt(0)
v_mfma_f32_16x16x32_bf16 v[120:123], a[128:131], v[96:99], v[120:123]
v_add_f32 v31, v31, v48
v_add_f32 v33, v33, v52
v_add_f32 v35, v35, v56
v_mfma_f32_16x16x32_bf16 v[124:127], a[128:131], v[100:103], v[124:127]
v_add_f32 v31, v31, v49
v_add_f32 v33, v33, v53
v_mfma_f32_16x16x32_bf16 v[128:131], a[128:131], v[104:107], v[128:131]
v_add_f32 v35, v35, v57
v_add_f32 v31, v31, v50
v_add_f32 v33, v33, v54
v_mfma_f32_16x16x32_bf16 v[132:135], a[132:135], v[96:99], v[132:135]
v_add_f32 v35, v35, v58
v_add_f32 v31, v31, v51
s_add_u32 s98, s84, s97
s_and_b32 s98, s98, 3
s_and_b32 s83, s84, -4
s_or_b32 s83, s83, s98
s_lshl_b32 s83, s83, 15
s_add_u32 s83, s83, s99
s_add_u32 s84, s84, 1
s_add_u32 m0, s77, 8192
s_add_u32 s94, s83, 0
buffer_load_dwordx4 v28, s[32:35], s94 offen offset:0 nt lds
v_mfma_f32_16x16x32_bf16 v[136:139], a[132:135], v[100:103], v[136:139]
v_add_f32 v33, v33, v55
v_add_f32 v35, v35, v59
v_add_f32 v31, v31, v60
v_mfma_f32_16x16x32_bf16 v[140:143], a[132:135], v[104:107], v[140:143]
v_add_f32 v33, v33, v64
v_add_f32 v35, v35, v68
v_mfma_f32_16x16x32_bf16 v[144:147], a[136:139], v[96:99], v[144:147]
v_add_f32 v31, v31, v61
v_add_f32 v33, v33, v65
v_add_f32 v35, v35, v69
v_mfma_f32_16x16x32_bf16 v[148:151], a[136:139], v[100:103], v[148:151]
v_add_f32 v31, v31, v62
v_add_f32 v33, v33, v66
v_mfma_f32_16x16x32_bf16 v[152:155], a[136:139], v[104:107], v[152:155]
v_add_f32 v35, v35, v70
v_add_f32 v31, v31, v63
v_add_f32 v33, v33, v67
v_mfma_f32_16x16x32_bf16 v[156:159], a[140:143], v[96:99], v[156:159]
v_add_f32 v35, v35, v71
v_fma_f32 v72, v72, s89, -v224
buffer_load_dwordx4 v29, s[32:35], s94 offen offset:1024 nt lds
v_mfma_f32_16x16x32_bf16 v[160:163], a[140:143], v[100:103], v[160:163]
v_fma_f32 v73, v73, s89, -v224
v_fma_f32 v74, v74, s89, -v224
v_fma_f32 v75, v75, s89, -v224
v_mfma_f32_16x16x32_bf16 v[164:167], a[140:143], v[104:107], v[164:167]
v_fma_f32 v76, v76, s89, -v226
v_fma_f32 v77, v77, s89, -v226
v_fma_f32 v78, v78, s89, -v226
s_waitcnt vmcnt(18)
ds_read_b128 a[96:99], v24 offset:16384
ds_read_b128 a[100:103], v24 offset:20480
ds_read_b128 a[104:107], v25 offset:16384
ds_read_b128 a[108:111], v25 offset:20480
ds_read_b128 a[112:115], v26 offset:16384
ds_read_b128 a[116:119], v26 offset:20480
ds_read_b128 a[120:123], v27 offset:16384
ds_read_b128 a[124:127], v27 offset:20480
v_mfma_f32_16x16x32_bf16 v[168:171], a[144:147], v[96:99], v[168:171]
v_fma_f32 v79, v79, s89, -v226
v_fma_f32 v80, v80, s89, -v228
v_mfma_f32_16x16x32_bf16 v[172:175], a[144:147], v[100:103], v[172:175]
v_fma_f32 v81, v81, s89, -v228
v_fma_f32 v82, v82, s89, -v228
v_fma_f32 v83, v83, s89, -v228
v_mfma_f32_16x16x32_bf16 v[176:179], a[144:147], v[104:107], v[176:179]
v_fma_f32 v84, v84, s89, -v224
v_fma_f32 v85, v85, s89, -v224
v_mfma_f32_16x16x32_bf16 v[180:183], a[148:151], v[96:99], v[180:183]
v_fma_f32 v86, v86, s89, -v224
v_fma_f32 v87, v87, s89, -v224
v_fma_f32 v88, v88, s89, -v226
buffer_load_dwordx4 v28, s[32:35], s94 offen offset:2048 nt lds
v_mfma_f32_16x16x32_bf16 v[184:187], a[148:151], v[100:103], v[184:187]
v_fma_f32 v89, v89, s89, -v226
v_fma_f32 v90, v90, s89, -v226
v_mfma_f32_16x16x32_bf16 v[188:191], a[148:151], v[104:107], v[188:191]
v_fma_f32 v91, v91, s89, -v226
v_fma_f32 v92, v92, s89, -v228
v_fma_f32 v93, v93, s89, -v228
v_mfma_f32_16x16x32_bf16 v[192:195], a[152:155], v[96:99], v[192:195]
v_fma_f32 v94, v94, s89, -v228
v_fma_f32 v95, v95, s89, -v228
v_mfma_f32_16x16x32_bf16 v[196:199], a[152:155], v[100:103], v[196:199]
v_max3_f32 v36, v72, v73, v74
v_max3_f32 v37, v76, v77, v78
v_max3_f32 v38, v80, v81, v82
v_mfma_f32_16x16x32_bf16 v[200:203], a[152:155], v[104:107], v[200:203]
v_max3_f32 v36, v36, v75, v84
v_max3_f32 v37, v37, v79, v88
v_mfma_f32_16x16x32_bf16 v[204:207], a[156:159], v[96:99], v[204:207]
v_max3_f32 v38, v38, v83, v92
v_max3_f32 v36, v36, v85, v86
v_max3_f32 v37, v37, v89, v90
buffer_load_dwordx4 v29, s[32:35], s94 offen offset:3072 nt lds
v_mfma_f32_16x16x32_bf16 v[208:211], a[156:159], v[100:103], v[208:211]
v_max3_f32 v38, v38, v93, v94
v_max_f32 v36, v36, v87
v_mfma_f32_16x16x32_bf16 v[212:215], a[156:159], v[104:107], v[212:215]
v_max_f32 v37, v37, v91
v_max_f32 v38, v38, v95
v_max3_f32 v39, v36, v37, v38
v_cmp_lt_f32 vcc, s11, v39
s_cbranch_vccz L_fast7
s_call_b64 s[90:91], L_rescaleJ1
L_fast7:
s_waitcnt lgkmcnt(0)
v_mfma_f32_16x16x32_bf16 v[48:51], a[96:99], a[0:3], 0
v_exp_f32 v72, v72
v_mfma_f32_16x16x32_bf16 v[52:55], a[96:99], a[16:19], 0
v_exp_f32 v73, v73
v_exp_f32 v74, v74
v_mfma_f32_16x16x32_bf16 v[56:59], a[96:99], a[32:35], 0
v_exp_f32 v75, v75
v_mfma_f32_16x16x32_bf16 v[60:63], a[100:103], a[0:3], 0
v_exp_f32 v84, v84
s_add_u32 m0, s77, 12288
s_add_u32 s94, s83, 4096
buffer_load_dwordx4 v28, s[32:35], s94 offen offset:0 nt lds
v_mfma_f32_16x16x32_bf16 v[64:67], a[100:103], a[16:19], 0
v_exp_f32 v85, v85
v_mfma_f32_16x16x32_bf16 v[68:71], a[100:103], a[32:35], 0
v_exp_f32 v86, v86
v_exp_f32 v87, v87
v_mfma_f32_16x16x32_bf16 v[48:51], a[104:107], a[4:7], v[48:51]
v_exp_f32 v76, v76
v_mfma_f32_16x16x32_bf16 v[52:55], a[104:107], a[20:23], v[52:55]
v_exp_f32 v77, v77
v_mfma_f32_16x16x32_bf16 v[56:59], a[104:107], a[36:39], v[56:59]
v_exp_f32 v78, v78
v_mfma_f32_16x16x32_bf16 v[60:63], a[108:111], a[4:7], v[60:63]
v_exp_f32 v79, v79
v_exp_f32 v88, v88
buffer_load_dwordx4 v29, s[32:35], s94 offen offset:1024 nt lds
v_mfma_f32_16x16x32_bf16 v[64:67], a[108:111], a[20:23], v[64:67]
v_exp_f32 v89, v89
v_mfma_f32_16x16x32_bf16 v[68:71], a[108:111], a[36:39], v[68:71]
v_exp_f32 v90, v90
v_mfma_f32_16x16x32_bf16 v[48:51], a[112:115], a[8:11], v[48:51]
v_exp_f32 v91, v91
v_cvt_pk_bf16_f32 v96, v72, v73
v_mfma_f32_16x16x32_bf16 v[52:55], a[112:115], a[24:27], v[52:55]
v_cvt_pk_bf16_f32 v97, v74, v75
v_cvt_pk_bf16_f32 v98, v84, v85
v_mfma_f32_16x16x32_bf16 v[56:59], a[112:115], a[40:43], v[56:59]
v_cvt_pk_bf16_f32 v99, v86, v87
v_exp_f32 v80, v80
v_mfma_f32_16x16x32_bf16 v[60:63], a[116:119], a[8:11], v[60:63]
v_exp_f32 v81, v81
buffer_load_dwordx4 v28, s[32:35], s94 offen offset:2048 nt lds
v_mfma_f32_16x16x32_bf16 v[64:67], a[116:119], a[24:27], v[64:67]
v_exp_f32 v82, v82
v_mfma_f32_16x16x32_bf16 v[68:71], a[116:119], a[40:43], v[68:71]
v_exp_f32 v83, v83
v_exp_f32 v92, v92
v_mfma_f32_16x16x32_bf16 v[48:51], a[120:123], a[12:15], v[48:51]
v_exp_f32 v93, v93
v_mfma_f32_16x16x32_bf16 v[52:55], a[120:123], a[28:31], v[52:55]
v_exp_f32 v94, v94
v_mfma_f32_16x16x32_bf16 v[56:59], a[120:123], a[44:47], v[56:59]
v_exp_f32 v95, v95
v_cvt_pk_bf16_f32 v100, v76, v77
v_mfma_f32_16x16x32_bf16 v[60:63], a[124:127], a[12:15], v[60:63]
v_cvt_pk_bf16_f32 v101, v78, v79
v_cvt_pk_bf16_f32 v102, v88, v89
buffer_load_dwordx4 v29, s[32:35], s94 offen offset:3072 nt lds
v_mfma_f32_16x16x32_bf16 v[64:67], a[124:127], a[28:31], v[64:67]
v_cvt_pk_bf16_f32 v103, v90, v91
v_cvt_pk_bf16_f32 v104, v80, v81
v_cvt_pk_bf16_f32 v105, v82, v83
v_mfma_f32_16x16x32_bf16 v[68:71], a[124:127], a[44:47], v[68:71]
v_cvt_pk_bf16_f32 v106, v92, v93
v_cvt_pk_bf16_f32 v107, v94, v95
v_mfma_f32_16x16x32_bf16 a[160:163], a[128:131], v[96:99], a[160:163]
v_add_f32 v225, v225, v72
v_add_f32 v227, v227, v76
v_add_f32 v229, v229, v80
v_mfma_f32_16x16x32_bf16 a[164:167], a[128:131], v[100:103], a[164:167]
v_add_f32 v225, v225, v73
v_add_f32 v227, v227, v77
v_mfma_f32_16x16x32_bf16 a[168:171], a[128:131], v[104:107], a[168:171]
v_add_f32 v229, v229, v81
v_add_f32 v225, v225, v74
v_add_f32 v227, v227, v78
v_mfma_f32_16x16x32_bf16 a[172:175], a[132:135], v[96:99], a[172:175]
v_add_f32 v229, v229, v82
v_add_f32 v225, v225, v75
s_add_u32 s85, s2, 0
s_and_b32 s85, s85, 3
s_lshl_b32 s85, s85, 15
s_add_u32 s85, s85, s93
s_add_u32 m0, s77, 16384
s_add_u32 s94, s85, 0
buffer_load_dwordx4 v218, s[44:47], s94 offen offset:0 lds
v_mfma_f32_16x16x32_bf16 a[176:179], a[132:135], v[100:103], a[176:179]
v_add_f32 v227, v227, v79
v_add_f32 v229, v229, v83
v_add_f32 v225, v225, v84
v_mfma_f32_16x16x32_bf16 a[180:183], a[132:135], v[104:107], a[180:183]
v_add_f32 v227, v227, v88
v_add_f32 v229, v229, v92
v_mfma_f32_16x16x32_bf16 a[184:187], a[136:139], v[96:99], a[184:187]
v_add_f32 v225, v225, v85
v_add_f32 v227, v227, v89
v_add_f32 v229, v229, v93
v_mfma_f32_16x16x32_bf16 a[188:191], a[136:139], v[100:103], a[188:191]
v_add_f32 v225, v225, v86
v_add_f32 v227, v227, v90
v_mfma_f32_16x16x32_bf16 a[192:195], a[136:139], v[104:107], a[192:195]
v_add_f32 v229, v229, v94
v_add_f32 v225, v225, v87
v_add_f32 v227, v227, v91
v_mfma_f32_16x16x32_bf16 a[196:199], a[140:143], v[96:99], a[196:199]
v_add_f32 v229, v229, v95
v_fma_f32 v48, v48, s89, -v30
s_add_u32 s94, s85, 3072
buffer_load_dwordx4 v219, s[44:47], s94 offen offset:1024 lds
v_mfma_f32_16x16x32_bf16 a[200:203], a[140:143], v[100:103], a[200:203]
v_fma_f32 v49, v49, s89, -v30
v_fma_f32 v50, v50, s89, -v30
v_fma_f32 v51, v51, s89, -v30
v_mfma_f32_16x16x32_bf16 a[204:207], a[140:143], v[104:107], a[204:207]
v_fma_f32 v52, v52, s89, -v32
v_fma_f32 v53, v53, s89, -v32
v_fma_f32 v54, v54, s89, -v32
v_mfma_f32_16x16x32_bf16 a[208:211], a[144:147], v[96:99], a[208:211]
v_fma_f32 v55, v55, s89, -v32
v_fma_f32 v56, v56, s89, -v34
v_mfma_f32_16x16x32_bf16 a[212:215], a[144:147], v[100:103], a[212:215]
v_fma_f32 v57, v57, s89, -v34
v_fma_f32 v58, v58, s89, -v34
v_fma_f32 v59, v59, s89, -v34
v_mfma_f32_16x16x32_bf16 a[216:219], a[144:147], v[104:107], a[216:219]
v_fma_f32 v60, v60, s89, -v30
v_fma_f32 v61, v61, s89, -v30
v_mfma_f32_16x16x32_bf16 a[220:223], a[148:151], v[96:99], a[220:223]
v_fma_f32 v62, v62, s89, -v30
v_fma_f32 v63, v63, s89, -v30
v_fma_f32 v64, v64, s89, -v32
s_add_u32 s94, s85, 6144
buffer_load_dwordx4 v218, s[44:47], s94 offen offset:2048 lds
v_mfma_f32_16x16x32_bf16 a[224:227], a[148:151], v[100:103], a[224:227]
v_fma_f32 v65, v65, s89, -v32
v_fma_f32 v66, v66, s89, -v32
v_mfma_f32_16x16x32_bf16 a[228:231], a[148:151], v[104:107], a[228:231]
v_fma_f32 v67, v67, s89, -v32
v_fma_f32 v68, v68, s89, -v34
v_fma_f32 v69, v69, s89, -v34
v_mfma_f32_16x16x32_bf16 a[232:235], a[152:155], v[96:99], a[232:235]
v_fma_f32 v70, v70, s89, -v34
v_fma_f32 v71, v71, s89, -v34
v_mfma_f32_16x16x32_bf16 a[236:239], a[152:155], v[100:103], a[236:239]
v_max3_f32 v36, v48, v49, v50
v_max3_f32 v37, v52, v53, v54
v_max3_f32 v38, v56, v57, v58
v_mfma_f32_16x16x32_bf16 a[240:243], a[152:155], v[104:107], a[240:243]
v_max3_f32 v36, v36, v51, v60
v_max3_f32 v37, v37, v55, v64
v_mfma_f32_16x16x32_bf16 a[244:247], a[156:159], v[96:99], a[244:247]
v_max3_f32 v38, v38, v59, v68
v_max3_f32 v36, v36, v61, v62
v_max3_f32 v37, v37, v65, v66
s_add_u32 s94, s85, 9216
buffer_load_dwordx4 v219, s[44:47], s94 offen offset:3072 lds
v_mfma_f32_16x16x32_bf16 a[248:251], a[156:159], v[100:103], a[248:251]
v_max3_f32 v38, v38, v69, v70
v_max_f32 v36, v36, v63
v_mfma_f32_16x16x32_bf16 a[252:255], a[156:159], v[104:107], a[252:255]
v_max_f32 v37, v37, v67
v_max_f32 v38, v38, v71
v_max3_f32 v39, v36, v37, v38
v_cmp_lt_f32 vcc, s87, v39
s_cbranch_vccz L_fast8
s_call_b64 s[90:91], L_rescale0
L_fast8:
v_mfma_f32_16x16x32_bf16 v[72:75], a[96:99], a[48:51], 0
v_exp_f32 v48, v48
v_mfma_f32_16x16x32_bf16 v[76:79], a[96:99], a[64:67], 0
v_exp_f32 v49, v49
v_exp_f32 v50, v50
v_mfma_f32_16x16x32_bf16 v[80:83], a[96:99], a[80:83], 0
v_exp_f32 v51, v51
v_mfma_f32_16x16x32_bf16 v[84:87], a[100:103], a[48:51], 0
v_exp_f32 v60, v60
s_add_u32 m0, s77, 20480
s_add_u32 s94, s85, 16384
buffer_load_dwordx4 v218, s[44:47], s94 offen offset:0 lds
v_mfma_f32_16x16x32_bf16 v[88:91], a[100:103], a[64:67], 0
v_exp_f32 v61, v61
v_mfma_f32_16x16x32_bf16 v[92:95], a[100:103], a[80:83], 0
v_exp_f32 v62, v62
v_exp_f32 v63, v63
v_mfma_f32_16x16x32_bf16 v[72:75], a[104:107], a[52:55], v[72:75]
v_exp_f32 v52, v52
v_mfma_f32_16x16x32_bf16 v[76:79], a[104:107], a[68:71], v[76:79]
v_exp_f32 v53, v53
v_mfma_f32_16x16x32_bf16 v[80:83], a[104:107], a[84:87], v[80:83]
v_exp_f32 v54, v54
v_mfma_f32_16x16x32_bf16 v[84:87], a[108:111], a[52:55], v[84:87]
v_exp_f32 v55, v55
v_exp_f32 v64, v64
s_add_u32 s94, s85, 19456
buffer_load_dwordx4 v219, s[44:47], s94 offen offset:1024 lds
v_mfma_f32_16x16x32_bf16 v[88:91], a[108:111], a[68:71], v[88:91]
v_exp_f32 v65, v65
v_mfma_f32_16x16x32_bf16 v[92:95], a[108:111], a[84:87], v[92:95]
v_exp_f32 v66, v66
s_waitcnt vmcnt(22)
ds_read_b64_tr_b16 a[128:129], v16 offset:24576
ds_read_b64_tr_b16 a[130:131], v16 offset:28672
ds_read_b64_tr_b16 a[132:133], v17 offset:24576
ds_read_b64_tr_b16 a[134:135], v17 offset:28672
ds_read_b64_tr_b16 a[136:137], v18 offset:24576
ds_read_b64_tr_b16 a[138:139], v18 offset:28672
ds_read_b64_tr_b16 a[140:141], v19 offset:24576
ds_read_b64_tr_b16 a[142:143], v19 offset:28672
ds_read_b64_tr_b16 a[144:145], v20 offset:24576
ds_read_b64_tr_b16 a[146:147], v20 offset:28672
ds_read_b64_tr_b16 a[148:149], v21 offset:24576
ds_read_b64_tr_b16 a[150:151], v21 offset:28672
ds_read_b64_tr_b16 a[152:153], v22 offset:24576
ds_read_b64_tr_b16 a[154:155], v22 offset:28672
ds_read_b64_tr_b16 a[156:157], v23 offset:24576
ds_read_b64_tr_b16 a[158:159], v23 offset:28672
v_mfma_f32_16x16x32_bf16 v[72:75], a[112:115], a[56:59], v[72:75]
v_exp_f32 v67, v67
v_cvt_pk_bf16_f32 v96, v48, v49
v_mfma_f32_16x16x32_bf16 v[76:79], a[112:115], a[72:75], v[76:79]
v_cvt_pk_bf16_f32 v97, v50, v51
v_cvt_pk_bf16_f32 v98, v60, v61
v_mfma_f32_16x16x32_bf16 v[80:83], a[112:115], a[88:91], v[80:83]
v_cvt_pk_bf16_f32 v99, v62, v63
v_exp_f32 v56, v56
v_mfma_f32_16x16x32_bf16 v[84:87], a[116:119], a[56:59], v[84:87]
v_exp_f32 v57, v57
s_add_u32 s94, s85, 22528
buffer_load_dwordx4 v218, s[44:47], s94 offen offset:2048 lds
v_mfma_f32_16x16x32_bf16 v[88:91], a[116:119], a[72:75], v[88:91]
v_exp_f32 v58, v58
v_mfma_f32_16x16x32_bf16 v[92:95], a[116:119], a[88:91], v[92:95]
v_exp_f32 v59, v59
v_exp_f32 v68, v68
v_mfma_f32_16x16x32_bf16 v[72:75], a[120:123], a[60:63], v[72:75]
v_exp_f32 v69, v69
v_mfma_f32_16x16x32_bf16 v[76:79], a[120:123], a[76:79], v[76:79]
v_exp_f32 v70, v70
v_mfma_f32_16x16x32_bf16 v[80:83], a[120:123], a[92:95], v[80:83]
v_exp_f32 v71, v71
v_cvt_pk_bf16_f32 v100, v52, v53
v_mfma_f32_16x16x32_bf16 v[84:87], a[124:127], a[60:63], v[84:87]
v_cvt_pk_bf16_f32 v101, v54, v55
v_cvt_pk_bf16_f32 v102, v64, v65
s_add_u32 s94, s85, 25600
buffer_load_dwordx4 v219, s[44:47], s94 offen offset:3072 lds
v_mfma_f32_16x16x32_bf16 v[88:91], a[124:127], a[76:79], v[88:91]
v_cvt_pk_bf16_f32 v103, v66, v67
v_cvt_pk_bf16_f32 v104, v56, v57
v_cvt_pk_bf16_f32 v105, v58, v59
v_mfma_f32_16x16x32_bf16 v[92:95], a[124:127], a[92:95], v[92:95]
v_cvt_pk_bf16_f32 v106, v68, v69
v_cvt_pk_bf16_f32 v107, v70, v71
s_waitcnt lgkmcnt(0)
v_mfma_f32_16x16x32_bf16 v[120:123], a[128:131], v[96:99], v[120:123]
v_add_f32 v31, v31, v48
v_add_f32 v33, v33, v52
v_add_f32 v35, v35, v56
v_mfma_f32_16x16x32_bf16 v[124:127], a[128:131], v[100:103], v[124:127]
v_add_f32 v31, v31, v49
v_add_f32 v33, v33, v53
v_mfma_f32_16x16x32_bf16 v[128:131], a[128:131], v[104:107], v[128:131]
v_add_f32 v35, v35, v57
v_add_f32 v31, v31, v50
v_add_f32 v33, v33, v54
v_mfma_f32_16x16x32_bf16 v[132:135], a[132:135], v[96:99], v[132:135]
v_add_f32 v35, v35, v58
v_add_f32 v31, v31, v51
s_add_u32 s85, s2, 1
s_and_b32 s85, s85, 3
s_lshl_b32 s85, s85, 15
s_add_u32 s85, s85, s93
s_add_u32 m0, s77, 24576
s_add_u32 s94, s85, 0
buffer_load_dwordx4 v218, s[44:47], s94 offen offset:0 lds
v_mfma_f32_16x16x32_bf16 v[136:139], a[132:135], v[100:103], v[136:139]
v_add_f32 v33, v33, v55
v_add_f32 v35, v35, v59
v_add_f32 v31, v31, v60
v_mfma_f32_16x16x32_bf16 v[140:143], a[132:135], v[104:107], v[140:143]
v_add_f32 v33, v33, v64
v_add_f32 v35, v35, v68
v_mfma_f32_16x16x32_bf16 v[144:147], a[136:139], v[96:99], v[144:147]
v_add_f32 v31, v31, v61
v_add_f32 v33, v33, v65
v_add_f32 v35, v35, v69
v_mfma_f32_16x16x32_bf16 v[148:151], a[136:139], v[100:103], v[148:151]
v_add_f32 v31, v31, v62
v_add_f32 v33, v33, v66
v_mfma_f32_16x16x32_bf16 v[152:155], a[136:139], v[104:107], v[152:155]
v_add_f32 v35, v35, v70
v_add_f32 v31, v31, v63
v_add_f32 v33, v33, v67
v_mfma_f32_16x16x32_bf16 v[156:159], a[140:143], v[96:99], v[156:159]
v_add_f32 v35, v35, v71
v_fma_f32 v72, v72, s89, -v224
s_add_u32 s94, s85, 3072
buffer_load_dwordx4 v219, s[44:47], s94 offen offset:1024 lds
v_mfma_f32_16x16x32_bf16 v[160:163], a[140:143], v[100:103], v[160:163]
v_fma_f32 v73, v73, s89, -v224
v_fma_f32 v74, v74, s89, -v224
v_fma_f32 v75, v75, s89, -v224
v_mfma_f32_16x16x32_bf16 v[164:167], a[140:143], v[104:107], v[164:167]
v_fma_f32 v76, v76, s89, -v226
v_fma_f32 v77, v77, s89, -v226
v_fma_f32 v78, v78, s89, -v226
s_waitcnt vmcnt(18)
ds_read_b128 a[96:99], v24 offset:0
ds_read_b128 a[100:103], v24 offset:4096
ds_read_b128 a[104:107], v25 offset:0
ds_read_b128 a[108:111], v25 offset:4096
ds_read_b128 a[112:115], v26 offset:0
ds_read_b128 a[116:119], v26 offset:4096
ds_read_b128 a[120:123], v27 offset:0
ds_read_b128 a[124:127], v27 offset:4096
v_mfma_f32_16x16x32_bf16 v[168:171], a[144:147], v[96:99], v[168:171]
v_fma_f32 v79, v79, s89, -v226
v_fma_f32 v80, v80, s89, -v228
v_mfma_f32_16x16x32_bf16 v[172:175], a[144:147], v[100:103], v[172:175]
v_fma_f32 v81, v81, s89, -v228
v_fma_f32 v82, v82, s89, -v228
v_fma_f32 v83, v83, s89, -v228
v_mfma_f32_16x16x32_bf16 v[176:179], a[144:147], v[104:107], v[176:179]
v_fma_f32 v84, v84, s89, -v224
v_fma_f32 v85, v85, s89, -v224
v_mfma_f32_16x16x32_bf16 v[180:183], a[148:151], v[96:99], v[180:183]
v_fma_f32 v86, v86, s89, -v224
v_fma_f32 v87, v87, s89, -v224
v_fma_f32 v88, v88, s89, -v226
s_add_u32 s94, s85, 6144
buffer_load_dwordx4 v218, s[44:47], s94 offen offset:2048 lds
v_mfma_f32_16x16x32_bf16 v[184:187], a[148:151], v[100:103], v[184:187]
v_fma_f32 v89, v89, s89, -v226
v_fma_f32 v90, v90, s89, -v226
v_mfma_f32_16x16x32_bf16 v[188:191], a[148:151], v[104:107], v[188:191]
v_fma_f32 v91, v91, s89, -v226
v_fma_f32 v92, v92, s89, -v228
v_fma_f32 v93, v93, s89, -v228
v_mfma_f32_16x16x32_bf16 v[192:195], a[152:155], v[96:99], v[192:195]
v_fma_f32 v94, v94, s89, -v228
v_fma_f32 v95, v95, s89, -v228
v_mfma_f32_16x16x32_bf16 v[196:199], a[152:155], v[100:103], v[196:199]
v_max3_f32 v36, v72, v73, v74
v_max3_f32 v37, v76, v77, v78
v_max3_f32 v38, v80, v81, v82
v_mfma_f32_16x16x32_bf16 v[200:203], a[152:155], v[104:107], v[200:203]
v_max3_f32 v36, v36, v75, v84
v_max3_f32 v37, v37, v79, v88
v_mfma_f32_16x16x32_bf16 v[204:207], a[156:159], v[96:99], v[204:207]
v_max3_f32 v38, v38, v83, v92
v_max3_f32 v36, v36, v85, v86
v_max3_f32 v37, v37, v89, v90
s_add_u32 s94, s85, 9216
buffer_load_dwordx4 v219, s[44:47], s94 offen offset:3072 lds
v_mfma_f32_16x16x32_bf16 v[208:211], a[156:159], v[100:103], v[208:211]
v_max3_f32 v38, v38, v93, v94
v_max_f32 v36, v36, v87
v_mfma_f32_16x16x32_bf16 v[212:215], a[156:159], v[104:107], v[212:215]
v_max_f32 v37, v37, v91
v_max_f32 v38, v38, v95
v_max3_f32 v39, v36, v37, v38
v_cmp_lt_f32 vcc, s11, v39
s_cbranch_vccz L_fast9
s_call_b64 s[90:91], L_rescaleJ1
L_fast9:
s_waitcnt lgkmcnt(0)
v_mfma_f32_16x16x32_bf16 v[48:51], a[96:99], a[0:3], 0
v_exp_f32 v72, v72
v_mfma_f32_16x16x32_bf16 v[52:55], a[96:99], a[16:19], 0
v_exp_f32 v73, v73
v_exp_f32 v74, v74
v_mfma_f32_16x16x32_bf16 v[56:59], a[96:99], a[32:35], 0
v_exp_f32 v75, v75
v_mfma_f32_16x16x32_bf16 v[60:63], a[100:103], a[0:3], 0
v_exp_f32 v84, v84
s_add_u32 m0, s77, 28672
s_add_u32 s94, s85, 16384
buffer_load_dwordx4 v218, s[44:47], s94 offen offset:0 lds
v_mfma_f32_16x16x32_bf16 v[64:67], a[100:103], a[16:19], 0
v_exp_f32 v85, v85
v_mfma_f32_16x16x32_bf16 v[68:71], a[100:103], a[32:35], 0
v_exp_f32 v86, v86
v_exp_f32 v87, v87
v_mfma_f32_16x16x32_bf16 v[48:51], a[104:107], a[4:7], v[48:51]
v_exp_f32 v76, v76
v_mfma_f32_16x16x32_bf16 v[52:55], a[104:107], a[20:23], v[52:55]
v_exp_f32 v77, v77
v_mfma_f32_16x16x32_bf16 v[56:59], a[104:107], a[36:39], v[56:59]
v_exp_f32 v78, v78
v_mfma_f32_16x16x32_bf16 v[60:63], a[108:111], a[4:7], v[60:63]
v_exp_f32 v79, v79
v_exp_f32 v88, v88
s_add_u32 s94, s85, 19456
buffer_load_dwordx4 v219, s[44:47], s94 offen offset:1024 lds
v_mfma_f32_16x16x32_bf16 v[64:67], a[108:111], a[20:23], v[64:67]
v_exp_f32 v89, v89
v_mfma_f32_16x16x32_bf16 v[68:71], a[108:111], a[36:39], v[68:71]
v_exp_f32 v90, v90
v_mfma_f32_16x16x32_bf16 v[48:51], a[112:115], a[8:11], v[48:51]
v_exp_f32 v91, v91
v_cvt_pk_bf16_f32 v96, v72, v73
v_mfma_f32_16x16x32_bf16 v[52:55], a[112:115], a[24:27], v[52:55]
v_cvt_pk_bf16_f32 v97, v74, v75
v_cvt_pk_bf16_f32 v98, v84, v85
v_mfma_f32_16x16x32_bf16 v[56:59], a[112:115], a[40:43], v[56:59]
v_cvt_pk_bf16_f32 v99, v86, v87
v_exp_f32 v80, v80
v_mfma_f32_16x16x32_bf16 v[60:63], a[116:119], a[8:11], v[60:63]
v_exp_f32 v81, v81
s_add_u32 s94, s85, 22528
buffer_load_dwordx4 v218, s[44:47], s94 offen offset:2048 lds
v_mfma_f32_16x16x32_bf16 v[64:67], a[116:119], a[24:27], v[64:67]
v_exp_f32 v82, v82
v_mfma_f32_16x16x32_bf16 v[68:71], a[116:119], a[40:43], v[68:71]
v_exp_f32 v83, v83
v_exp_f32 v92, v92
v_mfma_f32_16x16x32_bf16 v[48:51], a[120:123], a[12:15], v[48:51]
v_exp_f32 v93, v93
v_mfma_f32_16x16x32_bf16 v[52:55], a[120:123], a[28:31], v[52:55]
v_exp_f32 v94, v94
v_mfma_f32_16x16x32_bf16 v[56:59], a[120:123], a[44:47], v[56:59]
v_exp_f32 v95, v95
v_cvt_pk_bf16_f32 v100, v76, v77
v_mfma_f32_16x16x32_bf16 v[60:63], a[124:127], a[12:15], v[60:63]
v_cvt_pk_bf16_f32 v101, v78, v79
v_cvt_pk_bf16_f32 v102, v88, v89
s_add_u32 s94, s85, 25600
buffer_load_dwordx4 v219, s[44:47], s94 offen offset:3072 lds
v_mfma_f32_16x16x32_bf16 v[64:67], a[124:127], a[28:31], v[64:67]
v_cvt_pk_bf16_f32 v103, v90, v91
v_cvt_pk_bf16_f32 v104, v80, v81
v_cvt_pk_bf16_f32 v105, v82, v83
v_mfma_f32_16x16x32_bf16 v[68:71], a[124:127], a[44:47], v[68:71]
v_cvt_pk_bf16_f32 v106, v92, v93
v_cvt_pk_bf16_f32 v107, v94, v95
v_mfma_f32_16x16x32_bf16 a[160:163], a[128:131], v[96:99], a[160:163]
v_add_f32 v225, v225, v72
v_add_f32 v227, v227, v76
v_add_f32 v229, v229, v80
v_mfma_f32_16x16x32_bf16 a[164:167], a[128:131], v[100:103], a[164:167]
v_add_f32 v225, v225, v73
v_add_f32 v227, v227, v77
v_mfma_f32_16x16x32_bf16 a[168:171], a[128:131], v[104:107], a[168:171]
v_add_f32 v229, v229, v81
v_add_f32 v225, v225, v74
v_add_f32 v227, v227, v78
v_mfma_f32_16x16x32_bf16 a[172:175], a[132:135], v[96:99], a[172:175]
v_add_f32 v229, v229, v82
v_add_f32 v225, v225, v75
v_mfma_f32_16x16x32_bf16 a[176:179], a[132:135], v[100:103], a[176:179]
v_add_f32 v227, v227, v79
v_add_f32 v229, v229, v83
v_add_f32 v225, v225, v84
v_mfma_f32_16x16x32_bf16 a[180:183], a[132:135], v[104:107], a[180:183]
v_add_f32 v227, v227, v88
v_add_f32 v229, v229, v92
v_mfma_f32_16x16x32_bf16 a[184:187], a[136:139], v[96:99], a[184:187]
v_add_f32 v225, v225, v85
v_add_f32 v227, v227, v89
v_add_f32 v229, v229, v93
v_mfma_f32_16x16x32_bf16 a[188:191], a[136:139], v[100:103], a[188:191]
v_add_f32 v225, v225, v86
v_add_f32 v227, v227, v90
v_mfma_f32_16x16x32_bf16 a[192:195], a[136:139], v[104:107], a[192:195]
v_add_f32 v229, v229, v94
v_add_f32 v225, v225, v87
v_add_f32 v227, v227, v91
v_mfma_f32_16x16x32_bf16 a[196:199], a[140:143], v[96:99], a[196:199]
v_add_f32 v229, v229, v95
v_fma_f32 v48, v48, s89, -v30
v_mfma_f32_16x16x32_bf16 a[200:203], a[140:143], v[100:103], a[200:203]
v_fma_f32 v49, v49, s89, -v30
v_fma_f32 v50, v50, s89, -v30
v_fma_f32 v51, v51, s89, -v30
v_mfma_f32_16x16x32_bf16 a[204:207], a[140:143], v[104:107], a[204:207]
v_fma_f32 v52, v52, s89, -v32
v_fma_f32 v53, v53, s89, -v32
v_fma_f32 v54, v54, s89, -v32
v_mfma_f32_16x16x32_bf16 a[208:211], a[144:147], v[96:99], a[208:211]
v_fma_f32 v55, v55, s89, -v32
v_fma_f32 v56, v56, s89, -v34
v_mfma_f32_16x16x32_bf16 a[212:215], a[144:147], v[100:103], a[212:215]
v_fma_f32 v57, v57, s89, -v34
v_fma_f32 v58, v58, s89, -v34
v_fma_f32 v59, v59, s89, -v34
v_mfma_f32_16x16x32_bf16 a[216:219], a[144:147], v[104:107], a[216:219]
v_fma_f32 v60, v60, s89, -v30
v_fma_f32 v61, v61, s89, -v30
v_mfma_f32_16x16x32_bf16 a[220:223], a[148:151], v[96:99], a[220:223]
v_fma_f32 v62, v62, s89, -v30
v_fma_f32 v63, v63, s89, -v30
v_fma_f32 v64, v64, s89, -v32
v_mfma_f32_16x16x32_bf16 a[224:227], a[148:151], v[100:103], a[224:227]
v_fma_f32 v65, v65, s89, -v32
v_fma_f32 v66, v66, s89, -v32
v_mfma_f32_16x16x32_bf16 a[228:231], a[148:151], v[104:107], a[228:231]
v_fma_f32 v67, v67, s89, -v32
v_fma_f32 v68, v68, s89, -v34
v_fma_f32 v69, v69, s89, -v34
v_mfma_f32_16x16x32_bf16 a[232:235], a[152:155], v[96:99], a[232:235]
v_fma_f32 v70, v70, s89, -v34
v_fma_f32 v71, v71, s89, -v34
v_mfma_f32_16x16x32_bf16 a[236:239], a[152:155], v[100:103], a[236:239]
v_max3_f32 v36, v48, v49, v50
v_max3_f32 v37, v52, v53, v54
v_max3_f32 v38, v56, v57, v58
v_mfma_f32_16x16x32_bf16 a[240:243], a[152:155], v[104:107], a[240:243]
v_max3_f32 v36, v36, v51, v60
v_max3_f32 v37, v37, v55, v64
v_mfma_f32_16x16x32_bf16 a[244:247], a[156:159], v[96:99], a[244:247]
v_max3_f32 v38, v38, v59, v68
v_max3_f32 v36, v36, v61, v62
v_max3_f32 v37, v37, v65, v66
v_mfma_f32_16x16x32_bf16 a[248:251], a[156:159], v[100:103], a[248:251]
v_max3_f32 v38, v38, v69, v70
v_max_f32 v36, v36, v63
v_mfma_f32_16x16x32_bf16 a[252:255], a[156:159], v[104:107], a[252:255]
v_max_f32 v37, v37, v67
v_max_f32 v38, v38, v71
v_max3_f32 v39, v36, v37, v38
v_cmp_lt_f32 vcc, s87, v39
s_cbranch_vccz L_fast10
s_call_b64 s[90:91], L_rescale0
L_fast10:
v_mfma_f32_16x16x32_bf16 v[72:75], a[96:99], a[48:51], 0
v_exp_f32 v48, v48
v_mfma_f32_16x16x32_bf16 v[76:79], a[96:99], a[64:67], 0
v_exp_f32 v49, v49
v_exp_f32 v50, v50
v_mfma_f32_16x16x32_bf16 v[80:83], a[96:99], a[80:83], 0
v_exp_f32 v51, v51
v_mfma_f32_16x16x32_bf16 v[84:87], a[100:103], a[48:51], 0
v_exp_f32 v60, v60
v_mfma_f32_16x16x32_bf16 v[88:91], a[100:103], a[64:67], 0
v_exp_f32 v61, v61
v_mfma_f32_16x16x32_bf16 v[92:95], a[100:103], a[80:83], 0
v_exp_f32 v62, v62
v_exp_f32 v63, v63
v_mfma_f32_16x16x32_bf16 v[72:75], a[104:107], a[52:55], v[72:75]
v_exp_f32 v52, v52
v_mfma_f32_16x16x32_bf16 v[76:79], a[104:107], a[68:71], v[76:79]
v_exp_f32 v53, v53
v_mfma_f32_16x16x32_bf16 v[80:83], a[104:107], a[84:87], v[80:83]
v_exp_f32 v54, v54
v_mfma_f32_16x16x32_bf16 v[84:87], a[108:111], a[52:55], v[84:87]
v_exp_f32 v55, v55
v_exp_f32 v64, v64
v_mfma_f32_16x16x32_bf16 v[88:91], a[108:111], a[68:71], v[88:91]
v_exp_f32 v65, v65
v_mfma_f32_16x16x32_bf16 v[92:95], a[108:111], a[84:87], v[92:95]
v_exp_f32 v66, v66
s_waitcnt vmcnt(16)
ds_read_b64_tr_b16 a[128:129], v16 offset:8192
ds_read_b64_tr_b16 a[130:131], v16 offset:12288
ds_read_b64_tr_b16 a[132:133], v17 offset:8192
ds_read_b64_tr_b16 a[134:135], v17 offset:12288
ds_read_b64_tr_b16 a[136:137], v18 offset:8192
ds_read_b64_tr_b16 a[138:139], v18 offset:12288
ds_read_b64_tr_b16 a[140:141], v19 offset:8192
ds_read_b64_tr_b16 a[142:143], v19 offset:12288
ds_read_b64_tr_b16 a[144:145], v20 offset:8192
ds_read_b64_tr_b16 a[146:147], v20 offset:12288
ds_read_b64_tr_b16 a[148:149], v21 offset:8192
ds_read_b64_tr_b16 a[150:151], v21 offset:12288
ds_read_b64_tr_b16 a[152:153], v22 offset:8192
ds_read_b64_tr_b16 a[154:155], v22 offset:12288
ds_read_b64_tr_b16 a[156:157], v23 offset:8192
ds_read_b64_tr_b16 a[158:159], v23 offset:12288
v_mfma_f32_16x16x32_bf16 v[72:75], a[112:115], a[56:59], v[72:75]
v_exp_f32 v67, v67
v_cvt_pk_bf16_f32 v96, v48, v49
v_mfma_f32_16x16x32_bf16 v[76:79], a[112:115], a[72:75], v[76:79]
v_cvt_pk_bf16_f32 v97, v50, v51
v_cvt_pk_bf16_f32 v98, v60, v61
v_mfma_f32_16x16x32_bf16 v[80:83], a[112:115], a[88:91], v[80:83]
v_cvt_pk_bf16_f32 v99, v62, v63
v_exp_f32 v56, v56
v_mfma_f32_16x16x32_bf16 v[84:87], a[116:119], a[56:59], v[84:87]
v_exp_f32 v57, v57
v_mfma_f32_16x16x32_bf16 v[88:91], a[116:119], a[72:75], v[88:91]
v_exp_f32 v58, v58
v_mfma_f32_16x16x32_bf16 v[92:95], a[116:119], a[88:91], v[92:95]
v_exp_f32 v59, v59
v_exp_f32 v68, v68
v_mfma_f32_16x16x32_bf16 v[72:75], a[120:123], a[60:63], v[72:75]
v_exp_f32 v69, v69
v_mfma_f32_16x16x32_bf16 v[76:79], a[120:123], a[76:79], v[76:79]
v_exp_f32 v70, v70
v_mfma_f32_16x16x32_bf16 v[80:83], a[120:123], a[92:95], v[80:83]
v_exp_f32 v71, v71
v_cvt_pk_bf16_f32 v100, v52, v53
v_mfma_f32_16x16x32_bf16 v[84:87], a[124:127], a[60:63], v[84:87]
v_cvt_pk_bf16_f32 v101, v54, v55
v_cvt_pk_bf16_f32 v102, v64, v65
v_mfma_f32_16x16x32_bf16 v[88:91], a[124:127], a[76:79], v[88:91]
v_cvt_pk_bf16_f32 v103, v66, v67
v_cvt_pk_bf16_f32 v104, v56, v57
v_cvt_pk_bf16_f32 v105, v58, v59
v_mfma_f32_16x16x32_bf16 v[92:95], a[124:127], a[92:95], v[92:95]
v_cvt_pk_bf16_f32 v106, v68, v69
v_cvt_pk_bf16_f32 v107, v70, v71
s_waitcnt lgkmcnt(0)
v_mfma_f32_16x16x32_bf16 v[120:123], a[128:131], v[96:99], v[120:123]
v_add_f32 v31, v31, v48
v_add_f32 v33, v33, v52
v_add_f32 v35, v35, v56
v_mfma_f32_16x16x32_bf16 v[124:127], a[128:131], v[100:103], v[124:127]
v_add_f32 v31, v31, v49
v_add_f32 v33, v33, v53
v_mfma_f32_16x16x32_bf16 v[128:131], a[128:131], v[104:107], v[128:131]
v_add_f32 v35, v35, v57
v_add_f32 v31, v31, v50
v_add_f32 v33, v33, v54
v_mfma_f32_16x16x32_bf16 v[132:135], a[132:135], v[96:99], v[132:135]
v_add_f32 v35, v35, v58
v_add_f32 v31, v31, v51
v_mfma_f32_16x16x32_bf16 v[136:139], a[132:135], v[100:103], v[136:139]
v_add_f32 v33, v33, v55
v_add_f32 v35, v35, v59
v_add_f32 v31, v31, v60
v_mfma_f32_16x16x32_bf16 v[140:143], a[132:135], v[104:107], v[140:143]
v_add_f32 v33, v33, v64
v_add_f32 v35, v35, v68
v_mfma_f32_16x16x32_bf16 v[144:147], a[136:139], v[96:99], v[144:147]
v_add_f32 v31, v31, v61
v_add_f32 v33, v33, v65
v_add_f32 v35, v35, v69
v_mfma_f32_16x16x32_bf16 v[148:151], a[136:139], v[100:103], v[148:151]
v_add_f32 v31, v31, v62
v_add_f32 v33, v33, v66
v_mfma_f32_16x16x32_bf16 v[152:155], a[136:139], v[104:107], v[152:155]
v_add_f32 v35, v35, v70
v_add_f32 v31, v31, v63
v_add_f32 v33, v33, v67
v_mfma_f32_16x16x32_bf16 v[156:159], a[140:143], v[96:99], v[156:159]
v_add_f32 v35, v35, v71
v_fma_f32 v72, v72, s89, -v224
v_mfma_f32_16x16x32_bf16 v[160:163], a[140:143], v[100:103], v[160:163]
v_fma_f32 v73, v73, s89, -v224
v_fma_f32 v74, v74, s89, -v224
v_fma_f32 v75, v75, s89, -v224
v_mfma_f32_16x16x32_bf16 v[164:167], a[140:143], v[104:107], v[164:167]
v_fma_f32 v76, v76, s89, -v226
v_fma_f32 v77, v77, s89, -v226
v_fma_f32 v78, v78, s89, -v226
v_mfma_f32_16x16x32_bf16 v[168:171], a[144:147], v[96:99], v[168:171]
v_fma_f32 v79, v79, s89, -v226
v_fma_f32 v80, v80, s89, -v228
v_mfma_f32_16x16x32_bf16 v[172:175], a[144:147], v[100:103], v[172:175]
v_fma_f32 v81, v81, s89, -v228
v_fma_f32 v82, v82, s89, -v228
v_fma_f32 v83, v83, s89, -v228
v_mfma_f32_16x16x32_bf16 v[176:179], a[144:147], v[104:107], v[176:179]
v_fma_f32 v84, v84, s89, -v224
v_fma_f32 v85, v85, s89, -v224
v_mfma_f32_16x16x32_bf16 v[180:183], a[148:151], v[96:99], v[180:183]
v_fma_f32 v86, v86, s89, -v224
v_fma_f32 v87, v87, s89, -v224
v_fma_f32 v88, v88, s89, -v226
v_mfma_f32_16x16x32_bf16 v[184:187], a[148:151], v[100:103], v[184:187]
v_fma_f32 v89, v89, s89, -v226
v_fma_f32 v90, v90, s89, -v226
v_mfma_f32_16x16x32_bf16 v[188:191], a[148:151], v[104:107], v[188:191]
v_fma_f32 v91, v91, s89, -v226
v_fma_f32 v92, v92, s89, -v228
v_fma_f32 v93, v93, s89, -v228
v_mfma_f32_16x16x32_bf16 v[192:195], a[152:155], v[96:99], v[192:195]
v_fma_f32 v94, v94, s89, -v228
v_fma_f32 v95, v95, s89, -v228
v_mfma_f32_16x16x32_bf16 v[196:199], a[152:155], v[100:103], v[196:199]
v_max3_f32 v36, v72, v73, v74
v_max3_f32 v37, v76, v77, v78
v_max3_f32 v38, v80, v81, v82
v_mfma_f32_16x16x32_bf16 v[200:203], a[152:155], v[104:107], v[200:203]
v_max3_f32 v36, v36, v75, v84
v_max3_f32 v37, v37, v79, v88
v_mfma_f32_16x16x32_bf16 v[204:207], a[156:159], v[96:99], v[204:207]
v_max3_f32 v38, v38, v83, v92
v_max3_f32 v36, v36, v85, v86
v_max3_f32 v37, v37, v89, v90
v_mfma_f32_16x16x32_bf16 v[208:211], a[156:159], v[100:103], v[208:211]
v_max3_f32 v38, v38, v93, v94
v_max_f32 v36, v36, v87
v_mfma_f32_16x16x32_bf16 v[212:215], a[156:159], v[104:107], v[212:215]
v_max_f32 v37, v37, v91
v_max_f32 v38, v38, v95
v_max3_f32 v39, v36, v37, v38
v_cmp_lt_f32 vcc, s11, v39
s_cbranch_vccz L_fast11
s_call_b64 s[90:91], L_rescaleJ1
L_fast11:
s_waitcnt lgkmcnt(0)
v_exp_f32 v72, v72
v_exp_f32 v73, v73
v_exp_f32 v74, v74
v_exp_f32 v75, v75
v_exp_f32 v84, v84
v_exp_f32 v85, v85
v_exp_f32 v86, v86
v_exp_f32 v87, v87
v_exp_f32 v76, v76
v_exp_f32 v77, v77
v_exp_f32 v78, v78
v_exp_f32 v79, v79
v_exp_f32 v88, v88
v_exp_f32 v89, v89
v_exp_f32 v90, v90
v_exp_f32 v91, v91
v_cvt_pk_bf16_f32 v96, v72, v73
v_cvt_pk_bf16_f32 v97, v74, v75
v_cvt_pk_bf16_f32 v98, v84, v85
v_cvt_pk_bf16_f32 v99, v86, v87
v_exp_f32 v80, v80
v_exp_f32 v81, v81
v_exp_f32 v82, v82
v_exp_f32 v83, v83
v_exp_f32 v92, v92
v_exp_f32 v93, v93
v_exp_f32 v94, v94
v_exp_f32 v95, v95
v_cvt_pk_bf16_f32 v100, v76, v77
v_cvt_pk_bf16_f32 v101, v78, v79
v_cvt_pk_bf16_f32 v102, v88, v89
v_cvt_pk_bf16_f32 v103, v90, v91
v_cvt_pk_bf16_f32 v104, v80, v81
v_cvt_pk_bf16_f32 v105, v82, v83
v_cvt_pk_bf16_f32 v106, v92, v93
v_cvt_pk_bf16_f32 v107, v94, v95
v_mfma_f32_16x16x32_bf16 a[160:163], a[128:131], v[96:99], a[160:163]
v_add_f32 v225, v225, v72
v_mfma_f32_16x16x32_bf16 a[164:167], a[128:131], v[100:103], a[164:167]
v_add_f32 v227, v227, v76
v_mfma_f32_16x16x32_bf16 a[168:171], a[128:131], v[104:107], a[168:171]
v_add_f32 v229, v229, v80
v_mfma_f32_16x16x32_bf16 a[172:175], a[132:135], v[96:99], a[172:175]
v_add_f32 v225, v225, v73
v_mfma_f32_16x16x32_bf16 a[176:179], a[132:135], v[100:103], a[176:179]
v_add_f32 v227, v227, v77
v_mfma_f32_16x16x32_bf16 a[180:183], a[132:135], v[104:107], a[180:183]
v_add_f32 v229, v229, v81
v_mfma_f32_16x16x32_bf16 a[184:187], a[136:139], v[96:99], a[184:187]
v_add_f32 v225, v225, v74
v_mfma_f32_16x16x32_bf16 a[188:191], a[136:139], v[100:103], a[188:191]
v_add_f32 v227, v227, v78
v_mfma_f32_16x16x32_bf16 a[192:195], a[136:139], v[104:107], a[192:195]
v_add_f32 v229, v229, v82
v_mfma_f32_16x16x32_bf16 a[196:199], a[140:143], v[96:99], a[196:199]
v_add_f32 v225, v225, v75
v_mfma_f32_16x16x32_bf16 a[200:203], a[140:143], v[100:103], a[200:203]
v_add_f32 v227, v227, v79
v_mfma_f32_16x16x32_bf16 a[204:207], a[140:143], v[104:107], a[204:207]
v_add_f32 v229, v229, v83
v_mfma_f32_16x16x32_bf16 a[208:211], a[144:147], v[96:99], a[208:211]
v_add_f32 v225, v225, v84
v_mfma_f32_16x16x32_bf16 a[212:215], a[144:147], v[100:103], a[212:215]
v_add_f32 v227, v227, v88
v_mfma_f32_16x16x32_bf16 a[216:219], a[144:147], v[104:107], a[216:219]
v_add_f32 v229, v229, v92
v_mfma_f32_16x16x32_bf16 a[220:223], a[148:151], v[96:99], a[220:223]
v_add_f32 v225, v225, v85
v_mfma_f32_16x16x32_bf16 a[224:227], a[148:151], v[100:103], a[224:227]
v_add_f32 v227, v227, v89
v_mfma_f32_16x16x32_bf16 a[228:231], a[148:151], v[104:107], a[228:231]
v_add_f32 v229, v229, v93
v_mfma_f32_16x16x32_bf16 a[232:235], a[152:155], v[96:99], a[232:235]
v_add_f32 v225, v225, v86
v_mfma_f32_16x16x32_bf16 a[236:239], a[152:155], v[100:103], a[236:239]
v_add_f32 v227, v227, v90
v_mfma_f32_16x16x32_bf16 a[240:243], a[152:155], v[104:107], a[240:243]
v_add_f32 v229, v229, v94
v_mfma_f32_16x16x32_bf16 a[244:247], a[156:159], v[96:99], a[244:247]
v_add_f32 v225, v225, v87
v_mfma_f32_16x16x32_bf16 a[248:251], a[156:159], v[100:103], a[248:251]
v_add_f32 v227, v227, v91
v_mfma_f32_16x16x32_bf16 a[252:255], a[156:159], v[104:107], a[252:255]
v_add_f32 v229, v229, v95
v_mov_b32 v44, v31
v_mov_b32 v45, v33
v_mov_b32 v46, v35
s_nop 0
v_permlane32_swap_b32 v31, v44
v_permlane32_swap_b32 v33, v45
v_permlane32_swap_b32 v35, v46
s_nop 0
v_add_f32 v31, v31, v44
v_add_f32 v33, v33, v45
v_add_f32 v35, v35, v46
v_mov_b32 v44, v31
v_mov_b32 v45, v33
v_mov_b32 v46, v35
s_nop 0
v_permlane16_swap_b32 v31, v44
v_permlane16_swap_b32 v33, v45
v_permlane16_swap_b32 v35, v46
s_nop 0
v_add_f32 v31, v31, v44
v_add_f32 v33, v33, v45
v_add_f32 v35, v35, v46
v_mov_b32 v44, v225
v_mov_b32 v45, v227
v_mov_b32 v46, v229
s_nop 0
v_permlane32_swap_b32 v225, v44
v_permlane32_swap_b32 v227, v45
v_permlane32_swap_b32 v229, v46
s_nop 0
v_add_f32 v225, v225, v44
v_add_f32 v227, v227, v45
v_add_f32 v229, v229, v46
v_mov_b32 v44, v225
v_mov_b32 v45, v227
v_mov_b32 v46, v229
s_nop 0
v_permlane16_swap_b32 v225, v44
v_permlane16_swap_b32 v227, v45
v_permlane16_swap_b32 v229, v46
s_nop 0
v_add_f32 v225, v225, v44
v_add_f32 v227, v227, v45
v_add_f32 v229, v229, v46
v_and_b32 v36, 15, v0
v_lshlrev_b32 v36, 3, v36
s_lshl_b32 s79, s76, 13
s_add_u32 s79, s79, 137216
v_add_u32 v37, s79, v36
ds_write_b64 v37, v[30:31] offset:0
ds_write_b64 v37, v[224:225] offset:384
ds_write_b64 v37, v[32:33] offset:128
ds_write_b64 v37, v[226:227] offset:512
ds_write_b64 v37, v[34:35] offset:256
ds_write_b64 v37, v[228:229] offset:640
s_waitcnt lgkmcnt(0)
s_barrier
v_and_b32 v36, 15, v0
v_lshlrev_b32 v36, 3, v36
s_sub_u32 s79, s76, 0
s_and_b32 s79, s79, 3
s_lshl_b32 s79, s79, 13
s_add_u32 s79, s79, 137216
v_add_u32 v37, s79, v36
s_sub_u32 s79, s76, 1
s_and_b32 s79, s79, 3
s_lshl_b32 s79, s79, 13
s_add_u32 s79, s79, 137216
v_add_u32 v38, s79, v36
s_sub_u32 s79, s76, 2
s_and_b32 s79, s79, 3
s_lshl_b32 s79, s79, 13
s_add_u32 s79, s79, 137216
v_add_u32 v39, s79, v36
s_sub_u32 s79, s76, 3
s_and_b32 s79, s79, 3
s_lshl_b32 s79, s79, 13
s_add_u32 s79, s79, 137216
v_add_u32 v40, s79, v36
ds_read_b64 v[48:49], v37 offset:0
ds_read_b64 v[50:51], v37 offset:128
ds_read_b64 v[52:53], v37 offset:256
ds_read_b64 v[54:55], v38 offset:0
ds_read_b64 v[56:57], v38 offset:128
ds_read_b64 v[58:59], v38 offset:256
ds_read_b64 v[60:61], v39 offset:0
ds_read_b64 v[62:63], v39 offset:128
ds_read_b64 v[64:65], v39 offset:256
ds_read_b64 v[66:67], v40 offset:0
ds_read_b64 v[68:69], v40 offset:128
ds_read_b64 v[70:71], v40 offset:256
s_add_u32 s79, s76, 1
s_and_b32 s79, s79, 3
s_lshl_b32 s79, s79, 15
v_add_u32 v42, s79, v220
s_add_u32 s79, s76, 2
s_and_b32 s79, s79, 3
s_lshl_b32 s79, s79, 15
v_add_u32 v43, s79, v220
s_add_u32 s79, s76, 3
s_and_b32 s79, s79, 3
s_lshl_b32 s79, s79, 13
s_add_u32 s79, s79, 131072
v_add_u32 v44, s79, v220
ds_write_b128 v42, v[144:147] offset:0
ds_write_b128 v42, v[148:151] offset:1024
ds_write_b128 v42, v[152:155] offset:2048
ds_write_b128 v42, v[156:159] offset:3072
ds_write_b128 v42, v[160:163] offset:4096
ds_write_b128 v42, v[164:167] offset:5120
ds_write_b128 v43, v[168:171] offset:8192
ds_write_b128 v43, v[172:175] offset:9216
ds_write_b128 v43, v[176:179] offset:10240
ds_write_b128 v43, v[180:183] offset:11264
ds_write_b128 v43, v[184:187] offset:12288
ds_write_b128 v43, v[188:191] offset:13312
ds_write_b128 v44, v[192:195] offset:0
ds_write_b128 v44, v[196:199] offset:1024
ds_write_b128 v44, v[200:203] offset:2048
ds_write_b128 v44, v[204:207] offset:3072
ds_write_b128 v44, v[208:211] offset:4096
ds_write_b128 v44, v[212:215] offset:5120
s_waitcnt lgkmcnt(15)
v_max3_f32 v36, v48, v54, v60
v_max_f32 v36, v36, v66
v_sub_f32 v48, v48, v36
v_sub_f32 v54, v54, v36
v_sub_f32 v60, v60, v36
v_sub_f32 v66, v66, v36
v_exp_f32 v48, v48
v_exp_f32 v54, v54
v_exp_f32 v60, v60
v_exp_f32 v66, v66
s_nop 0
v_mul_f32 v37, v48, v49
v_fma_f32 v37, v54, v55, v37
v_fma_f32 v37, v60, v61, v37
v_fma_f32 v37, v66, v67, v37
v_rcp_f32 v37, v37
s_nop 0
v_mul_f32 v1, v48, v37
v_mul_f32 v4, v54, v37
v_mul_f32 v7, v60, v37
v_mul_f32 v10, v66, v37
v_max3_f32 v36, v50, v56, v62
v_max_f32 v36, v36, v68
v_sub_f32 v50, v50, v36
v_sub_f32 v56, v56, v36
v_sub_f32 v62, v62, v36
v_sub_f32 v68, v68, v36
v_exp_f32 v50, v50
v_exp_f32 v56, v56
v_exp_f32 v62, v62
v_exp_f32 v68, v68
s_nop 0
v_mul_f32 v37, v50, v51
v_fma_f32 v37, v56, v57, v37
v_fma_f32 v37, v62, v63, v37
v_fma_f32 v37, v68, v69, v37
v_rcp_f32 v37, v37
s_nop 0
v_mul_f32 v2, v50, v37
v_mul_f32 v5, v56, v37
v_mul_f32 v8, v62, v37
v_mul_f32 v11, v68, v37
v_max3_f32 v36, v52, v58, v64
v_max_f32 v36, v36, v70
v_sub_f32 v52, v52, v36
v_sub_f32 v58, v58, v36
v_sub_f32 v64, v64, v36
v_sub_f32 v70, v70, v36
v_exp_f32 v52, v52
v_exp_f32 v58, v58
v_exp_f32 v64, v64
v_exp_f32 v70, v70
s_nop 0
v_mul_f32 v37, v52, v53
v_fma_f32 v37, v58, v59, v37
v_fma_f32 v37, v64, v65, v37
v_fma_f32 v37, v70, v71, v37
v_rcp_f32 v37, v37
s_nop 0
v_mul_f32 v3, v52, v37
v_mul_f32 v6, v58, v37
v_mul_f32 v9, v64, v37
v_mul_f32 v12, v70, v37
v_add_u32 v38, s77, v220
s_lshl_b32 s79, s76, 13
s_add_u32 s79, s79, 131072
v_add_u32 v39, s79, v220
s_waitcnt lgkmcnt(0)
s_barrier
ds_read_b128 v[48:51], v38 offset:0
ds_read_b128 v[52:55], v38 offset:1024
ds_read_b128 v[56:59], v38 offset:2048
ds_read_b128 v[60:63], v38 offset:3072
ds_read_b128 v[64:67], v38 offset:4096
ds_read_b128 v[68:71], v38 offset:5120
ds_read_b128 v[72:75], v38 offset:8192
ds_read_b128 v[76:79], v38 offset:9216
ds_read_b128 v[80:83], v38 offset:10240
ds_read_b128 v[84:87], v38 offset:11264
ds_read_b128 v[88:91], v38 offset:12288
ds_read_b128 v[92:95], v38 offset:13312
ds_read_b128 v[96:99], v39 offset:0
ds_read_b128 v[100:103], v39 offset:1024
ds_read_b128 v[104:107], v39 offset:2048
ds_read_b128 v[108:111], v39 offset:3072
ds_read_b128 v[112:115], v39 offset:4096
ds_read_b128 v[116:119], v39 offset:5120
v_add_u32 v40, s79, v220
v_mul_f32 v120, v120, v1
v_mul_f32 v121, v121, v1
v_mul_f32 v122, v122, v1
v_mul_f32 v123, v123, v1
v_mul_f32 v124, v124, v2
v_mul_f32 v125, v125, v2
v_mul_f32 v126, v126, v2
v_mul_f32 v127, v127, v2
v_mul_f32 v128, v128, v3
v_mul_f32 v129, v129, v3
v_mul_f32 v130, v130, v3
v_mul_f32 v131, v131, v3
v_mul_f32 v132, v132, v1
v_mul_f32 v133, v133, v1
v_mul_f32 v134, v134, v1
v_mul_f32 v135, v135, v1
v_mul_f32 v136, v136, v2
v_mul_f32 v137, v137, v2
v_mul_f32 v138, v138, v2
v_mul_f32 v139, v139, v2
v_mul_f32 v140, v140, v3
v_mul_f32 v141, v141, v3
v_mul_f32 v142, v142, v3
v_mul_f32 v143, v143, v3
s_waitcnt lgkmcnt(12)
v_fmac_f32 v120, v48, v4
v_fmac_f32 v121, v49, v4
v_fmac_f32 v122, v50, v4
v_fmac_f32 v123, v51, v4
v_fmac_f32 v124, v52, v5
v_fmac_f32 v125, v53, v5
v_fmac_f32 v126, v54, v5
v_fmac_f32 v127, v55, v5
v_fmac_f32 v128, v56, v6
v_fmac_f32 v129, v57, v6
v_fmac_f32 v130, v58, v6
v_fmac_f32 v131, v59, v6
v_fmac_f32 v132, v60, v4
v_fmac_f32 v133, v61, v4
v_fmac_f32 v134, v62, v4
v_fmac_f32 v135, v63, v4
v_fmac_f32 v136, v64, v5
v_fmac_f32 v137, v65, v5
v_fmac_f32 v138, v66, v5
v_fmac_f32 v139, v67, v5
v_fmac_f32 v140, v68, v6
v_fmac_f32 v141, v69, v6
v_fmac_f32 v142, v70, v6
v_fmac_f32 v143, v71, v6
s_waitcnt lgkmcnt(6)
v_fmac_f32 v120, v72, v7
v_fmac_f32 v121, v73, v7
v_fmac_f32 v122, v74, v7
v_fmac_f32 v123, v75, v7
v_fmac_f32 v124, v76, v8
v_fmac_f32 v125, v77, v8
v_fmac_f32 v126, v78, v8
v_fmac_f32 v127, v79, v8
v_fmac_f32 v128, v80, v9
v_fmac_f32 v129, v81, v9
v_fmac_f32 v130, v82, v9
v_fmac_f32 v131, v83, v9
v_fmac_f32 v132, v84, v7
v_fmac_f32 v133, v85, v7
v_fmac_f32 v134, v86, v7
v_fmac_f32 v135, v87, v7
v_fmac_f32 v136, v88, v8
v_fmac_f32 v137, v89, v8
v_fmac_f32 v138, v90, v8
v_fmac_f32 v139, v91, v8
v_fmac_f32 v140, v92, v9
v_fmac_f32 v141, v93, v9
v_fmac_f32 v142, v94, v9
v_fmac_f32 v143, v95, v9
s_waitcnt lgkmcnt(0)
v_fmac_f32 v120, v96, v10
v_fmac_f32 v121, v97, v10
v_fmac_f32 v122, v98, v10
v_fmac_f32 v123, v99, v10
v_fmac_f32 v124, v100, v11
v_fmac_f32 v125, v101, v11
v_fmac_f32 v126, v102, v11
v_fmac_f32 v127, v103, v11
v_fmac_f32 v128, v104, v12
v_fmac_f32 v129, v105, v12
v_fmac_f32 v130, v106, v12
v_fmac_f32 v131, v107, v12
v_fmac_f32 v132, v108, v10
v_fmac_f32 v133, v109, v10
v_fmac_f32 v134, v110, v10
v_fmac_f32 v135, v111, v10
v_fmac_f32 v136, v112, v11
v_fmac_f32 v137, v113, v11
v_fmac_f32 v138, v114, v11
v_fmac_f32 v139, v115, v11
v_fmac_f32 v140, v116, v12
v_fmac_f32 v141, v117, v12
v_fmac_f32 v142, v118, v12
v_fmac_f32 v143, v119, v12
v_cvt_pk_bf16_f32 v48, v120, v121
v_cvt_pk_bf16_f32 v49, v122, v123
v_cvt_pk_bf16_f32 v50, v124, v125
v_cvt_pk_bf16_f32 v51, v126, v127
v_cvt_pk_bf16_f32 v52, v128, v129
v_cvt_pk_bf16_f32 v53, v130, v131
v_cvt_pk_bf16_f32 v54, v132, v133
v_cvt_pk_bf16_f32 v55, v134, v135
v_cvt_pk_bf16_f32 v56, v136, v137
v_cvt_pk_bf16_f32 v57, v138, v139
v_cvt_pk_bf16_f32 v58, v140, v141
v_cvt_pk_bf16_f32 v59, v142, v143
ds_write_b64 v40, v[48:49] offset:0
ds_write_b64 v40, v[50:51] offset:1024
ds_write_b64 v40, v[52:53] offset:2048
ds_write_b64 v40, v[54:55] offset:8
ds_write_b64 v40, v[56:57] offset:1032
ds_write_b64 v40, v[58:59] offset:2056
s_add_u32 s85, s2, 2
s_and_b32 s85, s85, 3
s_lshl_b32 s85, s85, 15
s_add_u32 s85, s85, s93
s_add_u32 m0, s77, 0
s_add_u32 s94, s85, 0
buffer_load_dwordx4 v218, s[44:47], s94 offen offset:0 lds
s_add_u32 s94, s85, 3072
buffer_load_dwordx4 v219, s[44:47], s94 offen offset:1024 lds
s_add_u32 s94, s85, 6144
buffer_load_dwordx4 v218, s[44:47], s94 offen offset:2048 lds
s_add_u32 s94, s85, 9216
buffer_load_dwordx4 v219, s[44:47], s94 offen offset:3072 lds
s_add_u32 s79, s2, 0
s_and_b32 s79, s79, 3
s_lshl_b32 s79, s79, 13
s_add_u32 s79, s79, 131072
v_add_u32 v41, s79, v220
s_add_u32 s79, s2, 1
s_and_b32 s79, s79, 3
s_lshl_b32 s79, s79, 13
s_add_u32 s79, s79, 131072
v_add_u32 v42, s79, v220
s_add_u32 s79, s2, 2
s_and_b32 s79, s79, 3
s_lshl_b32 s79, s79, 13
s_add_u32 s79, s79, 131072
v_add_u32 v43, s79, v220
s_add_u32 s79, s2, 3
s_and_b32 s79, s79, 3
s_lshl_b32 s79, s79, 13
s_add_u32 s79, s79, 131072
v_add_u32 v44, s79, v220
s_waitcnt lgkmcnt(0)
s_barrier
ds_read_b128 a[0:3], v41 offset:0
ds_read_b128 a[16:19], v41 offset:1024
ds_read_b128 a[32:35], v41 offset:2048
ds_read_b128 a[4:7], v42 offset:0
ds_read_b128 a[20:23], v42 offset:1024
ds_read_b128 a[36:39], v42 offset:2048
ds_read_b128 a[8:11], v43 offset:0
ds_read_b128 a[24:27], v43 offset:1024
ds_read_b128 a[40:43], v43 offset:2048
ds_read_b128 a[12:15], v44 offset:0
ds_read_b128 a[28:31], v44 offset:1024
ds_read_b128 a[44:47], v44 offset:2048
s_add_u32 m0, s77, 4096
s_add_u32 s94, s85, 16384
buffer_load_dwordx4 v218, s[44:47], s94 offen offset:0 lds
s_add_u32 s94, s85, 19456
buffer_load_dwordx4 v219, s[44:47], s94 offen offset:1024 lds
s_add_u32 s94, s85, 22528
buffer_load_dwordx4 v218, s[44:47], s94 offen offset:2048 lds
s_add_u32 s94, s85, 25600
buffer_load_dwordx4 v219, s[44:47], s94 offen offset:3072 lds
s_waitcnt lgkmcnt(0)
s_waitcnt vmcnt(16)
ds_read_b64_tr_b16 a[128:129], v16 offset:16384
ds_read_b64_tr_b16 a[130:131], v16 offset:20480
ds_read_b64_tr_b16 a[132:133], v17 offset:16384
ds_read_b64_tr_b16 a[134:135], v17 offset:20480
ds_read_b64_tr_b16 a[136:137], v18 offset:16384
ds_read_b64_tr_b16 a[138:139], v18 offset:20480
ds_read_b64_tr_b16 a[140:141], v19 offset:16384
ds_read_b64_tr_b16 a[142:143], v19 offset:20480
ds_read_b64_tr_b16 a[144:145], v20 offset:16384
ds_read_b64_tr_b16 a[146:147], v20 offset:20480
ds_read_b64_tr_b16 a[148:149], v21 offset:16384
ds_read_b64_tr_b16 a[150:151], v21 offset:20480
ds_read_b64_tr_b16 a[152:153], v22 offset:16384
ds_read_b64_tr_b16 a[154:155], v22 offset:20480
ds_read_b64_tr_b16 a[156:157], v23 offset:16384
ds_read_b64_tr_b16 a[158:159], v23 offset:20480
s_waitcnt lgkmcnt(0)
v_mfma_f32_16x16x32_bf16 v[120:123], a[128:131], a[0:3], 0
v_mfma_f32_16x16x32_bf16 v[124:127], a[128:131], a[16:19], 0
v_mfma_f32_16x16x32_bf16 v[128:131], a[128:131], a[32:35], 0
s_add_u32 s85, s2, 3
s_and_b32 s85, s85, 3
s_lshl_b32 s85, s85, 15
s_add_u32 s85, s85, s93
s_add_u32 m0, s77, 8192
s_add_u32 s94, s85, 0
buffer_load_dwordx4 v218, s[44:47], s94 offen offset:0 lds
v_mfma_f32_16x16x32_bf16 v[132:135], a[132:135], a[0:3], 0
v_mfma_f32_16x16x32_bf16 v[136:139], a[132:135], a[16:19], 0
v_mfma_f32_16x16x32_bf16 v[140:143], a[132:135], a[32:35], 0
s_add_u32 s94, s85, 3072
buffer_load_dwordx4 v219, s[44:47], s94 offen offset:1024 lds
v_mfma_f32_16x16x32_bf16 v[144:147], a[136:139], a[0:3], 0
v_mfma_f32_16x16x32_bf16 v[148:151], a[136:139], a[16:19], 0
v_mfma_f32_16x16x32_bf16 v[152:155], a[136:139], a[32:35], 0
s_add_u32 s94, s85, 6144
buffer_load_dwordx4 v218, s[44:47], s94 offen offset:2048 lds
s_waitcnt vmcnt(11)
ds_read_b64_tr_b16 a[96:97], v16 offset:24576
ds_read_b64_tr_b16 a[98:99], v16 offset:28672
ds_read_b64_tr_b16 a[100:101], v17 offset:24576
ds_read_b64_tr_b16 a[102:103], v17 offset:28672
ds_read_b64_tr_b16 a[104:105], v18 offset:24576
ds_read_b64_tr_b16 a[106:107], v18 offset:28672
ds_read_b64_tr_b16 a[108:109], v19 offset:24576
ds_read_b64_tr_b16 a[110:111], v19 offset:28672
ds_read_b64_tr_b16 a[112:113], v20 offset:24576
ds_read_b64_tr_b16 a[114:115], v20 offset:28672
ds_read_b64_tr_b16 a[116:117], v21 offset:24576
ds_read_b64_tr_b16 a[118:119], v21 offset:28672
ds_read_b64_tr_b16 a[120:121], v22 offset:24576
ds_read_b64_tr_b16 a[122:123], v22 offset:28672
ds_read_b64_tr_b16 a[124:125], v23 offset:24576
ds_read_b64_tr_b16 a[126:127], v23 offset:28672
v_mfma_f32_16x16x32_bf16 v[156:159], a[140:143], a[0:3], 0
v_mfma_f32_16x16x32_bf16 v[160:163], a[140:143], a[16:19], 0
v_mfma_f32_16x16x32_bf16 v[164:167], a[140:143], a[32:35], 0
s_add_u32 s94, s85, 9216
buffer_load_dwordx4 v219, s[44:47], s94 offen offset:3072 lds
v_mfma_f32_16x16x32_bf16 v[168:171], a[144:147], a[0:3], 0
v_mfma_f32_16x16x32_bf16 v[172:175], a[144:147], a[16:19], 0
v_mfma_f32_16x16x32_bf16 v[176:179], a[144:147], a[32:35], 0
s_add_u32 m0, s77, 12288
s_add_u32 s94, s85, 16384
buffer_load_dwordx4 v218, s[44:47], s94 offen offset:0 lds
v_mfma_f32_16x16x32_bf16 v[180:183], a[148:151], a[0:3], 0
v_mfma_f32_16x16x32_bf16 v[184:187], a[148:151], a[16:19], 0
v_mfma_f32_16x16x32_bf16 v[188:191], a[148:151], a[32:35], 0
s_add_u32 s94, s85, 19456
buffer_load_dwordx4 v219, s[44:47], s94 offen offset:1024 lds
v_mfma_f32_16x16x32_bf16 v[192:195], a[152:155], a[0:3], 0
v_mfma_f32_16x16x32_bf16 v[196:199], a[152:155], a[16:19], 0
v_mfma_f32_16x16x32_bf16 v[200:203], a[152:155], a[32:35], 0
s_add_u32 s94, s85, 22528
buffer_load_dwordx4 v218, s[44:47], s94 offen offset:2048 lds
v_mfma_f32_16x16x32_bf16 v[204:207], a[156:159], a[0:3], 0
v_mfma_f32_16x16x32_bf16 v[208:211], a[156:159], a[16:19], 0
v_mfma_f32_16x16x32_bf16 v[212:215], a[156:159], a[32:35], 0
s_add_u32 s94, s85, 25600
buffer_load_dwordx4 v219, s[44:47], s94 offen offset:3072 lds
s_waitcnt lgkmcnt(0)
v_mfma_f32_16x16x32_bf16 v[120:123], a[96:99], a[4:7], v[120:123]
v_mfma_f32_16x16x32_bf16 v[124:127], a[96:99], a[20:23], v[124:127]
v_mfma_f32_16x16x32_bf16 v[128:131], a[96:99], a[36:39], v[128:131]
s_add_u32 s85, s2, 0
s_and_b32 s85, s85, 3
s_lshl_b32 s85, s85, 15
s_add_u32 s85, s85, s93
s_add_u32 m0, s77, 16384
s_add_u32 s94, s85, 0
buffer_load_dwordx4 v218, s[68:71], s94 offen offset:0 lds
v_mfma_f32_16x16x32_bf16 v[132:135], a[100:103], a[4:7], v[132:135]
v_mfma_f32_16x16x32_bf16 v[136:139], a[100:103], a[20:23], v[136:139]
v_mfma_f32_16x16x32_bf16 v[140:143], a[100:103], a[36:39], v[140:143]
s_add_u32 s94, s85, 3072
buffer_load_dwordx4 v219, s[68:71], s94 offen offset:1024 lds
v_mfma_f32_16x16x32_bf16 v[144:147], a[104:107], a[4:7], v[144:147]
v_mfma_f32_16x16x32_bf16 v[148:151], a[104:107], a[20:23], v[148:151]
v_mfma_f32_16x16x32_bf16 v[152:155], a[104:107], a[36:39], v[152:155]
s_add_u32 s94, s85, 6144
buffer_load_dwordx4 v218, s[68:71], s94 offen offset:2048 lds
s_waitcnt vmcnt(11)
ds_read_b64_tr_b16 a[128:129], v16 offset:0
ds_read_b64_tr_b16 a[130:131], v16 offset:4096
ds_read_b64_tr_b16 a[132:133], v17 offset:0
ds_read_b64_tr_b16 a[134:135], v17 offset:4096
ds_read_b64_tr_b16 a[136:137], v18 offset:0
ds_read_b64_tr_b16 a[138:139], v18 offset:4096
ds_read_b64_tr_b16 a[140:141], v19 offset:0
ds_read_b64_tr_b16 a[142:143], v19 offset:4096
ds_read_b64_tr_b16 a[144:145], v20 offset:0
ds_read_b64_tr_b16 a[146:147], v20 offset:4096
ds_read_b64_tr_b16 a[148:149], v21 offset:0
ds_read_b64_tr_b16 a[150:151], v21 offset:4096
ds_read_b64_tr_b16 a[152:153], v22 offset:0
ds_read_b64_tr_b16 a[154:155], v22 offset:4096
ds_read_b64_tr_b16 a[156:157], v23 offset:0
ds_read_b64_tr_b16 a[158:159], v23 offset:4096
v_mfma_f32_16x16x32_bf16 v[156:159], a[108:111], a[4:7], v[156:159]
v_mfma_f32_16x16x32_bf16 v[160:163], a[108:111], a[20:23], v[160:163]
v_mfma_f32_16x16x32_bf16 v[164:167], a[108:111], a[36:39], v[164:167]
s_add_u32 s94, s85, 9216
buffer_load_dwordx4 v219, s[68:71], s94 offen offset:3072 lds
v_mfma_f32_16x16x32_bf16 v[168:171], a[112:115], a[4:7], v[168:171]
v_mfma_f32_16x16x32_bf16 v[172:175], a[112:115], a[20:23], v[172:175]
v_mfma_f32_16x16x32_bf16 v[176:179], a[112:115], a[36:39], v[176:179]
s_add_u32 m0, s77, 20480
s_add_u32 s94, s85, 16384
buffer_load_dwordx4 v218, s[68:71], s94 offen offset:0 lds
v_mfma_f32_16x16x32_bf16 v[180:183], a[116:119], a[4:7], v[180:183]
v_mfma_f32_16x16x32_bf16 v[184:187], a[116:119], a[20:23], v[184:187]
v_mfma_f32_16x16x32_bf16 v[188:191], a[116:119], a[36:39], v[188:191]
s_add_u32 s94, s85, 19456
buffer_load_dwordx4 v219, s[68:71], s94 offen offset:1024 lds
v_mfma_f32_16x16x32_bf16 v[192:195], a[120:123], a[4:7], v[192:195]
v_mfma_f32_16x16x32_bf16 v[196:199], a[120:123], a[20:23], v[196:199]
v_mfma_f32_16x16x32_bf16 v[200:203], a[120:123], a[36:39], v[200:203]
s_add_u32 s94, s85, 22528
buffer_load_dwordx4 v218, s[68:71], s94 offen offset:2048 lds
v_mfma_f32_16x16x32_bf16 v[204:207], a[124:127], a[4:7], v[204:207]
v_mfma_f32_16x16x32_bf16 v[208:211], a[124:127], a[20:23], v[208:211]
v_mfma_f32_16x16x32_bf16 v[212:215], a[124:127], a[36:39], v[212:215]
s_add_u32 s94, s85, 25600
buffer_load_dwordx4 v219, s[68:71], s94 offen offset:3072 lds
s_waitcnt lgkmcnt(0)
v_mfma_f32_16x16x32_bf16 v[120:123], a[128:131], a[8:11], v[120:123]
v_mfma_f32_16x16x32_bf16 v[124:127], a[128:131], a[24:27], v[124:127]
v_mfma_f32_16x16x32_bf16 v[128:131], a[128:131], a[40:43], v[128:131]
s_add_u32 s85, s2, 1
s_and_b32 s85, s85, 3
s_lshl_b32 s85, s85, 15
s_add_u32 s85, s85, s93
s_add_u32 m0, s77, 24576
s_add_u32 s94, s85, 0
buffer_load_dwordx4 v218, s[68:71], s94 offen offset:0 lds
v_mfma_f32_16x16x32_bf16 v[132:135], a[132:135], a[8:11], v[132:135]
v_mfma_f32_16x16x32_bf16 v[136:139], a[132:135], a[24:27], v[136:139]
v_mfma_f32_16x16x32_bf16 v[140:143], a[132:135], a[40:43], v[140:143]
s_add_u32 s94, s85, 3072
buffer_load_dwordx4 v219, s[68:71], s94 offen offset:1024 lds
v_mfma_f32_16x16x32_bf16 v[144:147], a[136:139], a[8:11], v[144:147]
v_mfma_f32_16x16x32_bf16 v[148:151], a[136:139], a[24:27], v[148:151]
v_mfma_f32_16x16x32_bf16 v[152:155], a[136:139], a[40:43], v[152:155]
s_add_u32 s94, s85, 6144
buffer_load_dwordx4 v218, s[68:71], s94 offen offset:2048 lds
s_waitcnt vmcnt(11)
ds_read_b64_tr_b16 a[96:97], v16 offset:8192
ds_read_b64_tr_b16 a[98:99], v16 offset:12288
ds_read_b64_tr_b16 a[100:101], v17 offset:8192
ds_read_b64_tr_b16 a[102:103], v17 offset:12288
ds_read_b64_tr_b16 a[104:105], v18 offset:8192
ds_read_b64_tr_b16 a[106:107], v18 offset:12288
ds_read_b64_tr_b16 a[108:109], v19 offset:8192
ds_read_b64_tr_b16 a[110:111], v19 offset:12288
ds_read_b64_tr_b16 a[112:113], v20 offset:8192
ds_read_b64_tr_b16 a[114:115], v20 offset:12288
ds_read_b64_tr_b16 a[116:117], v21 offset:8192
ds_read_b64_tr_b16 a[118:119], v21 offset:12288
ds_read_b64_tr_b16 a[120:121], v22 offset:8192
ds_read_b64_tr_b16 a[122:123], v22 offset:12288
ds_read_b64_tr_b16 a[124:125], v23 offset:8192
ds_read_b64_tr_b16 a[126:127], v23 offset:12288
v_mfma_f32_16x16x32_bf16 v[156:159], a[140:143], a[8:11], v[156:159]
v_mfma_f32_16x16x32_bf16 v[160:163], a[140:143], a[24:27], v[160:163]
v_mfma_f32_16x16x32_bf16 v[164:167], a[140:143], a[40:43], v[164:167]
s_add_u32 s94, s85, 9216
buffer_load_dwordx4 v219, s[68:71], s94 offen offset:3072 lds
v_mfma_f32_16x16x32_bf16 v[168:171], a[144:147], a[8:11], v[168:171]
v_mfma_f32_16x16x32_bf16 v[172:175], a[144:147], a[24:27], v[172:175]
v_mfma_f32_16x16x32_bf16 v[176:179], a[144:147], a[40:43], v[176:179]
s_add_u32 m0, s77, 28672
s_add_u32 s94, s85, 16384
buffer_load_dwordx4 v218, s[68:71], s94 offen offset:0 lds
v_mfma_f32_16x16x32_bf16 v[180:183], a[148:151], a[8:11], v[180:183]
v_mfma_f32_16x16x32_bf16 v[184:187], a[148:151], a[24:27], v[184:187]
v_mfma_f32_16x16x32_bf16 v[188:191], a[148:151], a[40:43], v[188:191]
s_add_u32 s94, s85, 19456
buffer_load_dwordx4 v219, s[68:71], s94 offen offset:1024 lds
v_mfma_f32_16x16x32_bf16 v[192:195], a[152:155], a[8:11], v[192:195]
v_mfma_f32_16x16x32_bf16 v[196:199], a[152:155], a[24:27], v[196:199]
v_mfma_f32_16x16x32_bf16 v[200:203], a[152:155], a[40:43], v[200:203]
s_add_u32 s94, s85, 22528
buffer_load_dwordx4 v218, s[68:71], s94 offen offset:2048 lds
v_mfma_f32_16x16x32_bf16 v[204:207], a[156:159], a[8:11], v[204:207]
v_mfma_f32_16x16x32_bf16 v[208:211], a[156:159], a[24:27], v[208:211]
v_mfma_f32_16x16x32_bf16 v[212:215], a[156:159], a[40:43], v[212:215]
s_add_u32 s94, s85, 25600
buffer_load_dwordx4 v219, s[68:71], s94 offen offset:3072 lds
s_waitcnt lgkmcnt(0)
v_mfma_f32_16x16x32_bf16 v[120:123], a[96:99], a[12:15], v[120:123]
v_mfma_f32_16x16x32_bf16 v[124:127], a[96:99], a[28:31], v[124:127]
v_mfma_f32_16x16x32_bf16 v[128:131], a[96:99], a[44:47], v[128:131]
v_mfma_f32_16x16x32_bf16 v[132:135], a[100:103], a[12:15], v[132:135]
v_mfma_f32_16x16x32_bf16 v[136:139], a[100:103], a[28:31], v[136:139]
v_mfma_f32_16x16x32_bf16 v[140:143], a[100:103], a[44:47], v[140:143]
v_mfma_f32_16x16x32_bf16 v[144:147], a[104:107], a[12:15], v[144:147]
v_mfma_f32_16x16x32_bf16 v[148:151], a[104:107], a[28:31], v[148:151]
v_mfma_f32_16x16x32_bf16 v[152:155], a[104:107], a[44:47], v[152:155]
v_mfma_f32_16x16x32_bf16 v[156:159], a[108:111], a[12:15], v[156:159]
v_mfma_f32_16x16x32_bf16 v[160:163], a[108:111], a[28:31], v[160:163]
v_mfma_f32_16x16x32_bf16 v[164:167], a[108:111], a[44:47], v[164:167]
v_mfma_f32_16x16x32_bf16 v[168:171], a[112:115], a[12:15], v[168:171]
v_mfma_f32_16x16x32_bf16 v[172:175], a[112:115], a[28:31], v[172:175]
v_mfma_f32_16x16x32_bf16 v[176:179], a[112:115], a[44:47], v[176:179]
v_mfma_f32_16x16x32_bf16 v[180:183], a[116:119], a[12:15], v[180:183]
v_mfma_f32_16x16x32_bf16 v[184:187], a[116:119], a[28:31], v[184:187]
v_mfma_f32_16x16x32_bf16 v[188:191], a[116:119], a[44:47], v[188:191]
v_mfma_f32_16x16x32_bf16 v[192:195], a[120:123], a[12:15], v[192:195]
v_mfma_f32_16x16x32_bf16 v[196:199], a[120:123], a[28:31], v[196:199]
v_mfma_f32_16x16x32_bf16 v[200:203], a[120:123], a[44:47], v[200:203]
v_mfma_f32_16x16x32_bf16 v[204:207], a[124:127], a[12:15], v[204:207]
v_mfma_f32_16x16x32_bf16 v[208:211], a[124:127], a[28:31], v[208:211]
v_mfma_f32_16x16x32_bf16 v[212:215], a[124:127], a[44:47], v[212:215]
s_barrier
v_and_b32 v36, 15, v0
v_lshlrev_b32 v36, 3, v36
s_sub_u32 s79, s76, 0
s_and_b32 s79, s79, 3
s_lshl_b32 s79, s79, 13
s_add_u32 s79, s79, 137600
v_add_u32 v37, s79, v36
s_sub_u32 s79, s76, 1
s_and_b32 s79, s79, 3
s_lshl_b32 s79, s79, 13
s_add_u32 s79, s79, 137600
v_add_u32 v38, s79, v36
s_sub_u32 s79, s76, 2
s_and_b32 s79, s79, 3
s_lshl_b32 s79, s79, 13
s_add_u32 s79, s79, 137600
v_add_u32 v39, s79, v36
s_sub_u32 s79, s76, 3
s_and_b32 s79, s79, 3
s_lshl_b32 s79, s79, 13
s_add_u32 s79, s79, 137600
v_add_u32 v40, s79, v36
ds_read_b64 v[48:49], v37 offset:0
ds_read_b64 v[50:51], v37 offset:128
ds_read_b64 v[52:53], v37 offset:256
ds_read_b64 v[54:55], v38 offset:0
ds_read_b64 v[56:57], v38 offset:128
ds_read_b64 v[58:59], v38 offset:256
ds_read_b64 v[60:61], v39 offset:0
ds_read_b64 v[62:63], v39 offset:128
ds_read_b64 v[64:65], v39 offset:256
ds_read_b64 v[66:67], v40 offset:0
ds_read_b64 v[68:69], v40 offset:128
ds_read_b64 v[70:71], v40 offset:256
s_add_u32 s79, s76, 1
s_and_b32 s79, s79, 3
s_lshl_b32 s79, s79, 15
v_add_u32 v42, s79, v220
s_add_u32 s79, s76, 2
s_and_b32 s79, s79, 3
s_lshl_b32 s79, s79, 15
v_add_u32 v43, s79, v220
s_add_u32 s79, s76, 3
s_and_b32 s79, s79, 3
s_lshl_b32 s79, s79, 13
s_add_u32 s79, s79, 131072
v_add_u32 v44, s79, v220
ds_write_b128 v42, a[184:187] offset:0
ds_write_b128 v42, a[188:191] offset:1024
ds_write_b128 v42, a[192:195] offset:2048
ds_write_b128 v42, a[196:199] offset:3072
ds_write_b128 v42, a[200:203] offset:4096
ds_write_b128 v42, a[204:207] offset:5120
ds_write_b128 v43, a[208:211] offset:8192
ds_write_b128 v43, a[212:215] offset:9216
ds_write_b128 v43, a[216:219] offset:10240
ds_write_b128 v43, a[220:223] offset:11264
ds_write_b128 v43, a[224:227] offset:12288
ds_write_b128 v43, a[228:231] offset:13312
ds_write_b128 v44, a[232:235] offset:0
ds_write_b128 v44, a[236:239] offset:1024
ds_write_b128 v44, a[240:243] offset:2048
ds_write_b128 v44, a[244:247] offset:3072
ds_write_b128 v44, a[248:251] offset:4096
ds_write_b128 v44, a[252:255] offset:5120
v_accvgpr_read_b32 v230, a160
v_accvgpr_read_b32 v231, a161
v_accvgpr_read_b32 v232, a162
v_accvgpr_read_b32 v233, a163
v_accvgpr_read_b32 v234, a164
v_accvgpr_read_b32 v235, a165
v_accvgpr_read_b32 v236, a166
v_accvgpr_read_b32 v237, a167
v_accvgpr_read_b32 v238, a168
v_accvgpr_read_b32 v239, a169
v_accvgpr_read_b32 v240, a170
v_accvgpr_read_b32 v241, a171
v_accvgpr_read_b32 v242, a172
v_accvgpr_read_b32 v243, a173
v_accvgpr_read_b32 v244, a174
v_accvgpr_read_b32 v245, a175
v_accvgpr_read_b32 v246, a176
v_accvgpr_read_b32 v247, a177
v_accvgpr_read_b32 v248, a178
v_accvgpr_read_b32 v249, a179
v_accvgpr_read_b32 v250, a180
v_accvgpr_read_b32 v251, a181
v_accvgpr_read_b32 v252, a182
v_accvgpr_read_b32 v253, a183
s_waitcnt lgkmcnt(15)
v_max3_f32 v36, v48, v54, v60
v_max_f32 v36, v36, v66
v_sub_f32 v48, v48, v36
v_sub_f32 v54, v54, v36
v_sub_f32 v60, v60, v36
v_sub_f32 v66, v66, v36
v_exp_f32 v48, v48
v_exp_f32 v54, v54
v_exp_f32 v60, v60
v_exp_f32 v66, v66
s_nop 0
v_mul_f32 v37, v48, v49
v_fma_f32 v37, v54, v55, v37
v_fma_f32 v37, v60, v61, v37
v_fma_f32 v37, v66, v67, v37
v_rcp_f32 v37, v37
s_nop 0
v_mul_f32 v1, v48, v37
v_mul_f32 v4, v54, v37
v_mul_f32 v7, v60, v37
v_mul_f32 v10, v66, v37
v_max3_f32 v36, v50, v56, v62
v_max_f32 v36, v36, v68
v_sub_f32 v50, v50, v36
v_sub_f32 v56, v56, v36
v_sub_f32 v62, v62, v36
v_sub_f32 v68, v68, v36
v_exp_f32 v50, v50
v_exp_f32 v56, v56
v_exp_f32 v62, v62
v_exp_f32 v68, v68
s_nop 0
v_mul_f32 v37, v50, v51
v_fma_f32 v37, v56, v57, v37
v_fma_f32 v37, v62, v63, v37
v_fma_f32 v37, v68, v69, v37
v_rcp_f32 v37, v37
s_nop 0
v_mul_f32 v2, v50, v37
v_mul_f32 v5, v56, v37
v_mul_f32 v8, v62, v37
v_mul_f32 v11, v68, v37
v_max3_f32 v36, v52, v58, v64
v_max_f32 v36, v36, v70
v_sub_f32 v52, v52, v36
v_sub_f32 v58, v58, v36
v_sub_f32 v64, v64, v36
v_sub_f32 v70, v70, v36
v_exp_f32 v52, v52
v_exp_f32 v58, v58
v_exp_f32 v64, v64
v_exp_f32 v70, v70
s_nop 0
v_mul_f32 v37, v52, v53
v_fma_f32 v37, v58, v59, v37
v_fma_f32 v37, v64, v65, v37
v_fma_f32 v37, v70, v71, v37
v_rcp_f32 v37, v37
s_nop 0
v_mul_f32 v3, v52, v37
v_mul_f32 v6, v58, v37
v_mul_f32 v9, v64, v37
v_mul_f32 v12, v70, v37
v_add_u32 v38, s77, v220
s_lshl_b32 s79, s76, 13
s_add_u32 s79, s79, 131072
v_add_u32 v39, s79, v220
s_waitcnt lgkmcnt(0)
s_barrier
ds_read_b128 v[48:51], v38 offset:0
ds_read_b128 v[52:55], v38 offset:1024
ds_read_b128 v[56:59], v38 offset:2048
ds_read_b128 v[60:63], v38 offset:3072
ds_read_b128 v[64:67], v38 offset:4096
ds_read_b128 v[68:71], v38 offset:5120
ds_read_b128 v[72:75], v38 offset:8192
ds_read_b128 v[76:79], v38 offset:9216
ds_read_b128 v[80:83], v38 offset:10240
ds_read_b128 v[84:87], v38 offset:11264
ds_read_b128 v[88:91], v38 offset:12288
ds_read_b128 v[92:95], v38 offset:13312
ds_read_b128 v[96:99], v39 offset:0
ds_read_b128 v[100:103], v39 offset:1024
ds_read_b128 v[104:107], v39 offset:2048
ds_read_b128 v[108:111], v39 offset:3072
ds_read_b128 v[112:115], v39 offset:4096
ds_read_b128 v[116:119], v39 offset:5120
v_add_u32 v40, s79, v220
v_mul_f32 v230, v230, v1
v_mul_f32 v231, v231, v1
v_mul_f32 v232, v232, v1
v_mul_f32 v233, v233, v1
v_mul_f32 v234, v234, v2
v_mul_f32 v235, v235, v2
v_mul_f32 v236, v236, v2
v_mul_f32 v237, v237, v2
v_mul_f32 v238, v238, v3
v_mul_f32 v239, v239, v3
v_mul_f32 v240, v240, v3
v_mul_f32 v241, v241, v3
v_mul_f32 v242, v242, v1
v_mul_f32 v243, v243, v1
v_mul_f32 v244, v244, v1
v_mul_f32 v245, v245, v1
v_mul_f32 v246, v246, v2
v_mul_f32 v247, v247, v2
v_mul_f32 v248, v248, v2
v_mul_f32 v249, v249, v2
v_mul_f32 v250, v250, v3
v_mul_f32 v251, v251, v3
v_mul_f32 v252, v252, v3
v_mul_f32 v253, v253, v3
s_waitcnt lgkmcnt(12)
v_fmac_f32 v230, v48, v4
v_fmac_f32 v231, v49, v4
v_fmac_f32 v232, v50, v4
v_fmac_f32 v233, v51, v4
v_fmac_f32 v234, v52, v5
v_fmac_f32 v235, v53, v5
v_fmac_f32 v236, v54, v5
v_fmac_f32 v237, v55, v5
v_fmac_f32 v238, v56, v6
v_fmac_f32 v239, v57, v6
v_fmac_f32 v240, v58, v6
v_fmac_f32 v241, v59, v6
v_fmac_f32 v242, v60, v4
v_fmac_f32 v243, v61, v4
v_fmac_f32 v244, v62, v4
v_fmac_f32 v245, v63, v4
v_fmac_f32 v246, v64, v5
v_fmac_f32 v247, v65, v5
v_fmac_f32 v248, v66, v5
v_fmac_f32 v249, v67, v5
v_fmac_f32 v250, v68, v6
v_fmac_f32 v251, v69, v6
v_fmac_f32 v252, v70, v6
v_fmac_f32 v253, v71, v6
s_waitcnt lgkmcnt(6)
v_fmac_f32 v230, v72, v7
v_fmac_f32 v231, v73, v7
v_fmac_f32 v232, v74, v7
v_fmac_f32 v233, v75, v7
v_fmac_f32 v234, v76, v8
v_fmac_f32 v235, v77, v8
v_fmac_f32 v236, v78, v8
v_fmac_f32 v237, v79, v8
v_fmac_f32 v238, v80, v9
v_fmac_f32 v239, v81, v9
v_fmac_f32 v240, v82, v9
v_fmac_f32 v241, v83, v9
v_fmac_f32 v242, v84, v7
v_fmac_f32 v243, v85, v7
v_fmac_f32 v244, v86, v7
v_fmac_f32 v245, v87, v7
v_fmac_f32 v246, v88, v8
v_fmac_f32 v247, v89, v8
v_fmac_f32 v248, v90, v8
v_fmac_f32 v249, v91, v8
v_fmac_f32 v250, v92, v9
v_fmac_f32 v251, v93, v9
v_fmac_f32 v252, v94, v9
v_fmac_f32 v253, v95, v9
s_waitcnt lgkmcnt(0)
v_fmac_f32 v230, v96, v10
v_fmac_f32 v231, v97, v10
v_fmac_f32 v232, v98, v10
v_fmac_f32 v233, v99, v10
v_fmac_f32 v234, v100, v11
v_fmac_f32 v235, v101, v11
v_fmac_f32 v236, v102, v11
v_fmac_f32 v237, v103, v11
v_fmac_f32 v238, v104, v12
v_fmac_f32 v239, v105, v12
v_fmac_f32 v240, v106, v12
v_fmac_f32 v241, v107, v12
v_fmac_f32 v242, v108, v10
v_fmac_f32 v243, v109, v10
v_fmac_f32 v244, v110, v10
v_fmac_f32 v245, v111, v10
v_fmac_f32 v246, v112, v11
v_fmac_f32 v247, v113, v11
v_fmac_f32 v248, v114, v11
v_fmac_f32 v249, v115, v11
v_fmac_f32 v250, v116, v12
v_fmac_f32 v251, v117, v12
v_fmac_f32 v252, v118, v12
v_fmac_f32 v253, v119, v12
v_cvt_pk_bf16_f32 v48, v230, v231
v_cvt_pk_bf16_f32 v49, v232, v233
v_cvt_pk_bf16_f32 v50, v234, v235
v_cvt_pk_bf16_f32 v51, v236, v237
v_cvt_pk_bf16_f32 v52, v238, v239
v_cvt_pk_bf16_f32 v53, v240, v241
v_cvt_pk_bf16_f32 v54, v242, v243
v_cvt_pk_bf16_f32 v55, v244, v245
v_cvt_pk_bf16_f32 v56, v246, v247
v_cvt_pk_bf16_f32 v57, v248, v249
v_cvt_pk_bf16_f32 v58, v250, v251
v_cvt_pk_bf16_f32 v59, v252, v253
ds_write_b64 v40, v[48:49] offset:0
ds_write_b64 v40, v[50:51] offset:1024
ds_write_b64 v40, v[52:53] offset:2048
ds_write_b64 v40, v[54:55] offset:8
ds_write_b64 v40, v[56:57] offset:1032
ds_write_b64 v40, v[58:59] offset:2056
s_add_u32 s85, s2, 2
s_and_b32 s85, s85, 3
s_lshl_b32 s85, s85, 15
s_add_u32 s85, s85, s93
s_add_u32 m0, s77, 0
s_add_u32 s94, s85, 0
buffer_load_dwordx4 v218, s[68:71], s94 offen offset:0 lds
s_add_u32 s94, s85, 3072
buffer_load_dwordx4 v219, s[68:71], s94 offen offset:1024 lds
s_add_u32 s94, s85, 6144
buffer_load_dwordx4 v218, s[68:71], s94 offen offset:2048 lds
s_add_u32 s94, s85, 9216
buffer_load_dwordx4 v219, s[68:71], s94 offen offset:3072 lds
s_add_u32 s79, s2, 0
s_and_b32 s79, s79, 3
s_lshl_b32 s79, s79, 13
s_add_u32 s79, s79, 131072
v_add_u32 v41, s79, v220
s_add_u32 s79, s2, 1
s_and_b32 s79, s79, 3
s_lshl_b32 s79, s79, 13
s_add_u32 s79, s79, 131072
v_add_u32 v42, s79, v220
s_add_u32 s79, s2, 2
s_and_b32 s79, s79, 3
s_lshl_b32 s79, s79, 13
s_add_u32 s79, s79, 131072
v_add_u32 v43, s79, v220
s_add_u32 s79, s2, 3
s_and_b32 s79, s79, 3
s_lshl_b32 s79, s79, 13
s_add_u32 s79, s79, 131072
v_add_u32 v44, s79, v220
s_waitcnt lgkmcnt(0)
s_barrier
ds_read_b128 a[0:3], v41 offset:0
ds_read_b128 a[16:19], v41 offset:1024
ds_read_b128 a[32:35], v41 offset:2048
ds_read_b128 a[4:7], v42 offset:0
ds_read_b128 a[20:23], v42 offset:1024
ds_read_b128 a[36:39], v42 offset:2048
ds_read_b128 a[8:11], v43 offset:0
ds_read_b128 a[24:27], v43 offset:1024
ds_read_b128 a[40:43], v43 offset:2048
ds_read_b128 a[12:15], v44 offset:0
ds_read_b128 a[28:31], v44 offset:1024
ds_read_b128 a[44:47], v44 offset:2048
s_add_u32 m0, s77, 4096
s_add_u32 s94, s85, 16384
buffer_load_dwordx4 v218, s[68:71], s94 offen offset:0 lds
s_add_u32 s94, s85, 19456
buffer_load_dwordx4 v219, s[68:71], s94 offen offset:1024 lds
s_add_u32 s94, s85, 22528
buffer_load_dwordx4 v218, s[68:71], s94 offen offset:2048 lds
s_add_u32 s94, s85, 25600
buffer_load_dwordx4 v219, s[68:71], s94 offen offset:3072 lds
s_waitcnt lgkmcnt(0)
s_waitcnt vmcnt(16)
ds_read_b64_tr_b16 a[128:129], v16 offset:16384
ds_read_b64_tr_b16 a[130:131], v16 offset:20480
ds_read_b64_tr_b16 a[132:133], v17 offset:16384
ds_read_b64_tr_b16 a[134:135], v17 offset:20480
ds_read_b64_tr_b16 a[136:137], v18 offset:16384
ds_read_b64_tr_b16 a[138:139], v18 offset:20480
ds_read_b64_tr_b16 a[140:141], v19 offset:16384
ds_read_b64_tr_b16 a[142:143], v19 offset:20480
ds_read_b64_tr_b16 a[144:145], v20 offset:16384
ds_read_b64_tr_b16 a[146:147], v20 offset:20480
ds_read_b64_tr_b16 a[148:149], v21 offset:16384
ds_read_b64_tr_b16 a[150:151], v21 offset:20480
ds_read_b64_tr_b16 a[152:153], v22 offset:16384
ds_read_b64_tr_b16 a[154:155], v22 offset:20480
ds_read_b64_tr_b16 a[156:157], v23 offset:16384
ds_read_b64_tr_b16 a[158:159], v23 offset:20480
s_waitcnt lgkmcnt(0)
v_mfma_f32_16x16x32_bf16 v[120:123], a[128:131], a[0:3], v[120:123]
v_mfma_f32_16x16x32_bf16 v[124:127], a[128:131], a[16:19], v[124:127]
v_mfma_f32_16x16x32_bf16 v[128:131], a[128:131], a[32:35], v[128:131]
s_add_u32 s85, s2, 3
s_and_b32 s85, s85, 3
s_lshl_b32 s85, s85, 15
s_add_u32 s85, s85, s93
s_add_u32 m0, s77, 8192
s_add_u32 s94, s85, 0
buffer_load_dwordx4 v218, s[68:71], s94 offen offset:0 lds
v_mfma_f32_16x16x32_bf16 v[132:135], a[132:135], a[0:3], v[132:135]
v_mfma_f32_16x16x32_bf16 v[136:139], a[132:135], a[16:19], v[136:139]
v_mfma_f32_16x16x32_bf16 v[140:143], a[132:135], a[32:35], v[140:143]
s_add_u32 s94, s85, 3072
buffer_load_dwordx4 v219, s[68:71], s94 offen offset:1024 lds
v_mfma_f32_16x16x32_bf16 v[144:147], a[136:139], a[0:3], v[144:147]
v_mfma_f32_16x16x32_bf16 v[148:151], a[136:139], a[16:19], v[148:151]
v_mfma_f32_16x16x32_bf16 v[152:155], a[136:139], a[32:35], v[152:155]
s_add_u32 s94, s85, 6144
buffer_load_dwordx4 v218, s[68:71], s94 offen offset:2048 lds
s_waitcnt vmcnt(11)
ds_read_b64_tr_b16 a[96:97], v16 offset:24576
ds_read_b64_tr_b16 a[98:99], v16 offset:28672
ds_read_b64_tr_b16 a[100:101], v17 offset:24576
ds_read_b64_tr_b16 a[102:103], v17 offset:28672
ds_read_b64_tr_b16 a[104:105], v18 offset:24576
ds_read_b64_tr_b16 a[106:107], v18 offset:28672
ds_read_b64_tr_b16 a[108:109], v19 offset:24576
ds_read_b64_tr_b16 a[110:111], v19 offset:28672
ds_read_b64_tr_b16 a[112:113], v20 offset:24576
ds_read_b64_tr_b16 a[114:115], v20 offset:28672
ds_read_b64_tr_b16 a[116:117], v21 offset:24576
ds_read_b64_tr_b16 a[118:119], v21 offset:28672
ds_read_b64_tr_b16 a[120:121], v22 offset:24576
ds_read_b64_tr_b16 a[122:123], v22 offset:28672
ds_read_b64_tr_b16 a[124:125], v23 offset:24576
ds_read_b64_tr_b16 a[126:127], v23 offset:28672
v_mfma_f32_16x16x32_bf16 v[156:159], a[140:143], a[0:3], v[156:159]
v_mfma_f32_16x16x32_bf16 v[160:163], a[140:143], a[16:19], v[160:163]
v_mfma_f32_16x16x32_bf16 v[164:167], a[140:143], a[32:35], v[164:167]
s_add_u32 s94, s85, 9216
buffer_load_dwordx4 v219, s[68:71], s94 offen offset:3072 lds
v_mfma_f32_16x16x32_bf16 v[168:171], a[144:147], a[0:3], v[168:171]
v_mfma_f32_16x16x32_bf16 v[172:175], a[144:147], a[16:19], v[172:175]
v_mfma_f32_16x16x32_bf16 v[176:179], a[144:147], a[32:35], v[176:179]
s_add_u32 m0, s77, 12288
s_add_u32 s94, s85, 16384
buffer_load_dwordx4 v218, s[68:71], s94 offen offset:0 lds
v_mfma_f32_16x16x32_bf16 v[180:183], a[148:151], a[0:3], v[180:183]
v_mfma_f32_16x16x32_bf16 v[184:187], a[148:151], a[16:19], v[184:187]
v_mfma_f32_16x16x32_bf16 v[188:191], a[148:151], a[32:35], v[188:191]
s_add_u32 s94, s85, 19456
buffer_load_dwordx4 v219, s[68:71], s94 offen offset:1024 lds
v_mfma_f32_16x16x32_bf16 v[192:195], a[152:155], a[0:3], v[192:195]
v_mfma_f32_16x16x32_bf16 v[196:199], a[152:155], a[16:19], v[196:199]
v_mfma_f32_16x16x32_bf16 v[200:203], a[152:155], a[32:35], v[200:203]
s_add_u32 s94, s85, 22528
buffer_load_dwordx4 v218, s[68:71], s94 offen offset:2048 lds
v_mfma_f32_16x16x32_bf16 v[204:207], a[156:159], a[0:3], v[204:207]
v_mfma_f32_16x16x32_bf16 v[208:211], a[156:159], a[16:19], v[208:211]
v_mfma_f32_16x16x32_bf16 v[212:215], a[156:159], a[32:35], v[212:215]
s_add_u32 s94, s85, 25600
buffer_load_dwordx4 v219, s[68:71], s94 offen offset:3072 lds
s_waitcnt lgkmcnt(0)
v_mfma_f32_16x16x32_bf16 v[120:123], a[96:99], a[4:7], v[120:123]
v_mfma_f32_16x16x32_bf16 v[124:127], a[96:99], a[20:23], v[124:127]
v_mfma_f32_16x16x32_bf16 v[128:131], a[96:99], a[36:39], v[128:131]
v_mfma_f32_16x16x32_bf16 v[132:135], a[100:103], a[4:7], v[132:135]
v_mfma_f32_16x16x32_bf16 v[136:139], a[100:103], a[20:23], v[136:139]
v_mfma_f32_16x16x32_bf16 v[140:143], a[100:103], a[36:39], v[140:143]
v_mfma_f32_16x16x32_bf16 v[144:147], a[104:107], a[4:7], v[144:147]
v_mfma_f32_16x16x32_bf16 v[148:151], a[104:107], a[20:23], v[148:151]
v_mfma_f32_16x16x32_bf16 v[152:155], a[104:107], a[36:39], v[152:155]
s_waitcnt vmcnt(8)
ds_read_b64_tr_b16 a[128:129], v16 offset:0
ds_read_b64_tr_b16 a[130:131], v16 offset:4096
ds_read_b64_tr_b16 a[132:133], v17 offset:0
ds_read_b64_tr_b16 a[134:135], v17 offset:4096
ds_read_b64_tr_b16 a[136:137], v18 offset:0
ds_read_b64_tr_b16 a[138:139], v18 offset:4096
ds_read_b64_tr_b16 a[140:141], v19 offset:0
ds_read_b64_tr_b16 a[142:143], v19 offset:4096
ds_read_b64_tr_b16 a[144:145], v20 offset:0
ds_read_b64_tr_b16 a[146:147], v20 offset:4096
ds_read_b64_tr_b16 a[148:149], v21 offset:0
ds_read_b64_tr_b16 a[150:151], v21 offset:4096
ds_read_b64_tr_b16 a[152:153], v22 offset:0
ds_read_b64_tr_b16 a[154:155], v22 offset:4096
ds_read_b64_tr_b16 a[156:157], v23 offset:0
ds_read_b64_tr_b16 a[158:159], v23 offset:4096
v_mfma_f32_16x16x32_bf16 v[156:159], a[108:111], a[4:7], v[156:159]
v_mfma_f32_16x16x32_bf16 v[160:163], a[108:111], a[20:23], v[160:163]
v_mfma_f32_16x16x32_bf16 v[164:167], a[108:111], a[36:39], v[164:167]
v_mfma_f32_16x16x32_bf16 v[168:171], a[112:115], a[4:7], v[168:171]
v_mfma_f32_16x16x32_bf16 v[172:175], a[112:115], a[20:23], v[172:175]
v_mfma_f32_16x16x32_bf16 v[176:179], a[112:115], a[36:39], v[176:179]
v_mfma_f32_16x16x32_bf16 v[180:183], a[116:119], a[4:7], v[180:183]
v_mfma_f32_16x16x32_bf16 v[184:187], a[116:119], a[20:23], v[184:187]
v_mfma_f32_16x16x32_bf16 v[188:191], a[116:119], a[36:39], v[188:191]
v_mfma_f32_16x16x32_bf16 v[192:195], a[120:123], a[4:7], v[192:195]
v_mfma_f32_16x16x32_bf16 v[196:199], a[120:123], a[20:23], v[196:199]
v_mfma_f32_16x16x32_bf16 v[200:203], a[120:123], a[36:39], v[200:203]
v_mfma_f32_16x16x32_bf16 v[204:207], a[124:127], a[4:7], v[204:207]
v_mfma_f32_16x16x32_bf16 v[208:211], a[124:127], a[20:23], v[208:211]
v_mfma_f32_16x16x32_bf16 v[212:215], a[124:127], a[36:39], v[212:215]
s_waitcnt lgkmcnt(0)
v_mfma_f32_16x16x32_bf16 v[120:123], a[128:131], a[8:11], v[120:123]
v_mfma_f32_16x16x32_bf16 v[124:127], a[128:131], a[24:27], v[124:127]
v_mfma_f32_16x16x32_bf16 v[128:131], a[128:131], a[40:43], v[128:131]
v_mfma_f32_16x16x32_bf16 v[132:135], a[132:135], a[8:11], v[132:135]
v_mfma_f32_16x16x32_bf16 v[136:139], a[132:135], a[24:27], v[136:139]
v_mfma_f32_16x16x32_bf16 v[140:143], a[132:135], a[40:43], v[140:143]
v_mfma_f32_16x16x32_bf16 v[144:147], a[136:139], a[8:11], v[144:147]
v_mfma_f32_16x16x32_bf16 v[148:151], a[136:139], a[24:27], v[148:151]
v_mfma_f32_16x16x32_bf16 v[152:155], a[136:139], a[40:43], v[152:155]
s_waitcnt vmcnt(0)
ds_read_b64_tr_b16 a[96:97], v16 offset:8192
ds_read_b64_tr_b16 a[98:99], v16 offset:12288
ds_read_b64_tr_b16 a[100:101], v17 offset:8192
ds_read_b64_tr_b16 a[102:103], v17 offset:12288
ds_read_b64_tr_b16 a[104:105], v18 offset:8192
ds_read_b64_tr_b16 a[106:107], v18 offset:12288
ds_read_b64_tr_b16 a[108:109], v19 offset:8192
ds_read_b64_tr_b16 a[110:111], v19 offset:12288
ds_read_b64_tr_b16 a[112:113], v20 offset:8192
ds_read_b64_tr_b16 a[114:115], v20 offset:12288
ds_read_b64_tr_b16 a[116:117], v21 offset:8192
ds_read_b64_tr_b16 a[118:119], v21 offset:12288
ds_read_b64_tr_b16 a[120:121], v22 offset:8192
ds_read_b64_tr_b16 a[122:123], v22 offset:12288
ds_read_b64_tr_b16 a[124:125], v23 offset:8192
ds_read_b64_tr_b16 a[126:127], v23 offset:12288
v_mfma_f32_16x16x32_bf16 v[156:159], a[140:143], a[8:11], v[156:159]
v_mfma_f32_16x16x32_bf16 v[160:163], a[140:143], a[24:27], v[160:163]
v_mfma_f32_16x16x32_bf16 v[164:167], a[140:143], a[40:43], v[164:167]
v_mfma_f32_16x16x32_bf16 v[168:171], a[144:147], a[8:11], v[168:171]
v_mfma_f32_16x16x32_bf16 v[172:175], a[144:147], a[24:27], v[172:175]
v_mfma_f32_16x16x32_bf16 v[176:179], a[144:147], a[40:43], v[176:179]
v_mfma_f32_16x16x32_bf16 v[180:183], a[148:151], a[8:11], v[180:183]
v_mfma_f32_16x16x32_bf16 v[184:187], a[148:151], a[24:27], v[184:187]
v_mfma_f32_16x16x32_bf16 v[188:191], a[148:151], a[40:43], v[188:191]
v_mfma_f32_16x16x32_bf16 v[192:195], a[152:155], a[8:11], v[192:195]
v_mfma_f32_16x16x32_bf16 v[196:199], a[152:155], a[24:27], v[196:199]
v_mfma_f32_16x16x32_bf16 v[200:203], a[152:155], a[40:43], v[200:203]
v_mfma_f32_16x16x32_bf16 v[204:207], a[156:159], a[8:11], v[204:207]
v_mfma_f32_16x16x32_bf16 v[208:211], a[156:159], a[24:27], v[208:211]
v_mfma_f32_16x16x32_bf16 v[212:215], a[156:159], a[40:43], v[212:215]
s_waitcnt lgkmcnt(0)
v_mfma_f32_16x16x32_bf16 v[120:123], a[96:99], a[12:15], v[120:123]
v_mfma_f32_16x16x32_bf16 v[124:127], a[96:99], a[28:31], v[124:127]
v_mfma_f32_16x16x32_bf16 v[128:131], a[96:99], a[44:47], v[128:131]
v_mfma_f32_16x16x32_bf16 v[132:135], a[100:103], a[12:15], v[132:135]
v_mfma_f32_16x16x32_bf16 v[136:139], a[100:103], a[28:31], v[136:139]
v_mfma_f32_16x16x32_bf16 v[140:143], a[100:103], a[44:47], v[140:143]
v_mfma_f32_16x16x32_bf16 v[144:147], a[104:107], a[12:15], v[144:147]
v_mfma_f32_16x16x32_bf16 v[148:151], a[104:107], a[28:31], v[148:151]
v_mfma_f32_16x16x32_bf16 v[152:155], a[104:107], a[44:47], v[152:155]
v_mfma_f32_16x16x32_bf16 v[156:159], a[108:111], a[12:15], v[156:159]
v_mfma_f32_16x16x32_bf16 v[160:163], a[108:111], a[28:31], v[160:163]
v_mfma_f32_16x16x32_bf16 v[164:167], a[108:111], a[44:47], v[164:167]
v_mfma_f32_16x16x32_bf16 v[168:171], a[112:115], a[12:15], v[168:171]
v_mfma_f32_16x16x32_bf16 v[172:175], a[112:115], a[28:31], v[172:175]
v_mfma_f32_16x16x32_bf16 v[176:179], a[112:115], a[44:47], v[176:179]
v_mfma_f32_16x16x32_bf16 v[180:183], a[116:119], a[12:15], v[180:183]
v_mfma_f32_16x16x32_bf16 v[184:187], a[116:119], a[28:31], v[184:187]
v_mfma_f32_16x16x32_bf16 v[188:191], a[116:119], a[44:47], v[188:191]
v_mfma_f32_16x16x32_bf16 v[192:195], a[120:123], a[12:15], v[192:195]
v_mfma_f32_16x16x32_bf16 v[196:199], a[120:123], a[28:31], v[196:199]
v_mfma_f32_16x16x32_bf16 v[200:203], a[120:123], a[44:47], v[200:203]
v_mfma_f32_16x16x32_bf16 v[204:207], a[124:127], a[12:15], v[204:207]
v_mfma_f32_16x16x32_bf16 v[208:211], a[124:127], a[28:31], v[208:211]
v_mfma_f32_16x16x32_bf16 v[212:215], a[124:127], a[44:47], v[212:215]
s_nop 7
v_cvt_pk_bf16_f32 v48, v120, v121
v_cvt_pk_bf16_f32 v49, v122, v123
v_cvt_pk_bf16_f32 v50, v132, v133
v_cvt_pk_bf16_f32 v51, v134, v135
v_cvt_pk_bf16_f32 v52, v144, v145
v_cvt_pk_bf16_f32 v53, v146, v147
v_cvt_pk_bf16_f32 v54, v156, v157
v_cvt_pk_bf16_f32 v55, v158, v159
v_cvt_pk_bf16_f32 v56, v168, v169
v_cvt_pk_bf16_f32 v57, v170, v171
v_cvt_pk_bf16_f32 v58, v180, v181
v_cvt_pk_bf16_f32 v59, v182, v183
v_cvt_pk_bf16_f32 v60, v192, v193
v_cvt_pk_bf16_f32 v61, v194, v195
v_cvt_pk_bf16_f32 v62, v204, v205
v_cvt_pk_bf16_f32 v63, v206, v207
v_cvt_pk_bf16_f32 v64, v124, v125
v_cvt_pk_bf16_f32 v65, v126, v127
v_cvt_pk_bf16_f32 v66, v136, v137
v_cvt_pk_bf16_f32 v67, v138, v139
v_cvt_pk_bf16_f32 v68, v148, v149
v_cvt_pk_bf16_f32 v69, v150, v151
v_cvt_pk_bf16_f32 v70, v160, v161
v_cvt_pk_bf16_f32 v71, v162, v163
v_cvt_pk_bf16_f32 v72, v172, v173
v_cvt_pk_bf16_f32 v73, v174, v175
v_cvt_pk_bf16_f32 v74, v184, v185
v_cvt_pk_bf16_f32 v75, v186, v187
v_cvt_pk_bf16_f32 v76, v196, v197
v_cvt_pk_bf16_f32 v77, v198, v199
v_cvt_pk_bf16_f32 v78, v208, v209
v_cvt_pk_bf16_f32 v79, v210, v211
v_cvt_pk_bf16_f32 v80, v128, v129
v_cvt_pk_bf16_f32 v81, v130, v131
v_cvt_pk_bf16_f32 v82, v140, v141
v_cvt_pk_bf16_f32 v83, v142, v143
v_cvt_pk_bf16_f32 v84, v152, v153
v_cvt_pk_bf16_f32 v85, v154, v155
v_cvt_pk_bf16_f32 v86, v164, v165
v_cvt_pk_bf16_f32 v87, v166, v167
v_cvt_pk_bf16_f32 v88, v176, v177
v_cvt_pk_bf16_f32 v89, v178, v179
v_cvt_pk_bf16_f32 v90, v188, v189
v_cvt_pk_bf16_f32 v91, v190, v191
v_cvt_pk_bf16_f32 v92, v200, v201
v_cvt_pk_bf16_f32 v93, v202, v203
v_cvt_pk_bf16_f32 v94, v212, v213
v_cvt_pk_bf16_f32 v95, v214, v215
s_mov_b32 s95, 0
buffer_store_dwordx4 v[48:51], v222, s[72:75], s95 offen offset:0 sc1
buffer_store_dwordx4 v[52:55], v222, s[72:75], s95 offen offset:1024 sc1
buffer_store_dwordx4 v[56:59], v222, s[72:75], s95 offen offset:2048 sc1
buffer_store_dwordx4 v[60:63], v222, s[72:75], s95 offen offset:3072 sc1
s_mov_b32 s95, 4096
buffer_store_dwordx4 v[64:67], v222, s[72:75], s95 offen offset:0 sc1
buffer_store_dwordx4 v[68:71], v222, s[72:75], s95 offen offset:1024 sc1
buffer_store_dwordx4 v[72:75], v222, s[72:75], s95 offen offset:2048 sc1
buffer_store_dwordx4 v[76:79], v222, s[72:75], s95 offen offset:3072 sc1
s_mov_b32 s95, 8192
buffer_store_dwordx4 v[80:83], v222, s[72:75], s95 offen offset:0 sc1
buffer_store_dwordx4 v[84:87], v222, s[72:75], s95 offen offset:1024 sc1
buffer_store_dwordx4 v[88:91], v222, s[72:75], s95 offen offset:2048 sc1
buffer_store_dwordx4 v[92:95], v222, s[72:75], s95 offen offset:3072 sc1
s_branch L_final
L_progB:
s_add_u32 s52, s28, s48
s_addc_u32 s53, s29, 0
s_mov_b32 s54, 0x80000
s_mov_b32 s55, 0x20000
s_add_u32 s60, s36, 4096
s_addc_u32 s61, s37, 0
s_sub_u32 s62, s38, 4096
s_mov_b32 s63, 0x20000
s_mov_b32 s97, 0
s_add_u32 m0, s77, 0
s_add_u32 s94, s93, 0
buffer_load_dwordx4 v218, s[40:43], s94 offen offset:0 lds
s_add_u32 s94, s93, 3072
buffer_load_dwordx4 v219, s[40:43], s94 offen offset:1024 lds
s_add_u32 s94, s93, 6144
buffer_load_dwordx4 v218, s[40:43], s94 offen offset:2048 lds
s_add_u32 s94, s93, 9216
buffer_load_dwordx4 v219, s[40:43], s94 offen offset:3072 lds
s_add_u32 m0, s77, 4096
s_add_u32 s94, s93, 16384
buffer_load_dwordx4 v218, s[40:43], s94 offen offset:0 lds
s_add_u32 s94, s93, 19456
buffer_load_dwordx4 v219, s[40:43], s94 offen offset:1024 lds
s_add_u32 s94, s93, 22528
buffer_load_dwordx4 v218, s[40:43], s94 offen offset:2048 lds
s_add_u32 s94, s93, 25600
buffer_load_dwordx4 v219, s[40:43], s94 offen offset:3072 lds
s_add_u32 m0, s77, 8192
s_add_u32 s94, s93, 32768
buffer_load_dwordx4 v218, s[40:43], s94 offen offset:0 lds
s_add_u32 s94, s93, 35840
buffer_load_dwordx4 v219, s[40:43], s94 offen offset:1024 lds
s_add_u32 s94, s93, 38912
buffer_load_dwordx4 v218, s[40:43], s94 offen offset:2048 lds
s_add_u32 s94, s93, 41984
buffer_load_dwordx4 v219, s[40:43], s94 offen offset:3072 lds
s_add_u32 s85, s2, 0
s_and_b32 s85, s85, 3
s_lshl_b32 s85, s85, 18
s_add_u32 s85, s85, s92
s_add_u32 m0, s77, 16384
s_add_u32 s94, s85, 0
buffer_load_dwordx4 v216, s[36:39], s94 offen offset:0 lds
s_add_u32 s94, s85, 31744
buffer_load_dwordx4 v217, s[36:39], s94 offen offset:1024 lds
s_add_u32 s94, s85, 63488
buffer_load_dwordx4 v216, s[36:39], s94 offen offset:2048 lds
s_add_u32 s94, s85, 95232
buffer_load_dwordx4 v217, s[36:39], s94 offen offset:3072 lds
s_add_u32 m0, s77, 20480
s_add_u32 s94, s85, 131072
buffer_load_dwordx4 v216, s[36:39], s94 offen offset:0 lds
s_add_u32 s94, s85, 162816
buffer_load_dwordx4 v217, s[36:39], s94 offen offset:1024 lds
s_add_u32 s94, s85, 194560
buffer_load_dwordx4 v216, s[36:39], s94 offen offset:2048 lds
s_add_u32 s94, s85, 226304
buffer_load_dwordx4 v217, s[36:39], s94 offen offset:3072 lds
s_add_u32 s85, s2, 1
s_and_b32 s85, s85, 3
s_lshl_b32 s85, s85, 18
s_add_u32 s85, s85, s92
s_add_u32 m0, s77, 24576
s_add_u32 s94, s85, 0
buffer_load_dwordx4 v216, s[36:39], s94 offen offset:0 lds
s_add_u32 s94, s85, 31744
buffer_load_dwordx4 v217, s[36:39], s94 offen offset:1024 lds
s_add_u32 s94, s85, 63488
buffer_load_dwordx4 v216, s[36:39], s94 offen offset:2048 lds
s_add_u32 s94, s85, 95232
buffer_load_dwordx4 v217, s[36:39], s94 offen offset:3072 lds
s_add_u32 m0, s77, 28672
s_add_u32 s94, s85, 131072
buffer_load_dwordx4 v216, s[36:39], s94 offen offset:0 lds
s_add_u32 s94, s85, 162816
buffer_load_dwordx4 v217, s[36:39], s94 offen offset:1024 lds
s_add_u32 s94, s85, 194560
buffer_load_dwordx4 v216, s[36:39], s94 offen offset:2048 lds
s_add_u32 s94, s85, 226304
buffer_load_dwordx4 v217, s[36:39], s94 offen offset:3072 lds
s_mov_b32 s96, 0
s_mov_b32 s84, 0
s_add_u32 s79, s2, 0
s_and_b32 s79, s79, 3
s_lshl_b32 s79, s79, 6
v_xor_b32 v36, s79, v221
v_xor_b32 v37, 32, v36
s_add_u32 s79, s2, 1
s_and_b32 s79, s79, 3
s_lshl_b32 s79, s79, 6
v_xor_b32 v38, s79, v221
v_xor_b32 v39, 32, v38
s_add_u32 s79, s2, 2
s_and_b32 s79, s79, 3
s_lshl_b32 s79, s79, 6
v_xor_b32 v40, s79, v221
v_xor_b32 v41, 32, v40
s_add_u32 s79, s2, 3
s_and_b32 s79, s79, 3
s_lshl_b32 s79, s79, 6
v_xor_b32 v42, s79, v221
v_xor_b32 v43, 32, v42
s_waitcnt vmcnt(16)
s_cmp_lg_u32 s76, 0
s_cbranch_scc1 L_nocountB
s_mov_b64 exec, 1
v_mov_b32 v1, 0
v_mov_b32 v2, 1
buffer_atomic_add v2, v1, s[80:83], 0 offen sc1
s_mov_b64 exec, -1
L_nocountB:
ds_read_b64 a[48:49], v36 offset:0
ds_read_b64 a[50:51], v37 offset:0
ds_read_b64 a[52:53], v38 offset:0
ds_read_b64 a[54:55], v39 offset:0
ds_read_b64 a[56:57], v40 offset:0
ds_read_b64 a[58:59], v41 offset:0
ds_read_b64 a[60:61], v42 offset:0
ds_read_b64 a[62:63], v43 offset:0
ds_read_b64 a[64:65], v36 offset:4096
ds_read_b64 a[66:67], v37 offset:4096
ds_read_b64 a[68:69], v38 offset:4096
ds_read_b64 a[70:71], v39 offset:4096
ds_read_b64 a[72:73], v40 offset:4096
ds_read_b64 a[74:75], v41 offset:4096
ds_read_b64 a[76:77], v42 offset:4096
ds_read_b64 a[78:79], v43 offset:4096
ds_read_b64 a[80:81], v36 offset:8192
ds_read_b64 a[82:83], v37 offset:8192
ds_read_b64 a[84:85], v38 offset:8192
ds_read_b64 a[86:87], v39 offset:8192
ds_read_b64 a[88:89], v40 offset:8192
ds_read_b64 a[90:91], v41 offset:8192
ds_read_b64 a[92:93], v42 offset:8192
ds_read_b64 a[94:95], v43 offset:8192
s_waitcnt lgkmcnt(0)
s_add_u32 s85, s2, 2
s_and_b32 s85, s85, 3
s_lshl_b32 s85, s85, 18
s_add_u32 s85, s85, s92
s_add_u32 m0, s77, 0
s_add_u32 s94, s85, 0
buffer_load_dwordx4 v216, s[36:39], s94 offen offset:0 lds
s_add_u32 s94, s85, 31744
buffer_load_dwordx4 v217, s[36:39], s94 offen offset:1024 lds
s_add_u32 s94, s85, 63488
buffer_load_dwordx4 v216, s[36:39], s94 offen offset:2048 lds
s_add_u32 s94, s85, 95232
buffer_load_dwordx4 v217, s[36:39], s94 offen offset:3072 lds
s_add_u32 m0, s77, 4096
s_add_u32 s94, s85, 131072
buffer_load_dwordx4 v216, s[36:39], s94 offen offset:0 lds
s_add_u32 s94, s85, 162816
buffer_load_dwordx4 v217, s[36:39], s94 offen offset:1024 lds
s_add_u32 s94, s85, 194560
buffer_load_dwordx4 v216, s[36:39], s94 offen offset:2048 lds
s_add_u32 s94, s85, 226304
buffer_load_dwordx4 v217, s[36:39], s94 offen offset:3072 lds
s_add_u32 s85, s2, 3
s_and_b32 s85, s85, 3
s_lshl_b32 s85, s85, 18
s_add_u32 s85, s85, s92
s_add_u32 m0, s77, 8192
s_add_u32 s94, s85, 0
buffer_load_dwordx4 v216, s[36:39], s94 offen offset:0 lds
s_add_u32 s94, s85, 31744
buffer_load_dwordx4 v217, s[36:39], s94 offen offset:1024 lds
s_add_u32 s94, s85, 63488
buffer_load_dwordx4 v216, s[36:39], s94 offen offset:2048 lds
s_add_u32 s94, s85, 95232
buffer_load_dwordx4 v217, s[36:39], s94 offen offset:3072 lds
s_add_u32 m0, s77, 12288
s_add_u32 s94, s85, 131072
buffer_load_dwordx4 v216, s[36:39], s94 offen offset:0 lds
s_add_u32 s94, s85, 162816
buffer_load_dwordx4 v217, s[36:39], s94 offen offset:1024 lds
s_add_u32 s94, s85, 194560
buffer_load_dwordx4 v216, s[36:39], s94 offen offset:2048 lds
s_add_u32 s94, s85, 226304
buffer_load_dwordx4 v217, s[36:39], s94 offen offset:3072 lds
s_waitcnt vmcnt(24)
ds_read_b64_tr_b16 a[128:129], v16 offset:16384
ds_read_b64_tr_b16 a[130:131], v16 offset:20480
ds_read_b64_tr_b16 a[132:133], v17 offset:16384
ds_read_b64_tr_b16 a[134:135], v17 offset:20480
ds_read_b64_tr_b16 a[136:137], v18 offset:16384
ds_read_b64_tr_b16 a[138:139], v18 offset:20480
ds_read_b64_tr_b16 a[140:141], v19 offset:16384
ds_read_b64_tr_b16 a[142:143], v19 offset:20480
ds_read_b64_tr_b16 a[144:145], v20 offset:16384
ds_read_b64_tr_b16 a[146:147], v20 offset:20480
ds_read_b64_tr_b16 a[148:149], v21 offset:16384
ds_read_b64_tr_b16 a[150:151], v21 offset:20480
ds_read_b64_tr_b16 a[152:153], v22 offset:16384
ds_read_b64_tr_b16 a[154:155], v22 offset:20480
ds_read_b64_tr_b16 a[156:157], v23 offset:16384
ds_read_b64_tr_b16 a[158:159], v23 offset:20480
s_waitcnt lgkmcnt(0)
v_mfma_f32_16x16x32_bf16 v[120:123], a[128:131], a[48:51], 0
v_mfma_f32_16x16x32_bf16 v[124:127], a[128:131], a[64:67], 0
v_mfma_f32_16x16x32_bf16 v[128:131], a[128:131], a[80:83], 0
v_mfma_f32_16x16x32_bf16 v[132:135], a[132:135], a[48:51], 0
v_mfma_f32_16x16x32_bf16 v[136:139], a[132:135], a[64:67], 0
v_mfma_f32_16x16x32_bf16 v[140:143], a[132:135], a[80:83], 0
v_mfma_f32_16x16x32_bf16 v[144:147], a[136:139], a[48:51], 0
v_mfma_f32_16x16x32_bf16 v[148:151], a[136:139], a[64:67], 0
v_mfma_f32_16x16x32_bf16 v[152:155], a[136:139], a[80:83], 0
s_waitcnt vmcnt(16)
ds_read_b64_tr_b16 a[96:97], v16 offset:24576
ds_read_b64_tr_b16 a[98:99], v16 offset:28672
ds_read_b64_tr_b16 a[100:101], v17 offset:24576
ds_read_b64_tr_b16 a[102:103], v17 offset:28672
ds_read_b64_tr_b16 a[104:105], v18 offset:24576
ds_read_b64_tr_b16 a[106:107], v18 offset:28672
ds_read_b64_tr_b16 a[108:109], v19 offset:24576
ds_read_b64_tr_b16 a[110:111], v19 offset:28672
ds_read_b64_tr_b16 a[112:113], v20 offset:24576
ds_read_b64_tr_b16 a[114:115], v20 offset:28672
ds_read_b64_tr_b16 a[116:117], v21 offset:24576
ds_read_b64_tr_b16 a[118:119], v21 offset:28672
ds_read_b64_tr_b16 a[120:121], v22 offset:24576
ds_read_b64_tr_b16 a[122:123], v22 offset:28672
ds_read_b64_tr_b16 a[124:125], v23 offset:24576
ds_read_b64_tr_b16 a[126:127], v23 offset:28672
v_mfma_f32_16x16x32_bf16 v[156:159], a[140:143], a[48:51], 0
v_mfma_f32_16x16x32_bf16 v[160:163], a[140:143], a[64:67], 0
v_mfma_f32_16x16x32_bf16 v[164:167], a[140:143], a[80:83], 0
v_mfma_f32_16x16x32_bf16 v[168:171], a[144:147], a[48:51], 0
v_mfma_f32_16x16x32_bf16 v[172:175], a[144:147], a[64:67], 0
v_mfma_f32_16x16x32_bf16 v[176:179], a[144:147], a[80:83], 0
v_mfma_f32_16x16x32_bf16 v[180:183], a[148:151], a[48:51], 0
v_mfma_f32_16x16x32_bf16 v[184:187], a[148:151], a[64:67], 0
v_mfma_f32_16x16x32_bf16 v[188:191], a[148:151], a[80:83], 0
v_mfma_f32_16x16x32_bf16 v[192:195], a[152:155], a[48:51], 0
v_mfma_f32_16x16x32_bf16 v[196:199], a[152:155], a[64:67], 0
v_mfma_f32_16x16x32_bf16 v[200:203], a[152:155], a[80:83], 0
v_mfma_f32_16x16x32_bf16 v[204:207], a[156:159], a[48:51], 0
v_mfma_f32_16x16x32_bf16 v[208:211], a[156:159], a[64:67], 0
v_mfma_f32_16x16x32_bf16 v[212:215], a[156:159], a[80:83], 0
s_waitcnt lgkmcnt(0)
v_mfma_f32_16x16x32_bf16 v[120:123], a[96:99], a[52:55], v[120:123]
v_mfma_f32_16x16x32_bf16 v[124:127], a[96:99], a[68:71], v[124:127]
v_mfma_f32_16x16x32_bf16 v[128:131], a[96:99], a[84:87], v[128:131]
v_mfma_f32_16x16x32_bf16 v[132:135], a[100:103], a[52:55], v[132:135]
v_mfma_f32_16x16x32_bf16 v[136:139], a[100:103], a[68:71], v[136:139]
v_mfma_f32_16x16x32_bf16 v[140:143], a[100:103], a[84:87], v[140:143]
v_mfma_f32_16x16x32_bf16 v[144:147], a[104:107], a[52:55], v[144:147]
v_mfma_f32_16x16x32_bf16 v[148:151], a[104:107], a[68:71], v[148:151]
v_mfma_f32_16x16x32_bf16 v[152:155], a[104:107], a[84:87], v[152:155]
s_waitcnt vmcnt(8)
ds_read_b64_tr_b16 a[128:129], v16 offset:0
ds_read_b64_tr_b16 a[130:131], v16 offset:4096
ds_read_b64_tr_b16 a[132:133], v17 offset:0
ds_read_b64_tr_b16 a[134:135], v17 offset:4096
ds_read_b64_tr_b16 a[136:137], v18 offset:0
ds_read_b64_tr_b16 a[138:139], v18 offset:4096
ds_read_b64_tr_b16 a[140:141], v19 offset:0
ds_read_b64_tr_b16 a[142:143], v19 offset:4096
ds_read_b64_tr_b16 a[144:145], v20 offset:0
ds_read_b64_tr_b16 a[146:147], v20 offset:4096
ds_read_b64_tr_b16 a[148:149], v21 offset:0
ds_read_b64_tr_b16 a[150:151], v21 offset:4096
ds_read_b64_tr_b16 a[152:153], v22 offset:0
ds_read_b64_tr_b16 a[154:155], v22 offset:4096
ds_read_b64_tr_b16 a[156:157], v23 offset:0
ds_read_b64_tr_b16 a[158:159], v23 offset:4096
v_mfma_f32_16x16x32_bf16 v[156:159], a[108:111], a[52:55], v[156:159]
v_mfma_f32_16x16x32_bf16 v[160:163], a[108:111], a[68:71], v[160:163]
v_mfma_f32_16x16x32_bf16 v[164:167], a[108:111], a[84:87], v[164:167]
v_mfma_f32_16x16x32_bf16 v[168:171], a[112:115], a[52:55], v[168:171]
v_mfma_f32_16x16x32_bf16 v[172:175], a[112:115], a[68:71], v[172:175]
v_mfma_f32_16x16x32_bf16 v[176:179], a[112:115], a[84:87], v[176:179]
v_mfma_f32_16x16x32_bf16 v[180:183], a[116:119], a[52:55], v[180:183]
v_mfma_f32_16x16x32_bf16 v[184:187], a[116:119], a[68:71], v[184:187]
v_mfma_f32_16x16x32_bf16 v[188:191], a[116:119], a[84:87], v[188:191]
v_mfma_f32_16x16x32_bf16 v[192:195], a[120:123], a[52:55], v[192:195]
v_mfma_f32_16x16x32_bf16 v[196:199], a[120:123], a[68:71], v[196:199]
v_mfma_f32_16x16x32_bf16 v[200:203], a[120:123], a[84:87], v[200:203]
v_mfma_f32_16x16x32_bf16 v[204:207], a[124:127], a[52:55], v[204:207]
v_mfma_f32_16x16x32_bf16 v[208:211], a[124:127], a[68:71], v[208:211]
v_mfma_f32_16x16x32_bf16 v[212:215], a[124:127], a[84:87], v[212:215]
s_waitcnt lgkmcnt(0)
v_mfma_f32_16x16x32_bf16 v[120:123], a[128:131], a[56:59], v[120:123]
v_mfma_f32_16x16x32_bf16 v[124:127], a[128:131], a[72:75], v[124:127]
v_mfma_f32_16x16x32_bf16 v[128:131], a[128:131], a[88:91], v[128:131]
s_add_u32 s98, s96, s97
s_and_b32 s98, s98, 3
s_and_b32 s78, s96, -4
s_or_b32 s78, s78, s98
s_lshl_b32 s78, s78, 15
s_add_u32 s78, s78, s99
s_add_u32 s96, s96, 1
s_add_u32 m0, s77, 16384
s_add_u32 s94, s78, 0
buffer_load_dwordx4 v28, s[28:31], s94 offen offset:0 nt lds
v_mfma_f32_16x16x32_bf16 v[132:135], a[132:135], a[56:59], v[132:135]
v_mfma_f32_16x16x32_bf16 v[136:139], a[132:135], a[72:75], v[136:139]
v_mfma_f32_16x16x32_bf16 v[140:143], a[132:135], a[88:91], v[140:143]
buffer_load_dwordx4 v29, s[28:31], s94 offen offset:1024 nt lds
v_mfma_f32_16x16x32_bf16 v[144:147], a[136:139], a[56:59], v[144:147]
v_mfma_f32_16x16x32_bf16 v[148:151], a[136:139], a[72:75], v[148:151]
v_mfma_f32_16x16x32_bf16 v[152:155], a[136:139], a[88:91], v[152:155]
buffer_load_dwordx4 v28, s[28:31], s94 offen offset:2048 nt lds
s_waitcnt vmcnt(3)
ds_read_b64_tr_b16 a[96:97], v16 offset:8192
ds_read_b64_tr_b16 a[98:99], v16 offset:12288
ds_read_b64_tr_b16 a[100:101], v17 offset:8192
ds_read_b64_tr_b16 a[102:103], v17 offset:12288
ds_read_b64_tr_b16 a[104:105], v18 offset:8192
ds_read_b64_tr_b16 a[106:107], v18 offset:12288
ds_read_b64_tr_b16 a[108:109], v19 offset:8192
ds_read_b64_tr_b16 a[110:111], v19 offset:12288
ds_read_b64_tr_b16 a[112:113], v20 offset:8192
ds_read_b64_tr_b16 a[114:115], v20 offset:12288
ds_read_b64_tr_b16 a[116:117], v21 offset:8192
ds_read_b64_tr_b16 a[118:119], v21 offset:12288
ds_read_b64_tr_b16 a[120:121], v22 offset:8192
ds_read_b64_tr_b16 a[122:123], v22 offset:12288
ds_read_b64_tr_b16 a[124:125], v23 offset:8192
ds_read_b64_tr_b16 a[126:127], v23 offset:12288
v_mfma_f32_16x16x32_bf16 v[156:159], a[140:143], a[56:59], v[156:159]
v_mfma_f32_16x16x32_bf16 v[160:163], a[140:143], a[72:75], v[160:163]
v_mfma_f32_16x16x32_bf16 v[164:167], a[140:143], a[88:91], v[164:167]
buffer_load_dwordx4 v29, s[28:31], s94 offen offset:3072 nt lds
v_mfma_f32_16x16x32_bf16 v[168:171], a[144:147], a[56:59], v[168:171]
v_mfma_f32_16x16x32_bf16 v[172:175], a[144:147], a[72:75], v[172:175]
v_mfma_f32_16x16x32_bf16 v[176:179], a[144:147], a[88:91], v[176:179]
s_add_u32 m0, s77, 20480
s_add_u32 s94, s78, 4096
buffer_load_dwordx4 v28, s[28:31], s94 offen offset:0 nt lds
v_mfma_f32_16x16x32_bf16 v[180:183], a[148:151], a[56:59], v[180:183]
v_mfma_f32_16x16x32_bf16 v[184:187], a[148:151], a[72:75], v[184:187]
v_mfma_f32_16x16x32_bf16 v[188:191], a[148:151], a[88:91], v[188:191]
buffer_load_dwordx4 v29, s[28:31], s94 offen offset:1024 nt lds
v_mfma_f32_16x16x32_bf16 v[192:195], a[152:155], a[56:59], v[192:195]
v_mfma_f32_16x16x32_bf16 v[196:199], a[152:155], a[72:75], v[196:199]
v_mfma_f32_16x16x32_bf16 v[200:203], a[152:155], a[88:91], v[200:203]
buffer_load_dwordx4 v28, s[28:31], s94 offen offset:2048 nt lds
v_mfma_f32_16x16x32_bf16 v[204:207], a[156:159], a[56:59], v[204:207]
v_mfma_f32_16x16x32_bf16 v[208:211], a[156:159], a[72:75], v[208:211]
v_mfma_f32_16x16x32_bf16 v[212:215], a[156:159], a[88:91], v[212:215]
buffer_load_dwordx4 v29, s[28:31], s94 offen offset:3072 nt lds
s_waitcnt lgkmcnt(0)
v_mfma_f32_16x16x32_bf16 v[120:123], a[96:99], a[60:63], v[120:123]
v_mfma_f32_16x16x32_bf16 v[124:127], a[96:99], a[76:79], v[124:127]
v_mfma_f32_16x16x32_bf16 v[128:131], a[96:99], a[92:95], v[128:131]
s_add_u32 s98, s84, s97
s_and_b32 s98, s98, 3
s_and_b32 s83, s84, -4
s_or_b32 s83, s83, s98
s_lshl_b32 s83, s83, 15
s_add_u32 s83, s83, s99
s_add_u32 s84, s84, 1
s_add_u32 m0, s77, 24576
s_add_u32 s94, s83, 0
buffer_load_dwordx4 v28, s[32:35], s94 offen offset:0 nt lds
v_mfma_f32_16x16x32_bf16 v[132:135], a[100:103], a[60:63], v[132:135]
v_mfma_f32_16x16x32_bf16 v[136:139], a[100:103], a[76:79], v[136:139]
v_mfma_f32_16x16x32_bf16 v[140:143], a[100:103], a[92:95], v[140:143]
buffer_load_dwordx4 v29, s[32:35], s94 offen offset:1024 nt lds
v_mfma_f32_16x16x32_bf16 v[144:147], a[104:107], a[60:63], v[144:147]
v_mfma_f32_16x16x32_bf16 v[148:151], a[104:107], a[76:79], v[148:151]
v_mfma_f32_16x16x32_bf16 v[152:155], a[104:107], a[92:95], v[152:155]
buffer_load_dwordx4 v28, s[32:35], s94 offen offset:2048 nt lds
v_mfma_f32_16x16x32_bf16 v[156:159], a[108:111], a[60:63], v[156:159]
v_mfma_f32_16x16x32_bf16 v[160:163], a[108:111], a[76:79], v[160:163]
v_mfma_f32_16x16x32_bf16 v[164:167], a[108:111], a[92:95], v[164:167]
buffer_load_dwordx4 v29, s[32:35], s94 offen offset:3072 nt lds
v_mfma_f32_16x16x32_bf16 v[168:171], a[112:115], a[60:63], v[168:171]
v_mfma_f32_16x16x32_bf16 v[172:175], a[112:115], a[76:79], v[172:175]
v_mfma_f32_16x16x32_bf16 v[176:179], a[112:115], a[92:95], v[176:179]
s_add_u32 m0, s77, 28672
s_add_u32 s94, s83, 4096
buffer_load_dwordx4 v28, s[32:35], s94 offen offset:0 nt lds
v_mfma_f32_16x16x32_bf16 v[180:183], a[116:119], a[60:63], v[180:183]
v_mfma_f32_16x16x32_bf16 v[184:187], a[116:119], a[76:79], v[184:187]
v_mfma_f32_16x16x32_bf16 v[188:191], a[116:119], a[92:95], v[188:191]
buffer_load_dwordx4 v29, s[32:35], s94 offen offset:1024 nt lds
v_mfma_f32_16x16x32_bf16 v[192:195], a[120:123], a[60:63], v[192:195]
v_mfma_f32_16x16x32_bf16 v[196:199], a[120:123], a[76:79], v[196:199]
v_mfma_f32_16x16x32_bf16 v[200:203], a[120:123], a[92:95], v[200:203]
buffer_load_dwordx4 v28, s[32:35], s94 offen offset:2048 nt lds
v_mfma_f32_16x16x32_bf16 v[204:207], a[124:127], a[60:63], v[204:207]
v_mfma_f32_16x16x32_bf16 v[208:211], a[124:127], a[76:79], v[208:211]
v_mfma_f32_16x16x32_bf16 v[212:215], a[124:127], a[92:95], v[212:215]
buffer_load_dwordx4 v29, s[32:35], s94 offen offset:3072 nt lds
s_nop 7
s_barrier
s_add_u32 s79, s76, 1
s_and_b32 s79, s79, 3
s_lshl_b32 s79, s79, 15
v_add_u32 v42, s79, v220
s_add_u32 s79, s76, 2
s_and_b32 s79, s79, 3
s_lshl_b32 s79, s79, 15
v_add_u32 v43, s79, v220
s_add_u32 s79, s76, 3
s_and_b32 s79, s79, 3
s_lshl_b32 s79, s79, 13
s_add_u32 s79, s79, 131072
v_add_u32 v44, s79, v220
ds_write_b128 v42, v[144:147] offset:0
ds_write_b128 v42, v[148:151] offset:1024
ds_write_b128 v42, v[152:155] offset:2048
ds_write_b128 v42, v[156:159] offset:3072
ds_write_b128 v42, v[160:163] offset:4096
ds_write_b128 v42, v[164:167] offset:5120
ds_write_b128 v43, v[168:171] offset:8192
ds_write_b128 v43, v[172:175] offset:9216
ds_write_b128 v43, v[176:179] offset:10240
ds_write_b128 v43, v[180:183] offset:11264
ds_write_b128 v43, v[184:187] offset:12288
ds_write_b128 v43, v[188:191] offset:13312
ds_write_b128 v44, v[192:195] offset:0
ds_write_b128 v44, v[196:199] offset:1024
ds_write_b128 v44, v[200:203] offset:2048
ds_write_b128 v44, v[204:207] offset:3072
ds_write_b128 v44, v[208:211] offset:4096
ds_write_b128 v44, v[212:215] offset:5120
v_add_u32 v38, s77, v220
s_lshl_b32 s79, s76, 13
s_add_u32 s79, s79, 131072
v_add_u32 v39, s79, v220
s_waitcnt lgkmcnt(0)
s_barrier
ds_read_b128 v[48:51], v38 offset:0
ds_read_b128 v[52:55], v38 offset:1024
ds_read_b128 v[56:59], v38 offset:2048
ds_read_b128 v[60:63], v38 offset:3072
ds_read_b128 v[64:67], v38 offset:4096
ds_read_b128 v[68:71], v38 offset:5120
ds_read_b128 v[72:75], v38 offset:8192
ds_read_b128 v[76:79], v38 offset:9216
ds_read_b128 v[80:83], v38 offset:10240
ds_read_b128 v[84:87], v38 offset:11264
ds_read_b128 v[88:91], v38 offset:12288
ds_read_b128 v[92:95], v38 offset:13312
ds_read_b128 v[96:99], v39 offset:0
ds_read_b128 v[100:103], v39 offset:1024
ds_read_b128 v[104:107], v39 offset:2048
ds_read_b128 v[108:111], v39 offset:3072
ds_read_b128 v[112:115], v39 offset:4096
ds_read_b128 v[116:119], v39 offset:5120
v_lshrrev_b32 v40, 5, v0
v_lshlrev_b32 v40, 8, v40
v_and_b32 v41, 15, v0
v_lshl_add_u32 v40, v41, 4, v40
v_bfe_u32 v41, v0, 4, 1
v_lshl_add_u32 v40, v41, 3, v40
v_add_u32 v40, s79, v40
s_waitcnt lgkmcnt(12)
v_add_f32 v120, v120, v48
v_add_f32 v121, v121, v49
v_add_f32 v122, v122, v50
v_add_f32 v123, v123, v51
v_add_f32 v124, v124, v52
v_add_f32 v125, v125, v53
v_add_f32 v126, v126, v54
v_add_f32 v127, v127, v55
v_add_f32 v128, v128, v56
v_add_f32 v129, v129, v57
v_add_f32 v130, v130, v58
v_add_f32 v131, v131, v59
v_add_f32 v132, v132, v60
v_add_f32 v133, v133, v61
v_add_f32 v134, v134, v62
v_add_f32 v135, v135, v63
v_add_f32 v136, v136, v64
v_add_f32 v137, v137, v65
v_add_f32 v138, v138, v66
v_add_f32 v139, v139, v67
v_add_f32 v140, v140, v68
v_add_f32 v141, v141, v69
v_add_f32 v142, v142, v70
v_add_f32 v143, v143, v71
s_waitcnt lgkmcnt(6)
v_add_f32 v120, v120, v72
v_add_f32 v121, v121, v73
v_add_f32 v122, v122, v74
v_add_f32 v123, v123, v75
v_add_f32 v124, v124, v76
v_add_f32 v125, v125, v77
v_add_f32 v126, v126, v78
v_add_f32 v127, v127, v79
v_add_f32 v128, v128, v80
v_add_f32 v129, v129, v81
v_add_f32 v130, v130, v82
v_add_f32 v131, v131, v83
v_add_f32 v132, v132, v84
v_add_f32 v133, v133, v85
v_add_f32 v134, v134, v86
v_add_f32 v135, v135, v87
v_add_f32 v136, v136, v88
v_add_f32 v137, v137, v89
v_add_f32 v138, v138, v90
v_add_f32 v139, v139, v91
v_add_f32 v140, v140, v92
v_add_f32 v141, v141, v93
v_add_f32 v142, v142, v94
v_add_f32 v143, v143, v95
s_waitcnt lgkmcnt(0)
v_add_f32 v120, v120, v96
v_add_f32 v121, v121, v97
v_add_f32 v122, v122, v98
v_add_f32 v123, v123, v99
v_add_f32 v124, v124, v100
v_add_f32 v125, v125, v101
v_add_f32 v126, v126, v102
v_add_f32 v127, v127, v103
v_add_f32 v128, v128, v104
v_add_f32 v129, v129, v105
v_add_f32 v130, v130, v106
v_add_f32 v131, v131, v107
v_add_f32 v132, v132, v108
v_add_f32 v133, v133, v109
v_add_f32 v134, v134, v110
v_add_f32 v135, v135, v111
v_add_f32 v136, v136, v112
v_add_f32 v137, v137, v113
v_add_f32 v138, v138, v114
v_add_f32 v139, v139, v115
v_add_f32 v140, v140, v116
v_add_f32 v141, v141, v117
v_add_f32 v142, v142, v118
v_add_f32 v143, v143, v119
v_cvt_pk_bf16_f32 v48, v120, v121
v_cvt_pk_bf16_f32 v49, v122, v123
v_cvt_pk_bf16_f32 v50, v124, v125
v_cvt_pk_bf16_f32 v51, v126, v127
v_cvt_pk_bf16_f32 v52, v128, v129
v_cvt_pk_bf16_f32 v53, v130, v131
v_cvt_pk_bf16_f32 v54, v132, v133
v_cvt_pk_bf16_f32 v55, v134, v135
v_cvt_pk_bf16_f32 v56, v136, v137
v_cvt_pk_bf16_f32 v57, v138, v139
v_cvt_pk_bf16_f32 v58, v140, v141
v_cvt_pk_bf16_f32 v59, v142, v143
ds_write_b64 v40, v[48:49] offset:0
ds_write_b64 v40, v[50:51] offset:1024
ds_write_b64 v40, v[52:53] offset:2048
ds_write_b64 v40, v[54:55] offset:512
ds_write_b64 v40, v[56:57] offset:1536
ds_write_b64 v40, v[58:59] offset:2560
s_add_u32 s98, s96, s97
s_and_b32 s98, s98, 3
s_and_b32 s78, s96, -4
s_or_b32 s78, s78, s98
s_lshl_b32 s78, s78, 15
s_add_u32 s78, s78, s99
s_add_u32 s96, s96, 1
s_add_u32 m0, s77, 0
s_add_u32 s94, s78, 0
buffer_load_dwordx4 v28, s[28:31], s94 offen offset:0 nt lds
buffer_load_dwordx4 v29, s[28:31], s94 offen offset:1024 nt lds
buffer_load_dwordx4 v28, s[28:31], s94 offen offset:2048 nt lds
buffer_load_dwordx4 v29, s[28:31], s94 offen offset:3072 nt lds
v_add_u32 v41, 131072, v220
s_waitcnt lgkmcnt(0)
s_barrier
ds_read_b128 a[0:3], v41 offset:0
ds_read_b128 a[16:19], v41 offset:1024
ds_read_b128 a[32:35], v41 offset:2048
ds_read_b128 a[4:7], v41 offset:8192
ds_read_b128 a[20:23], v41 offset:9216
ds_read_b128 a[36:39], v41 offset:10240
ds_read_b128 a[8:11], v41 offset:16384
ds_read_b128 a[24:27], v41 offset:17408
ds_read_b128 a[40:43], v41 offset:18432
ds_read_b128 a[12:15], v41 offset:24576
ds_read_b128 a[28:31], v41 offset:25600
ds_read_b128 a[44:47], v41 offset:26624
s_add_u32 m0, s77, 4096
s_add_u32 s94, s78, 4096
buffer_load_dwordx4 v28, s[28:31], s94 offen offset:0 nt lds
buffer_load_dwordx4 v29, s[28:31], s94 offen offset:1024 nt lds
buffer_load_dwordx4 v28, s[28:31], s94 offen offset:2048 nt lds
buffer_load_dwordx4 v29, s[28:31], s94 offen offset:3072 nt lds
s_waitcnt lgkmcnt(0)
s_waitcnt vmcnt(16)
ds_read_b128 a[96:99], v24 offset:16384
ds_read_b128 a[100:103], v24 offset:20480
ds_read_b128 a[104:107], v25 offset:16384
ds_read_b128 a[108:111], v25 offset:20480
ds_read_b128 a[112:115], v26 offset:16384
ds_read_b128 a[116:119], v26 offset:20480
ds_read_b128 a[120:123], v27 offset:16384
ds_read_b128 a[124:127], v27 offset:20480
v_mov_b32 v120, 0
v_mov_b32 v121, 0
v_mov_b32 v122, 0
v_mov_b32 v123, 0
v_mov_b32 v124, 0
v_mov_b32 v125, 0
v_mov_b32 v126, 0
v_mov_b32 v127, 0
v_mov_b32 v128, 0
v_mov_b32 v129, 0
v_mov_b32 v130, 0
v_mov_b32 v131, 0
v_mov_b32 v132, 0
v_mov_b32 v133, 0
v_mov_b32 v134, 0
v_mov_b32 v135, 0
v_mov_b32 v136, 0
v_mov_b32 v137, 0
v_mov_b32 v138, 0
v_mov_b32 v139, 0
v_mov_b32 v140, 0
v_mov_b32 v141, 0
v_mov_b32 v142, 0
v_mov_b32 v143, 0
v_mov_b32 v144, 0
v_mov_b32 v145, 0
v_mov_b32 v146, 0
v_mov_b32 v147, 0
v_mov_b32 v148, 0
v_mov_b32 v149, 0
v_mov_b32 v150, 0
v_mov_b32 v151, 0
v_mov_b32 v152, 0
v_mov_b32 v153, 0
v_mov_b32 v154, 0
v_mov_b32 v155, 0
v_mov_b32 v156, 0
v_mov_b32 v157, 0
v_mov_b32 v158, 0
v_mov_b32 v159, 0
v_mov_b32 v160, 0
v_mov_b32 v161, 0
v_mov_b32 v162, 0
v_mov_b32 v163, 0
v_mov_b32 v164, 0
v_mov_b32 v165, 0
v_mov_b32 v166, 0
v_mov_b32 v167, 0
v_mov_b32 v168, 0
v_mov_b32 v169, 0
v_mov_b32 v170, 0
v_mov_b32 v171, 0
v_mov_b32 v172, 0
v_mov_b32 v173, 0
v_mov_b32 v174, 0
v_mov_b32 v175, 0
v_mov_b32 v176, 0
v_mov_b32 v177, 0
v_mov_b32 v178, 0
v_mov_b32 v179, 0
v_mov_b32 v180, 0
v_mov_b32 v181, 0
v_mov_b32 v182, 0
v_mov_b32 v183, 0
v_mov_b32 v184, 0
v_mov_b32 v185, 0
v_mov_b32 v186, 0
v_mov_b32 v187, 0
v_mov_b32 v188, 0
v_mov_b32 v189, 0
v_mov_b32 v190, 0
v_mov_b32 v191, 0
v_mov_b32 v192, 0
v_mov_b32 v193, 0
v_mov_b32 v194, 0
v_mov_b32 v195, 0
v_mov_b32 v196, 0
v_mov_b32 v197, 0
v_mov_b32 v198, 0
v_mov_b32 v199, 0
v_mov_b32 v200, 0
v_mov_b32 v201, 0
v_mov_b32 v202, 0
v_mov_b32 v203, 0
v_mov_b32 v204, 0
v_mov_b32 v205, 0
v_mov_b32 v206, 0
v_mov_b32 v207, 0
v_mov_b32 v208, 0
v_mov_b32 v209, 0
v_mov_b32 v210, 0
v_mov_b32 v211, 0
v_mov_b32 v212, 0
v_mov_b32 v213, 0
v_mov_b32 v214, 0
v_mov_b32 v215, 0
v_mov_b32 v30, 0
v_mov_b32 v31, 0
v_mov_b32 v32, 0
v_mov_b32 v33, 0
v_mov_b32 v34, 0
v_mov_b32 v35, 0
s_mov_b32 s87, 0xff800000
s_mov_b32 s88, 0xff800000
s_waitcnt lgkmcnt(0)
v_mfma_f32_16x16x32_bf16 v[48:51], a[96:99], a[0:3], 0
v_mfma_f32_16x16x32_bf16 v[52:55], a[96:99], a[16:19], 0
v_mfma_f32_16x16x32_bf16 v[56:59], a[96:99], a[32:35], 0
s_add_u32 s98, s96, s97
s_and_b32 s98, s98, 3
s_and_b32 s78, s96, -4
s_or_b32 s78, s78, s98
s_lshl_b32 s78, s78, 15
s_add_u32 s78, s78, s99
s_add_u32 s96, s96, 1
s_add_u32 m0, s77, 16384
s_add_u32 s94, s78, 0
buffer_load_dwordx4 v28, s[28:31], s94 offen offset:0 nt lds
v_mfma_f32_16x16x32_bf16 v[60:63], a[100:103], a[0:3], 0
v_mfma_f32_16x16x32_bf16 v[64:67], a[100:103], a[16:19], 0
v_mfma_f32_16x16x32_bf16 v[68:71], a[100:103], a[32:35], 0
buffer_load_dwordx4 v29, s[28:31], s94 offen offset:1024 nt lds
v_mfma_f32_16x16x32_bf16 v[48:51], a[104:107], a[4:7], v[48:51]
v_mfma_f32_16x16x32_bf16 v[52:55], a[104:107], a[20:23], v[52:55]
v_mfma_f32_16x16x32_bf16 v[56:59], a[104:107], a[36:39], v[56:59]
buffer_load_dwordx4 v28, s[28:31], s94 offen offset:2048 nt lds
v_mfma_f32_16x16x32_bf16 v[60:63], a[108:111], a[4:7], v[60:63]
v_mfma_f32_16x16x32_bf16 v[64:67], a[108:111], a[20:23], v[64:67]
v_mfma_f32_16x16x32_bf16 v[68:71], a[108:111], a[36:39], v[68:71]
buffer_load_dwordx4 v29, s[28:31], s94 offen offset:3072 nt lds
v_mfma_f32_16x16x32_bf16 v[48:51], a[112:115], a[8:11], v[48:51]
v_mfma_f32_16x16x32_bf16 v[52:55], a[112:115], a[24:27], v[52:55]
v_mfma_f32_16x16x32_bf16 v[56:59], a[112:115], a[40:43], v[56:59]
s_add_u32 m0, s77, 20480
s_add_u32 s94, s78, 4096
buffer_load_dwordx4 v28, s[28:31], s94 offen offset:0 nt lds
v_mfma_f32_16x16x32_bf16 v[60:63], a[116:119], a[8:11], v[60:63]
v_mfma_f32_16x16x32_bf16 v[64:67], a[116:119], a[24:27], v[64:67]
v_mfma_f32_16x16x32_bf16 v[68:71], a[116:119], a[40:43], v[68:71]
buffer_load_dwordx4 v29, s[28:31], s94 offen offset:1024 nt lds
v_mfma_f32_16x16x32_bf16 v[48:51], a[120:123], a[12:15], v[48:51]
v_mfma_f32_16x16x32_bf16 v[52:55], a[120:123], a[28:31], v[52:55]
v_mfma_f32_16x16x32_bf16 v[56:59], a[120:123], a[44:47], v[56:59]
buffer_load_dwordx4 v28, s[28:31], s94 offen offset:2048 nt lds
v_mfma_f32_16x16x32_bf16 v[60:63], a[124:127], a[12:15], v[60:63]
v_mfma_f32_16x16x32_bf16 v[64:67], a[124:127], a[28:31], v[64:67]
v_mfma_f32_16x16x32_bf16 v[68:71], a[124:127], a[44:47], v[68:71]
buffer_load_dwordx4 v29, s[28:31], s94 offen offset:3072 nt lds
s_waitcnt vmcnt(8)
ds_read_b128 a[96:99], v24 offset:0
ds_read_b128 a[100:103], v24 offset:4096
ds_read_b128 a[104:107], v25 offset:0
ds_read_b128 a[108:111], v25 offset:4096
ds_read_b128 a[112:115], v26 offset:0
ds_read_b128 a[116:119], v26 offset:4096
ds_read_b128 a[120:123], v27 offset:0
ds_read_b128 a[124:127], v27 offset:4096
s_add_u32 s98, s84, s97
s_and_b32 s98, s98, 3
s_and_b32 s83, s84, -4
s_or_b32 s83, s83, s98
s_lshl_b32 s83, s83, 15
s_add_u32 s83, s83, s99
s_add_u32 s84, s84, 1
s_add_u32 m0, s77, 8192
s_add_u32 s94, s83, 0
buffer_load_dwordx4 v28, s[32:35], s94 offen offset:0 nt lds
buffer_load_dwordx4 v29, s[32:35], s94 offen offset:1024 nt lds
buffer_load_dwordx4 v28, s[32:35], s94 offen offset:2048 nt lds
buffer_load_dwordx4 v29, s[32:35], s94 offen offset:3072 nt lds
s_add_u32 m0, s77, 12288
s_add_u32 s94, s83, 4096
buffer_load_dwordx4 v28, s[32:35], s94 offen offset:0 nt lds
buffer_load_dwordx4 v29, s[32:35], s94 offen offset:1024 nt lds
buffer_load_dwordx4 v28, s[32:35], s94 offen offset:2048 nt lds
buffer_load_dwordx4 v29, s[32:35], s94 offen offset:3072 nt lds
s_nop 3
v_fma_f32 v48, v48, s89, -v30
v_fma_f32 v49, v49, s89, -v30
v_fma_f32 v50, v50, s89, -v30
v_fma_f32 v51, v51, s89, -v30
v_fma_f32 v52, v52, s89, -v32
v_fma_f32 v53, v53, s89, -v32
v_fma_f32 v54, v54, s89, -v32
v_fma_f32 v55, v55, s89, -v32
v_fma_f32 v56, v56, s89, -v34
v_fma_f32 v57, v57, s89, -v34
v_fma_f32 v58, v58, s89, -v34
v_fma_f32 v59, v59, s89, -v34
v_fma_f32 v60, v60, s89, -v30
v_fma_f32 v61, v61, s89, -v30
v_fma_f32 v62, v62, s89, -v30
v_fma_f32 v63, v63, s89, -v30
v_fma_f32 v64, v64, s89, -v32
v_fma_f32 v65, v65, s89, -v32
v_fma_f32 v66, v66, s89, -v32
v_fma_f32 v67, v67, s89, -v32
v_fma_f32 v68, v68, s89, -v34
v_fma_f32 v69, v69, s89, -v34
v_fma_f32 v70, v70, s89, -v34
v_fma_f32 v71, v71, s89, -v34
v_max3_f32 v36, v48, v49, v50
v_max3_f32 v37, v52, v53, v54
v_max3_f32 v38, v56, v57, v58
v_max3_f32 v36, v36, v51, v60
v_max3_f32 v37, v37, v55, v64
v_max3_f32 v38, v38, v59, v68
v_max3_f32 v36, v36, v61, v62
v_max3_f32 v37, v37, v65, v66
v_max3_f32 v38, v38, v69, v70
v_max_f32 v36, v36, v63
v_max_f32 v37, v37, v67
v_max_f32 v38, v38, v71
v_max3_f32 v39, v36, v37, v38
v_cmp_lt_f32 vcc, s87, v39
s_cbranch_vccz L_fast12
s_call_b64 s[90:91], L_rescale0
L_fast12:
s_mov_b32 s86, 6
L_loopB1:
s_waitcnt lgkmcnt(0)
v_mfma_f32_16x16x32_bf16 v[72:75], a[96:99], a[0:3], 0
v_exp_f32 v48, v48
v_mfma_f32_16x16x32_bf16 v[76:79], a[96:99], a[16:19], 0
v_exp_f32 v49, v49
v_exp_f32 v50, v50
s_add_u32 s98, s96, s97
s_and_b32 s98, s98, 3
s_and_b32 s78, s96, -4
s_or_b32 s78, s78, s98
s_lshl_b32 s78, s78, 15
s_add_u32 s78, s78, s99
s_add_u32 s96, s96, 1
s_add_u32 m0, s77, 0
s_add_u32 s94, s78, 0
buffer_load_dwordx4 v28, s[28:31], s94 offen offset:0 nt lds
v_mfma_f32_16x16x32_bf16 v[80:83], a[96:99], a[32:35], 0
v_exp_f32 v51, v51
v_mfma_f32_16x16x32_bf16 v[84:87], a[100:103], a[0:3], 0
v_exp_f32 v60, v60
v_mfma_f32_16x16x32_bf16 v[88:91], a[100:103], a[16:19], 0
v_exp_f32 v61, v61
buffer_load_dwordx4 v29, s[28:31], s94 offen offset:1024 nt lds
v_mfma_f32_16x16x32_bf16 v[92:95], a[100:103], a[32:35], 0
v_exp_f32 v62, v62
v_exp_f32 v63, v63
v_mfma_f32_16x16x32_bf16 v[72:75], a[104:107], a[4:7], v[72:75]
v_exp_f32 v52, v52
v_mfma_f32_16x16x32_bf16 v[76:79], a[104:107], a[20:23], v[76:79]
v_exp_f32 v53, v53
buffer_load_dwordx4 v28, s[28:31], s94 offen offset:2048 nt lds
v_mfma_f32_16x16x32_bf16 v[80:83], a[104:107], a[36:39], v[80:83]
v_exp_f32 v54, v54
v_mfma_f32_16x16x32_bf16 v[84:87], a[108:111], a[4:7], v[84:87]
v_exp_f32 v55, v55
v_exp_f32 v64, v64
v_mfma_f32_16x16x32_bf16 v[88:91], a[108:111], a[20:23], v[88:91]
v_exp_f32 v65, v65
s_waitcnt vmcnt(19)
ds_read_b64_tr_b16 a[128:129], v16 offset:24576
ds_read_b64_tr_b16 a[130:131], v16 offset:28672
ds_read_b64_tr_b16 a[132:133], v17 offset:24576
ds_read_b64_tr_b16 a[134:135], v17 offset:28672
ds_read_b64_tr_b16 a[136:137], v18 offset:24576
ds_read_b64_tr_b16 a[138:139], v18 offset:28672
ds_read_b64_tr_b16 a[140:141], v19 offset:24576
ds_read_b64_tr_b16 a[142:143], v19 offset:28672
ds_read_b64_tr_b16 a[144:145], v20 offset:24576
ds_read_b64_tr_b16 a[146:147], v20 offset:28672
ds_read_b64_tr_b16 a[148:149], v21 offset:24576
ds_read_b64_tr_b16 a[150:151], v21 offset:28672
ds_read_b64_tr_b16 a[152:153], v22 offset:24576
ds_read_b64_tr_b16 a[154:155], v22 offset:28672
ds_read_b64_tr_b16 a[156:157], v23 offset:24576
ds_read_b64_tr_b16 a[158:159], v23 offset:28672
v_mfma_f32_16x16x32_bf16 v[92:95], a[108:111], a[36:39], v[92:95]
v_exp_f32 v66, v66
v_mfma_f32_16x16x32_bf16 v[72:75], a[112:115], a[8:11], v[72:75]
v_exp_f32 v67, v67
v_cvt_pk_bf16_f32 v96, v48, v49
v_mfma_f32_16x16x32_bf16 v[76:79], a[112:115], a[24:27], v[76:79]
v_cvt_pk_bf16_f32 v97, v50, v51
v_cvt_pk_bf16_f32 v98, v60, v61
buffer_load_dwordx4 v29, s[28:31], s94 offen offset:3072 nt lds
v_mfma_f32_16x16x32_bf16 v[80:83], a[112:115], a[40:43], v[80:83]
v_cvt_pk_bf16_f32 v99, v62, v63
v_exp_f32 v56, v56
v_mfma_f32_16x16x32_bf16 v[84:87], a[116:119], a[8:11], v[84:87]
v_exp_f32 v57, v57
v_mfma_f32_16x16x32_bf16 v[88:91], a[116:119], a[24:27], v[88:91]
v_exp_f32 v58, v58
s_add_u32 m0, s77, 4096
s_add_u32 s94, s78, 4096
buffer_load_dwordx4 v28, s[28:31], s94 offen offset:0 nt lds
v_mfma_f32_16x16x32_bf16 v[92:95], a[116:119], a[40:43], v[92:95]
v_exp_f32 v59, v59
v_exp_f32 v68, v68
v_mfma_f32_16x16x32_bf16 v[72:75], a[120:123], a[12:15], v[72:75]
v_exp_f32 v69, v69
v_mfma_f32_16x16x32_bf16 v[76:79], a[120:123], a[28:31], v[76:79]
v_exp_f32 v70, v70
buffer_load_dwordx4 v29, s[28:31], s94 offen offset:1024 nt lds
v_mfma_f32_16x16x32_bf16 v[80:83], a[120:123], a[44:47], v[80:83]
v_exp_f32 v71, v71
v_cvt_pk_bf16_f32 v100, v52, v53
v_mfma_f32_16x16x32_bf16 v[84:87], a[124:127], a[12:15], v[84:87]
v_cvt_pk_bf16_f32 v101, v54, v55
v_cvt_pk_bf16_f32 v102, v64, v65
buffer_load_dwordx4 v28, s[28:31], s94 offen offset:2048 nt lds
v_mfma_f32_16x16x32_bf16 v[88:91], a[124:127], a[28:31], v[88:91]
v_cvt_pk_bf16_f32 v103, v66, v67
v_cvt_pk_bf16_f32 v104, v56, v57
v_cvt_pk_bf16_f32 v105, v58, v59
v_mfma_f32_16x16x32_bf16 v[92:95], a[124:127], a[44:47], v[92:95]
v_cvt_pk_bf16_f32 v106, v68, v69
v_cvt_pk_bf16_f32 v107, v70, v71
buffer_load_dwordx4 v29, s[28:31], s94 offen offset:3072 nt lds
s_waitcnt lgkmcnt(0)
v_mfma_f32_16x16x32_bf16 v[120:123], a[128:131], v[96:99], v[120:123]
v_add_f32 v31, v31, v48
v_add_f32 v33, v33, v52
v_add_f32 v35, v35, v56
v_mfma_f32_16x16x32_bf16 v[124:127], a[128:131], v[100:103], v[124:127]
v_add_f32 v31, v31, v49
v_add_f32 v33, v33, v53
s_add_u32 s98, s84, s97
s_and_b32 s98, s98, 3
s_and_b32 s83, s84, -4
s_or_b32 s83, s83, s98
s_lshl_b32 s83, s83, 15
s_add_u32 s83, s83, s99
s_add_u32 s84, s84, 1
s_add_u32 m0, s77, 24576
s_add_u32 s94, s83, 0
buffer_load_dwordx4 v28, s[32:35], s94 offen offset:0 nt lds
v_mfma_f32_16x16x32_bf16 v[128:131], a[128:131], v[104:107], v[128:131]
v_add_f32 v35, v35, v57
v_add_f32 v31, v31, v50
v_add_f32 v33, v33, v54
v_mfma_f32_16x16x32_bf16 v[132:135], a[132:135], v[96:99], v[132:135]
v_add_f32 v35, v35, v58
v_add_f32 v31, v31, v51
v_mfma_f32_16x16x32_bf16 v[136:139], a[132:135], v[100:103], v[136:139]
v_add_f32 v33, v33, v55
v_add_f32 v35, v35, v59
v_add_f32 v31, v31, v60
buffer_load_dwordx4 v29, s[32:35], s94 offen offset:1024 nt lds
v_mfma_f32_16x16x32_bf16 v[140:143], a[132:135], v[104:107], v[140:143]
v_add_f32 v33, v33, v64
v_add_f32 v35, v35, v68
v_mfma_f32_16x16x32_bf16 v[144:147], a[136:139], v[96:99], v[144:147]
v_add_f32 v31, v31, v61
v_add_f32 v33, v33, v65
v_add_f32 v35, v35, v69
v_mfma_f32_16x16x32_bf16 v[148:151], a[136:139], v[100:103], v[148:151]
v_add_f32 v31, v31, v62
v_add_f32 v33, v33, v66
buffer_load_dwordx4 v28, s[32:35], s94 offen offset:2048 nt lds
v_mfma_f32_16x16x32_bf16 v[152:155], a[136:139], v[104:107], v[152:155]
v_add_f32 v35, v35, v70
v_add_f32 v31, v31, v63
v_add_f32 v33, v33, v67
v_mfma_f32_16x16x32_bf16 v[156:159], a[140:143], v[96:99], v[156:159]
v_add_f32 v35, v35, v71
v_fma_f32 v72, v72, s89, -v30
v_mfma_f32_16x16x32_bf16 v[160:163], a[140:143], v[100:103], v[160:163]
v_fma_f32 v73, v73, s89, -v30
v_fma_f32 v74, v74, s89, -v30
v_fma_f32 v75, v75, s89, -v30
s_waitcnt vmcnt(19)
ds_read_b128 a[96:99], v24 offset:16384
ds_read_b128 a[100:103], v24 offset:20480
ds_read_b128 a[104:107], v25 offset:16384
ds_read_b128 a[108:111], v25 offset:20480
ds_read_b128 a[112:115], v26 offset:16384
ds_read_b128 a[116:119], v26 offset:20480
ds_read_b128 a[120:123], v27 offset:16384
ds_read_b128 a[124:127], v27 offset:20480
v_mfma_f32_16x16x32_bf16 v[164:167], a[140:143], v[104:107], v[164:167]
v_fma_f32 v76, v76, s89, -v32
v_fma_f32 v77, v77, s89, -v32
v_fma_f32 v78, v78, s89, -v32
v_mfma_f32_16x16x32_bf16 v[168:171], a[144:147], v[96:99], v[168:171]
v_fma_f32 v79, v79, s89, -v32
v_fma_f32 v80, v80, s89, -v34
v_mfma_f32_16x16x32_bf16 v[172:175], a[144:147], v[100:103], v[172:175]
v_fma_f32 v81, v81, s89, -v34
v_fma_f32 v82, v82, s89, -v34
v_fma_f32 v83, v83, s89, -v34
buffer_load_dwordx4 v29, s[32:35], s94 offen offset:3072 nt lds
v_mfma_f32_16x16x32_bf16 v[176:179], a[144:147], v[104:107], v[176:179]
v_fma_f32 v84, v84, s89, -v30
v_fma_f32 v85, v85, s89, -v30
v_mfma_f32_16x16x32_bf16 v[180:183], a[148:151], v[96:99], v[180:183]
v_fma_f32 v86, v86, s89, -v30
v_fma_f32 v87, v87, s89, -v30
v_fma_f32 v88, v88, s89, -v32
v_mfma_f32_16x16x32_bf16 v[184:187], a[148:151], v[100:103], v[184:187]
v_fma_f32 v89, v89, s89, -v32
v_fma_f32 v90, v90, s89, -v32
s_add_u32 m0, s77, 28672
s_add_u32 s94, s83, 4096
buffer_load_dwordx4 v28, s[32:35], s94 offen offset:0 nt lds
v_mfma_f32_16x16x32_bf16 v[188:191], a[148:151], v[104:107], v[188:191]
v_fma_f32 v91, v91, s89, -v32
v_fma_f32 v92, v92, s89, -v34
v_fma_f32 v93, v93, s89, -v34
v_mfma_f32_16x16x32_bf16 v[192:195], a[152:155], v[96:99], v[192:195]
v_fma_f32 v94, v94, s89, -v34
v_fma_f32 v95, v95, s89, -v34
v_mfma_f32_16x16x32_bf16 v[196:199], a[152:155], v[100:103], v[196:199]
v_max3_f32 v36, v72, v73, v74
v_max3_f32 v37, v76, v77, v78
v_max3_f32 v38, v80, v81, v82
buffer_load_dwordx4 v29, s[32:35], s94 offen offset:1024 nt lds
v_mfma_f32_16x16x32_bf16 v[200:203], a[152:155], v[104:107], v[200:203]
v_max3_f32 v36, v36, v75, v84
v_max3_f32 v37, v37, v79, v88
v_mfma_f32_16x16x32_bf16 v[204:207], a[156:159], v[96:99], v[204:207]
v_max3_f32 v38, v38, v83, v92
v_max3_f32 v36, v36, v85, v86
v_max3_f32 v37, v37, v89, v90
buffer_load_dwordx4 v28, s[32:35], s94 offen offset:2048 nt lds
v_mfma_f32_16x16x32_bf16 v[208:211], a[156:159], v[100:103], v[208:211]
v_max3_f32 v38, v38, v93, v94
v_max_f32 v36, v36, v87
v_mfma_f32_16x16x32_bf16 v[212:215], a[156:159], v[104:107], v[212:215]
v_max_f32 v37, v37, v91
v_max_f32 v38, v38, v95
v_max3_f32 v39, v36, v37, v38
buffer_load_dwordx4 v29, s[32:35], s94 offen offset:3072 nt lds
v_cmp_lt_f32 vcc, s87, v39
s_cbranch_vccz L_fast13
s_call_b64 s[90:91], L_rescale1
L_fast13:
s_waitcnt lgkmcnt(0)
v_mfma_f32_16x16x32_bf16 v[48:51], a[96:99], a[0:3], 0
v_exp_f32 v72, v72
v_mfma_f32_16x16x32_bf16 v[52:55], a[96:99], a[16:19], 0
v_exp_f32 v73, v73
v_exp_f32 v74, v74
s_add_u32 s98, s96, s97
s_and_b32 s98, s98, 3
s_and_b32 s78, s96, -4
s_or_b32 s78, s78, s98
s_lshl_b32 s78, s78, 15
s_add_u32 s78, s78, s99
s_add_u32 s96, s96, 1
s_add_u32 m0, s77, 16384
s_add_u32 s94, s78, 0
buffer_load_dwordx4 v28, s[28:31], s94 offen offset:0 nt lds
v_mfma_f32_16x16x32_bf16 v[56:59], a[96:99], a[32:35], 0
v_exp_f32 v75, v75
v_mfma_f32_16x16x32_bf16 v[60:63], a[100:103], a[0:3], 0
v_exp_f32 v84, v84
v_mfma_f32_16x16x32_bf16 v[64:67], a[100:103], a[16:19], 0
v_exp_f32 v85, v85
buffer_load_dwordx4 v29, s[28:31], s94 offen offset:1024 nt lds
v_mfma_f32_16x16x32_bf16 v[68:71], a[100:103], a[32:35], 0
v_exp_f32 v86, v86
v_exp_f32 v87, v87
v_mfma_f32_16x16x32_bf16 v[48:51], a[104:107], a[4:7], v[48:51]
v_exp_f32 v76, v76
v_mfma_f32_16x16x32_bf16 v[52:55], a[104:107], a[20:23], v[52:55]
v_exp_f32 v77, v77
buffer_load_dwordx4 v28, s[28:31], s94 offen offset:2048 nt lds
v_mfma_f32_16x16x32_bf16 v[56:59], a[104:107], a[36:39], v[56:59]
v_exp_f32 v78, v78
v_mfma_f32_16x16x32_bf16 v[60:63], a[108:111], a[4:7], v[60:63]
v_exp_f32 v79, v79
v_exp_f32 v88, v88
v_mfma_f32_16x16x32_bf16 v[64:67], a[108:111], a[20:23], v[64:67]
v_exp_f32 v89, v89
s_waitcnt vmcnt(19)
ds_read_b64_tr_b16 a[128:129], v16 offset:8192
ds_read_b64_tr_b16 a[130:131], v16 offset:12288
ds_read_b64_tr_b16 a[132:133], v17 offset:8192
ds_read_b64_tr_b16 a[134:135], v17 offset:12288
ds_read_b64_tr_b16 a[136:137], v18 offset:8192
ds_read_b64_tr_b16 a[138:139], v18 offset:12288
ds_read_b64_tr_b16 a[140:141], v19 offset:8192
ds_read_b64_tr_b16 a[142:143], v19 offset:12288
ds_read_b64_tr_b16 a[144:145], v20 offset:8192
ds_read_b64_tr_b16 a[146:147], v20 offset:12288
ds_read_b64_tr_b16 a[148:149], v21 offset:8192
ds_read_b64_tr_b16 a[150:151], v21 offset:12288
ds_read_b64_tr_b16 a[152:153], v22 offset:8192
ds_read_b64_tr_b16 a[154:155], v22 offset:12288
ds_read_b64_tr_b16 a[156:157], v23 offset:8192
ds_read_b64_tr_b16 a[158:159], v23 offset:12288
v_mfma_f32_16x16x32_bf16 v[68:71], a[108:111], a[36:39], v[68:71]
v_exp_f32 v90, v90
v_mfma_f32_16x16x32_bf16 v[48:51], a[112:115], a[8:11], v[48:51]
v_exp_f32 v91, v91
v_cvt_pk_bf16_f32 v96, v72, v73
v_mfma_f32_16x16x32_bf16 v[52:55], a[112:115], a[24:27], v[52:55]
v_cvt_pk_bf16_f32 v97, v74, v75
v_cvt_pk_bf16_f32 v98, v84, v85
buffer_load_dwordx4 v29, s[28:31], s94 offen offset:3072 nt lds
v_mfma_f32_16x16x32_bf16 v[56:59], a[112:115], a[40:43], v[56:59]
v_cvt_pk_bf16_f32 v99, v86, v87
v_exp_f32 v80, v80
v_mfma_f32_16x16x32_bf16 v[60:63], a[116:119], a[8:11], v[60:63]
v_exp_f32 v81, v81
v_mfma_f32_16x16x32_bf16 v[64:67], a[116:119], a[24:27], v[64:67]
v_exp_f32 v82, v82
s_add_u32 m0, s77, 20480
s_add_u32 s94, s78, 4096
buffer_load_dwordx4 v28, s[28:31], s94 offen offset:0 nt lds
v_mfma_f32_16x16x32_bf16 v[68:71], a[116:119], a[40:43], v[68:71]
v_exp_f32 v83, v83
v_exp_f32 v92, v92
v_mfma_f32_16x16x32_bf16 v[48:51], a[120:123], a[12:15], v[48:51]
v_exp_f32 v93, v93
v_mfma_f32_16x16x32_bf16 v[52:55], a[120:123], a[28:31], v[52:55]
v_exp_f32 v94, v94
buffer_load_dwordx4 v29, s[28:31], s94 offen offset:1024 nt lds
v_mfma_f32_16x16x32_bf16 v[56:59], a[120:123], a[44:47], v[56:59]
v_exp_f32 v95, v95
v_cvt_pk_bf16_f32 v100, v76, v77
v_mfma_f32_16x16x32_bf16 v[60:63], a[124:127], a[12:15], v[60:63]
v_cvt_pk_bf16_f32 v101, v78, v79
v_cvt_pk_bf16_f32 v102, v88, v89
buffer_load_dwordx4 v28, s[28:31], s94 offen offset:2048 nt lds
v_mfma_f32_16x16x32_bf16 v[64:67], a[124:127], a[28:31], v[64:67]
v_cvt_pk_bf16_f32 v103, v90, v91
v_cvt_pk_bf16_f32 v104, v80, v81
v_cvt_pk_bf16_f32 v105, v82, v83
v_mfma_f32_16x16x32_bf16 v[68:71], a[124:127], a[44:47], v[68:71]
v_cvt_pk_bf16_f32 v106, v92, v93
v_cvt_pk_bf16_f32 v107, v94, v95
buffer_load_dwordx4 v29, s[28:31], s94 offen offset:3072 nt lds
s_waitcnt lgkmcnt(0)
v_mfma_f32_16x16x32_bf16 v[120:123], a[128:131], v[96:99], v[120:123]
v_add_f32 v31, v31, v72
v_add_f32 v33, v33, v76
v_add_f32 v35, v35, v80
v_mfma_f32_16x16x32_bf16 v[124:127], a[128:131], v[100:103], v[124:127]
v_add_f32 v31, v31, v73
v_add_f32 v33, v33, v77
s_add_u32 s98, s84, s97
s_and_b32 s98, s98, 3
s_and_b32 s83, s84, -4
s_or_b32 s83, s83, s98
s_lshl_b32 s83, s83, 15
s_add_u32 s83, s83, s99
s_add_u32 s84, s84, 1
s_add_u32 m0, s77, 8192
s_add_u32 s94, s83, 0
buffer_load_dwordx4 v28, s[32:35], s94 offen offset:0 nt lds
v_mfma_f32_16x16x32_bf16 v[128:131], a[128:131], v[104:107], v[128:131]
v_add_f32 v35, v35, v81
v_add_f32 v31, v31, v74
v_add_f32 v33, v33, v78
v_mfma_f32_16x16x32_bf16 v[132:135], a[132:135], v[96:99], v[132:135]
v_add_f32 v35, v35, v82
v_add_f32 v31, v31, v75
v_mfma_f32_16x16x32_bf16 v[136:139], a[132:135], v[100:103], v[136:139]
v_add_f32 v33, v33, v79
v_add_f32 v35, v35, v83
v_add_f32 v31, v31, v84
buffer_load_dwordx4 v29, s[32:35], s94 offen offset:1024 nt lds
v_mfma_f32_16x16x32_bf16 v[140:143], a[132:135], v[104:107], v[140:143]
v_add_f32 v33, v33, v88
v_add_f32 v35, v35, v92
v_mfma_f32_16x16x32_bf16 v[144:147], a[136:139], v[96:99], v[144:147]
v_add_f32 v31, v31, v85
v_add_f32 v33, v33, v89
v_add_f32 v35, v35, v93
v_mfma_f32_16x16x32_bf16 v[148:151], a[136:139], v[100:103], v[148:151]
v_add_f32 v31, v31, v86
v_add_f32 v33, v33, v90
buffer_load_dwordx4 v28, s[32:35], s94 offen offset:2048 nt lds
v_mfma_f32_16x16x32_bf16 v[152:155], a[136:139], v[104:107], v[152:155]
v_add_f32 v35, v35, v94
v_add_f32 v31, v31, v87
v_add_f32 v33, v33, v91
v_mfma_f32_16x16x32_bf16 v[156:159], a[140:143], v[96:99], v[156:159]
v_add_f32 v35, v35, v95
v_fma_f32 v48, v48, s89, -v30
v_mfma_f32_16x16x32_bf16 v[160:163], a[140:143], v[100:103], v[160:163]
v_fma_f32 v49, v49, s89, -v30
v_fma_f32 v50, v50, s89, -v30
v_fma_f32 v51, v51, s89, -v30
s_waitcnt vmcnt(19)
ds_read_b128 a[96:99], v24 offset:0
ds_read_b128 a[100:103], v24 offset:4096
ds_read_b128 a[104:107], v25 offset:0
ds_read_b128 a[108:111], v25 offset:4096
ds_read_b128 a[112:115], v26 offset:0
ds_read_b128 a[116:119], v26 offset:4096
ds_read_b128 a[120:123], v27 offset:0
ds_read_b128 a[124:127], v27 offset:4096
v_mfma_f32_16x16x32_bf16 v[164:167], a[140:143], v[104:107], v[164:167]
v_fma_f32 v52, v52, s89, -v32
v_fma_f32 v53, v53, s89, -v32
v_fma_f32 v54, v54, s89, -v32
v_mfma_f32_16x16x32_bf16 v[168:171], a[144:147], v[96:99], v[168:171]
v_fma_f32 v55, v55, s89, -v32
v_fma_f32 v56, v56, s89, -v34
v_mfma_f32_16x16x32_bf16 v[172:175], a[144:147], v[100:103], v[172:175]
v_fma_f32 v57, v57, s89, -v34
v_fma_f32 v58, v58, s89, -v34
v_fma_f32 v59, v59, s89, -v34
buffer_load_dwordx4 v29, s[32:35], s94 offen offset:3072 nt lds
v_mfma_f32_16x16x32_bf16 v[176:179], a[144:147], v[104:107], v[176:179]
v_fma_f32 v60, v60, s89, -v30
v_fma_f32 v61, v61, s89, -v30
v_mfma_f32_16x16x32_bf16 v[180:183], a[148:151], v[96:99], v[180:183]
v_fma_f32 v62, v62, s89, -v30
v_fma_f32 v63, v63, s89, -v30
v_fma_f32 v64, v64, s89, -v32
v_mfma_f32_16x16x32_bf16 v[184:187], a[148:151], v[100:103], v[184:187]
v_fma_f32 v65, v65, s89, -v32
v_fma_f32 v66, v66, s89, -v32
s_add_u32 m0, s77, 12288
s_add_u32 s94, s83, 4096
buffer_load_dwordx4 v28, s[32:35], s94 offen offset:0 nt lds
v_mfma_f32_16x16x32_bf16 v[188:191], a[148:151], v[104:107], v[188:191]
v_fma_f32 v67, v67, s89, -v32
v_fma_f32 v68, v68, s89, -v34
v_fma_f32 v69, v69, s89, -v34
v_mfma_f32_16x16x32_bf16 v[192:195], a[152:155], v[96:99], v[192:195]
v_fma_f32 v70, v70, s89, -v34
v_fma_f32 v71, v71, s89, -v34
v_mfma_f32_16x16x32_bf16 v[196:199], a[152:155], v[100:103], v[196:199]
v_max3_f32 v36, v48, v49, v50
v_max3_f32 v37, v52, v53, v54
v_max3_f32 v38, v56, v57, v58
buffer_load_dwordx4 v29, s[32:35], s94 offen offset:1024 nt lds
v_mfma_f32_16x16x32_bf16 v[200:203], a[152:155], v[104:107], v[200:203]
v_max3_f32 v36, v36, v51, v60
v_max3_f32 v37, v37, v55, v64
v_mfma_f32_16x16x32_bf16 v[204:207], a[156:159], v[96:99], v[204:207]
v_max3_f32 v38, v38, v59, v68
v_max3_f32 v36, v36, v61, v62
v_max3_f32 v37, v37, v65, v66
buffer_load_dwordx4 v28, s[32:35], s94 offen offset:2048 nt lds
v_mfma_f32_16x16x32_bf16 v[208:211], a[156:159], v[100:103], v[208:211]
v_max3_f32 v38, v38, v69, v70
v_max_f32 v36, v36, v63
v_mfma_f32_16x16x32_bf16 v[212:215], a[156:159], v[104:107], v[212:215]
v_max_f32 v37, v37, v67
v_max_f32 v38, v38, v71
v_max3_f32 v39, v36, v37, v38
buffer_load_dwordx4 v29, s[32:35], s94 offen offset:3072 nt lds
v_cmp_lt_f32 vcc, s87, v39
s_cbranch_vccz L_fast14
s_call_b64 s[90:91], L_rescale0
L_fast14:
s_sub_u32 s86, s86, 1
s_cmp_lg_u32 s86, 0
s_cbranch_scc1 L_loopB1
s_waitcnt lgkmcnt(0)
s_mov_b32 s36, s50
s_mov_b32 s37, s51
s_mov_b32 s38, 256
s_mov_b32 s39, 0x20000
v_mov_b32 v15, 0
buffer_load_dword v14, v15, s[36:39], 0 offen sc1
v_mfma_f32_16x16x32_bf16 v[72:75], a[96:99], a[0:3], 0
v_exp_f32 v48, v48
v_mfma_f32_16x16x32_bf16 v[76:79], a[96:99], a[16:19], 0
v_exp_f32 v49, v49
v_exp_f32 v50, v50
s_add_u32 s98, s96, s97
s_and_b32 s98, s98, 3
s_and_b32 s78, s96, -4
s_or_b32 s78, s78, s98
s_lshl_b32 s78, s78, 15
s_add_u32 s78, s78, s99
s_add_u32 s96, s96, 1
s_add_u32 m0, s77, 0
s_add_u32 s94, s78, 0
buffer_load_dwordx4 v28, s[28:31], s94 offen offset:0 nt lds
v_mfma_f32_16x16x32_bf16 v[80:83], a[96:99], a[32:35], 0
v_exp_f32 v51, v51
v_mfma_f32_16x16x32_bf16 v[84:87], a[100:103], a[0:3], 0
v_exp_f32 v60, v60
v_mfma_f32_16x16x32_bf16 v[88:91], a[100:103], a[16:19], 0
v_exp_f32 v61, v61
buffer_load_dwordx4 v29, s[28:31], s94 offen offset:1024 nt lds
v_mfma_f32_16x16x32_bf16 v[92:95], a[100:103], a[32:35], 0
v_exp_f32 v62, v62
v_exp_f32 v63, v63
v_mfma_f32_16x16x32_bf16 v[72:75], a[104:107], a[4:7], v[72:75]
v_exp_f32 v52, v52
v_mfma_f32_16x16x32_bf16 v[76:79], a[104:107], a[20:23], v[76:79]
v_exp_f32 v53, v53
buffer_load_dwordx4 v28, s[28:31], s94 offen offset:2048 nt lds
v_mfma_f32_16x16x32_bf16 v[80:83], a[104:107], a[36:39], v[80:83]
v_exp_f32 v54, v54
v_mfma_f32_16x16x32_bf16 v[84:87], a[108:111], a[4:7], v[84:87]
v_exp_f32 v55, v55
v_exp_f32 v64, v64
v_mfma_f32_16x16x32_bf16 v[88:91], a[108:111], a[20:23], v[88:91]
v_exp_f32 v65, v65
s_waitcnt vmcnt(20)
ds_read_b64_tr_b16 a[128:129], v16 offset:24576
ds_read_b64_tr_b16 a[130:131], v16 offset:28672
ds_read_b64_tr_b16 a[132:133], v17 offset:24576
ds_read_b64_tr_b16 a[134:135], v17 offset:28672
ds_read_b64_tr_b16 a[136:137], v18 offset:24576
ds_read_b64_tr_b16 a[138:139], v18 offset:28672
ds_read_b64_tr_b16 a[140:141], v19 offset:24576
ds_read_b64_tr_b16 a[142:143], v19 offset:28672
ds_read_b64_tr_b16 a[144:145], v20 offset:24576
ds_read_b64_tr_b16 a[146:147], v20 offset:28672
ds_read_b64_tr_b16 a[148:149], v21 offset:24576
ds_read_b64_tr_b16 a[150:151], v21 offset:28672
ds_read_b64_tr_b16 a[152:153], v22 offset:24576
ds_read_b64_tr_b16 a[154:155], v22 offset:28672
ds_read_b64_tr_b16 a[156:157], v23 offset:24576
ds_read_b64_tr_b16 a[158:159], v23 offset:28672
v_mfma_f32_16x16x32_bf16 v[92:95], a[108:111], a[36:39], v[92:95]
v_exp_f32 v66, v66
v_mfma_f32_16x16x32_bf16 v[72:75], a[112:115], a[8:11], v[72:75]
v_exp_f32 v67, v67
v_cvt_pk_bf16_f32 v96, v48, v49
v_mfma_f32_16x16x32_bf16 v[76:79], a[112:115], a[24:27], v[76:79]
v_cvt_pk_bf16_f32 v97, v50, v51
v_cvt_pk_bf16_f32 v98, v60, v61
buffer_load_dwordx4 v29, s[28:31], s94 offen offset:3072 nt lds
v_mfma_f32_16x16x32_bf16 v[80:83], a[112:115], a[40:43], v[80:83]
v_cvt_pk_bf16_f32 v99, v62, v63
v_exp_f32 v56, v56
v_mfma_f32_16x16x32_bf16 v[84:87], a[116:119], a[8:11], v[84:87]
v_exp_f32 v57, v57
v_mfma_f32_16x16x32_bf16 v[88:91], a[116:119], a[24:27], v[88:91]
v_exp_f32 v58, v58
s_add_u32 m0, s77, 4096
s_add_u32 s94, s78, 4096
buffer_load_dwordx4 v28, s[28:31], s94 offen offset:0 nt lds
v_mfma_f32_16x16x32_bf16 v[92:95], a[116:119], a[40:43], v[92:95]
v_exp_f32 v59, v59
v_exp_f32 v68, v68
v_mfma_f32_16x16x32_bf16 v[72:75], a[120:123], a[12:15], v[72:75]
v_exp_f32 v69, v69
v_mfma_f32_16x16x32_bf16 v[76:79], a[120:123], a[28:31], v[76:79]
v_exp_f32 v70, v70
buffer_load_dwordx4 v29, s[28:31], s94 offen offset:1024 nt lds
v_mfma_f32_16x16x32_bf16 v[80:83], a[120:123], a[44:47], v[80:83]
v_exp_f32 v71, v71
v_cvt_pk_bf16_f32 v100, v52, v53
v_mfma_f32_16x16x32_bf16 v[84:87], a[124:127], a[12:15], v[84:87]
v_cvt_pk_bf16_f32 v101, v54, v55
v_cvt_pk_bf16_f32 v102, v64, v65
buffer_load_dwordx4 v28, s[28:31], s94 offen offset:2048 nt lds
v_mfma_f32_16x16x32_bf16 v[88:91], a[124:127], a[28:31], v[88:91]
v_cvt_pk_bf16_f32 v103, v66, v67
v_cvt_pk_bf16_f32 v104, v56, v57
v_cvt_pk_bf16_f32 v105, v58, v59
v_mfma_f32_16x16x32_bf16 v[92:95], a[124:127], a[44:47], v[92:95]
v_cvt_pk_bf16_f32 v106, v68, v69
v_cvt_pk_bf16_f32 v107, v70, v71
buffer_load_dwordx4 v29, s[28:31], s94 offen offset:3072 nt lds
s_waitcnt lgkmcnt(0)
v_mfma_f32_16x16x32_bf16 v[120:123], a[128:131], v[96:99], v[120:123]
v_add_f32 v31, v31, v48
v_add_f32 v33, v33, v52
v_add_f32 v35, v35, v56
v_mfma_f32_16x16x32_bf16 v[124:127], a[128:131], v[100:103], v[124:127]
v_add_f32 v31, v31, v49
v_add_f32 v33, v33, v53
s_add_u32 s98, s84, s97
s_and_b32 s98, s98, 3
s_and_b32 s83, s84, -4
s_or_b32 s83, s83, s98
s_lshl_b32 s83, s83, 15
s_add_u32 s83, s83, s99
s_add_u32 s84, s84, 1
s_add_u32 m0, s77, 24576
s_add_u32 s94, s83, 0
buffer_load_dwordx4 v28, s[32:35], s94 offen offset:0 nt lds
v_mfma_f32_16x16x32_bf16 v[128:131], a[128:131], v[104:107], v[128:131]
v_add_f32 v35, v35, v57
v_add_f32 v31, v31, v50
v_add_f32 v33, v33, v54
v_mfma_f32_16x16x32_bf16 v[132:135], a[132:135], v[96:99], v[132:135]
v_add_f32 v35, v35, v58
v_add_f32 v31, v31, v51
v_mfma_f32_16x16x32_bf16 v[136:139], a[132:135], v[100:103], v[136:139]
v_add_f32 v33, v33, v55
v_add_f32 v35, v35, v59
v_add_f32 v31, v31, v60
buffer_load_dwordx4 v29, s[32:35], s94 offen offset:1024 nt lds
v_mfma_f32_16x16x32_bf16 v[140:143], a[132:135], v[104:107], v[140:143]
v_add_f32 v33, v33, v64
v_add_f32 v35, v35, v68
v_mfma_f32_16x16x32_bf16 v[144:147], a[136:139], v[96:99], v[144:147]
v_add_f32 v31, v31, v61
v_add_f32 v33, v33, v65
v_add_f32 v35, v35, v69
v_mfma_f32_16x16x32_bf16 v[148:151], a[136:139], v[100:103], v[148:151]
v_add_f32 v31, v31, v62
v_add_f32 v33, v33, v66
buffer_load_dwordx4 v28, s[32:35], s94 offen offset:2048 nt lds
v_mfma_f32_16x16x32_bf16 v[152:155], a[136:139], v[104:107], v[152:155]
v_add_f32 v35, v35, v70
v_add_f32 v31, v31, v63
v_add_f32 v33, v33, v67
v_mfma_f32_16x16x32_bf16 v[156:159], a[140:143], v[96:99], v[156:159]
v_add_f32 v35, v35, v71
v_fma_f32 v72, v72, s89, -v30
v_mfma_f32_16x16x32_bf16 v[160:163], a[140:143], v[100:103], v[160:163]
v_fma_f32 v73, v73, s89, -v30
v_fma_f32 v74, v74, s89, -v30
v_fma_f32 v75, v75, s89, -v30
s_waitcnt vmcnt(20)
ds_read_b128 a[96:99], v24 offset:16384
ds_read_b128 a[100:103], v24 offset:20480
ds_read_b128 a[104:107], v25 offset:16384
ds_read_b128 a[108:111], v25 offset:20480
ds_read_b128 a[112:115], v26 offset:16384
ds_read_b128 a[116:119], v26 offset:20480
ds_read_b128 a[120:123], v27 offset:16384
ds_read_b128 a[124:127], v27 offset:20480
v_mfma_f32_16x16x32_bf16 v[164:167], a[140:143], v[104:107], v[164:167]
v_fma_f32 v76, v76, s89, -v32
v_fma_f32 v77, v77, s89, -v32
v_fma_f32 v78, v78, s89, -v32
v_mfma_f32_16x16x32_bf16 v[168:171], a[144:147], v[96:99], v[168:171]
v_fma_f32 v79, v79, s89, -v32
v_fma_f32 v80, v80, s89, -v34
v_mfma_f32_16x16x32_bf16 v[172:175], a[144:147], v[100:103], v[172:175]
v_fma_f32 v81, v81, s89, -v34
v_fma_f32 v82, v82, s89, -v34
v_fma_f32 v83, v83, s89, -v34
buffer_load_dwordx4 v29, s[32:35], s94 offen offset:3072 nt lds
v_mfma_f32_16x16x32_bf16 v[176:179], a[144:147], v[104:107], v[176:179]
v_fma_f32 v84, v84, s89, -v30
v_fma_f32 v85, v85, s89, -v30
v_mfma_f32_16x16x32_bf16 v[180:183], a[148:151], v[96:99], v[180:183]
v_fma_f32 v86, v86, s89, -v30
v_fma_f32 v87, v87, s89, -v30
v_fma_f32 v88, v88, s89, -v32
v_mfma_f32_16x16x32_bf16 v[184:187], a[148:151], v[100:103], v[184:187]
v_fma_f32 v89, v89, s89, -v32
v_fma_f32 v90, v90, s89, -v32
s_add_u32 m0, s77, 28672
s_add_u32 s94, s83, 4096
buffer_load_dwordx4 v28, s[32:35], s94 offen offset:0 nt lds
v_mfma_f32_16x16x32_bf16 v[188:191], a[148:151], v[104:107], v[188:191]
v_fma_f32 v91, v91, s89, -v32
v_fma_f32 v92, v92, s89, -v34
v_fma_f32 v93, v93, s89, -v34
v_mfma_f32_16x16x32_bf16 v[192:195], a[152:155], v[96:99], v[192:195]
v_fma_f32 v94, v94, s89, -v34
v_fma_f32 v95, v95, s89, -v34
v_mfma_f32_16x16x32_bf16 v[196:199], a[152:155], v[100:103], v[196:199]
v_max3_f32 v36, v72, v73, v74
v_max3_f32 v37, v76, v77, v78
v_max3_f32 v38, v80, v81, v82
buffer_load_dwordx4 v29, s[32:35], s94 offen offset:1024 nt lds
v_mfma_f32_16x16x32_bf16 v[200:203], a[152:155], v[104:107], v[200:203]
v_max3_f32 v36, v36, v75, v84
v_max3_f32 v37, v37, v79, v88
v_mfma_f32_16x16x32_bf16 v[204:207], a[156:159], v[96:99], v[204:207]
v_max3_f32 v38, v38, v83, v92
v_max3_f32 v36, v36, v85, v86
v_max3_f32 v37, v37, v89, v90
buffer_load_dwordx4 v28, s[32:35], s94 offen offset:2048 nt lds
v_mfma_f32_16x16x32_bf16 v[208:211], a[156:159], v[100:103], v[208:211]
v_max3_f32 v38, v38, v93, v94
v_max_f32 v36, v36, v87
v_mfma_f32_16x16x32_bf16 v[212:215], a[156:159], v[104:107], v[212:215]
v_max_f32 v37, v37, v91
v_max_f32 v38, v38, v95
v_max3_f32 v39, v36, v37, v38
buffer_load_dwordx4 v29, s[32:35], s94 offen offset:3072 nt lds
v_cmp_lt_f32 vcc, s87, v39
s_cbranch_vccz L_fast15
s_call_b64 s[90:91], L_rescale1
L_fast15:
s_waitcnt lgkmcnt(0)
v_mfma_f32_16x16x32_bf16 v[48:51], a[96:99], a[0:3], 0
v_exp_f32 v72, v72
v_mfma_f32_16x16x32_bf16 v[52:55], a[96:99], a[16:19], 0
v_exp_f32 v73, v73
v_exp_f32 v74, v74
s_add_u32 s85, s2, 0
s_and_b32 s85, s85, 3
s_lshl_b32 s85, s85, 15
s_add_u32 s85, s85, s93
s_add_u32 m0, s77, 16384
s_add_u32 s94, s85, 0
buffer_load_dwordx4 v218, s[44:47], s94 offen offset:0 lds
v_mfma_f32_16x16x32_bf16 v[56:59], a[96:99], a[32:35], 0
v_exp_f32 v75, v75
v_mfma_f32_16x16x32_bf16 v[60:63], a[100:103], a[0:3], 0
v_exp_f32 v84, v84
v_mfma_f32_16x16x32_bf16 v[64:67], a[100:103], a[16:19], 0
v_exp_f32 v85, v85
s_add_u32 s94, s85, 3072
buffer_load_dwordx4 v219, s[44:47], s94 offen offset:1024 lds
v_mfma_f32_16x16x32_bf16 v[68:71], a[100:103], a[32:35], 0
v_exp_f32 v86, v86
v_exp_f32 v87, v87
v_mfma_f32_16x16x32_bf16 v[48:51], a[104:107], a[4:7], v[48:51]
v_exp_f32 v76, v76
v_mfma_f32_16x16x32_bf16 v[52:55], a[104:107], a[20:23], v[52:55]
v_exp_f32 v77, v77
s_add_u32 s94, s85, 6144
buffer_load_dwordx4 v218, s[44:47], s94 offen offset:2048 lds
v_mfma_f32_16x16x32_bf16 v[56:59], a[104:107], a[36:39], v[56:59]
v_exp_f32 v78, v78
v_mfma_f32_16x16x32_bf16 v[60:63], a[108:111], a[4:7], v[60:63]
v_exp_f32 v79, v79
v_exp_f32 v88, v88
v_mfma_f32_16x16x32_bf16 v[64:67], a[108:111], a[20:23], v[64:67]
v_exp_f32 v89, v89
s_waitcnt vmcnt(20)
ds_read_b64_tr_b16 a[128:129], v16 offset:8192
ds_read_b64_tr_b16 a[130:131], v16 offset:12288
ds_read_b64_tr_b16 a[132:133], v17 offset:8192
ds_read_b64_tr_b16 a[134:135], v17 offset:12288
ds_read_b64_tr_b16 a[136:137], v18 offset:8192
ds_read_b64_tr_b16 a[138:139], v18 offset:12288
ds_read_b64_tr_b16 a[140:141], v19 offset:8192
ds_read_b64_tr_b16 a[142:143], v19 offset:12288
ds_read_b64_tr_b16 a[144:145], v20 offset:8192
ds_read_b64_tr_b16 a[146:147], v20 offset:12288
ds_read_b64_tr_b16 a[148:149], v21 offset:8192
ds_read_b64_tr_b16 a[150:151], v21 offset:12288
ds_read_b64_tr_b16 a[152:153], v22 offset:8192
ds_read_b64_tr_b16 a[154:155], v22 offset:12288
ds_read_b64_tr_b16 a[156:157], v23 offset:8192
ds_read_b64_tr_b16 a[158:159], v23 offset:12288
v_mfma_f32_16x16x32_bf16 v[68:71], a[108:111], a[36:39], v[68:71]
v_exp_f32 v90, v90
v_mfma_f32_16x16x32_bf16 v[48:51], a[112:115], a[8:11], v[48:51]
v_exp_f32 v91, v91
v_cvt_pk_bf16_f32 v96, v72, v73
v_mfma_f32_16x16x32_bf16 v[52:55], a[112:115], a[24:27], v[52:55]
v_cvt_pk_bf16_f32 v97, v74, v75
v_cvt_pk_bf16_f32 v98, v84, v85
s_add_u32 s94, s85, 9216
buffer_load_dwordx4 v219, s[44:47], s94 offen offset:3072 lds
v_mfma_f32_16x16x32_bf16 v[56:59], a[112:115], a[40:43], v[56:59]
v_cvt_pk_bf16_f32 v99, v86, v87
v_exp_f32 v80, v80
v_mfma_f32_16x16x32_bf16 v[60:63], a[116:119], a[8:11], v[60:63]
v_exp_f32 v81, v81
v_mfma_f32_16x16x32_bf16 v[64:67], a[116:119], a[24:27], v[64:67]
v_exp_f32 v82, v82
s_add_u32 m0, s77, 20480
s_add_u32 s94, s85, 16384
buffer_load_dwordx4 v218, s[44:47], s94 offen offset:0 lds
v_mfma_f32_16x16x32_bf16 v[68:71], a[116:119], a[40:43], v[68:71]
v_exp_f32 v83, v83
v_exp_f32 v92, v92
v_mfma_f32_16x16x32_bf16 v[48:51], a[120:123], a[12:15], v[48:51]
v_exp_f32 v93, v93
v_mfma_f32_16x16x32_bf16 v[52:55], a[120:123], a[28:31], v[52:55]
v_exp_f32 v94, v94
s_add_u32 s94, s85, 19456
buffer_load_dwordx4 v219, s[44:47], s94 offen offset:1024 lds
v_mfma_f32_16x16x32_bf16 v[56:59], a[120:123], a[44:47], v[56:59]
v_exp_f32 v95, v95
v_cvt_pk_bf16_f32 v100, v76, v77
v_mfma_f32_16x16x32_bf16 v[60:63], a[124:127], a[12:15], v[60:63]
v_cvt_pk_bf16_f32 v101, v78, v79
v_cvt_pk_bf16_f32 v102, v88, v89
s_add_u32 s94, s85, 22528
buffer_load_dwordx4 v218, s[44:47], s94 offen offset:2048 lds
v_mfma_f32_16x16x32_bf16 v[64:67], a[124:127], a[28:31], v[64:67]
v_cvt_pk_bf16_f32 v103, v90, v91
v_cvt_pk_bf16_f32 v104, v80, v81
v_cvt_pk_bf16_f32 v105, v82, v83
v_mfma_f32_16x16x32_bf16 v[68:71], a[124:127], a[44:47], v[68:71]
v_cvt_pk_bf16_f32 v106, v92, v93
v_cvt_pk_bf16_f32 v107, v94, v95
s_add_u32 s94, s85, 25600
buffer_load_dwordx4 v219, s[44:47], s94 offen offset:3072 lds
s_waitcnt lgkmcnt(0)
v_mfma_f32_16x16x32_bf16 v[120:123], a[128:131], v[96:99], v[120:123]
v_add_f32 v31, v31, v72
v_add_f32 v33, v33, v76
v_add_f32 v35, v35, v80
v_mfma_f32_16x16x32_bf16 v[124:127], a[128:131], v[100:103], v[124:127]
v_add_f32 v31, v31, v73
v_add_f32 v33, v33, v77
s_add_u32 s98, s84, s97
s_and_b32 s98, s98, 3
s_and_b32 s83, s84, -4
s_or_b32 s83, s83, s98
s_lshl_b32 s83, s83, 15
s_add_u32 s83, s83, s99
s_add_u32 s84, s84, 1
s_add_u32 m0, s77, 8192
s_add_u32 s94, s83, 0
buffer_load_dwordx4 v28, s[32:35], s94 offen offset:0 nt lds
v_mfma_f32_16x16x32_bf16 v[128:131], a[128:131], v[104:107], v[128:131]
v_add_f32 v35, v35, v81
v_add_f32 v31, v31, v74
v_add_f32 v33, v33, v78
v_mfma_f32_16x16x32_bf16 v[132:135], a[132:135], v[96:99], v[132:135]
v_add_f32 v35, v35, v82
v_add_f32 v31, v31, v75
v_mfma_f32_16x16x32_bf16 v[136:139], a[132:135], v[100:103], v[136:139]
v_add_f32 v33, v33, v79
v_add_f32 v35, v35, v83
v_add_f32 v31, v31, v84
buffer_load_dwordx4 v29, s[32:35], s94 offen offset:1024 nt lds
v_mfma_f32_16x16x32_bf16 v[140:143], a[132:135], v[104:107], v[140:143]
v_add_f32 v33, v33, v88
v_add_f32 v35, v35, v92
v_mfma_f32_16x16x32_bf16 v[144:147], a[136:139], v[96:99], v[144:147]
v_add_f32 v31, v31, v85
v_add_f32 v33, v33, v89
v_add_f32 v35, v35, v93
v_mfma_f32_16x16x32_bf16 v[148:151], a[136:139], v[100:103], v[148:151]
v_add_f32 v31, v31, v86
v_add_f32 v33, v33, v90
buffer_load_dwordx4 v28, s[32:35], s94 offen offset:2048 nt lds
v_mfma_f32_16x16x32_bf16 v[152:155], a[136:139], v[104:107], v[152:155]
v_add_f32 v35, v35, v94
v_add_f32 v31, v31, v87
v_add_f32 v33, v33, v91
v_mfma_f32_16x16x32_bf16 v[156:159], a[140:143], v[96:99], v[156:159]
v_add_f32 v35, v35, v95
v_fma_f32 v48, v48, s89, -v30
v_mfma_f32_16x16x32_bf16 v[160:163], a[140:143], v[100:103], v[160:163]
v_fma_f32 v49, v49, s89, -v30
v_fma_f32 v50, v50, s89, -v30
v_fma_f32 v51, v51, s89, -v30
s_waitcnt vmcnt(19)
ds_read_b128 a[96:99], v24 offset:0
ds_read_b128 a[100:103], v24 offset:4096
ds_read_b128 a[104:107], v25 offset:0
ds_read_b128 a[108:111], v25 offset:4096
ds_read_b128 a[112:115], v26 offset:0
ds_read_b128 a[116:119], v26 offset:4096
ds_read_b128 a[120:123], v27 offset:0
ds_read_b128 a[124:127], v27 offset:4096
v_mfma_f32_16x16x32_bf16 v[164:167], a[140:143], v[104:107], v[164:167]
v_fma_f32 v52, v52, s89, -v32
v_fma_f32 v53, v53, s89, -v32
v_fma_f32 v54, v54, s89, -v32
v_mfma_f32_16x16x32_bf16 v[168:171], a[144:147], v[96:99], v[168:171]
v_fma_f32 v55, v55, s89, -v32
v_fma_f32 v56, v56, s89, -v34
v_mfma_f32_16x16x32_bf16 v[172:175], a[144:147], v[100:103], v[172:175]
v_fma_f32 v57, v57, s89, -v34
v_fma_f32 v58, v58, s89, -v34
v_fma_f32 v59, v59, s89, -v34
buffer_load_dwordx4 v29, s[32:35], s94 offen offset:3072 nt lds
v_mfma_f32_16x16x32_bf16 v[176:179], a[144:147], v[104:107], v[176:179]
v_fma_f32 v60, v60, s89, -v30
v_fma_f32 v61, v61, s89, -v30
v_mfma_f32_16x16x32_bf16 v[180:183], a[148:151], v[96:99], v[180:183]
v_fma_f32 v62, v62, s89, -v30
v_fma_f32 v63, v63, s89, -v30
v_fma_f32 v64, v64, s89, -v32
v_mfma_f32_16x16x32_bf16 v[184:187], a[148:151], v[100:103], v[184:187]
v_fma_f32 v65, v65, s89, -v32
v_fma_f32 v66, v66, s89, -v32
s_add_u32 m0, s77, 12288
s_add_u32 s94, s83, 4096
buffer_load_dwordx4 v28, s[32:35], s94 offen offset:0 nt lds
v_mfma_f32_16x16x32_bf16 v[188:191], a[148:151], v[104:107], v[188:191]
v_fma_f32 v67, v67, s89, -v32
v_fma_f32 v68, v68, s89, -v34
v_fma_f32 v69, v69, s89, -v34
v_mfma_f32_16x16x32_bf16 v[192:195], a[152:155], v[96:99], v[192:195]
v_fma_f32 v70, v70, s89, -v34
v_fma_f32 v71, v71, s89, -v34
v_mfma_f32_16x16x32_bf16 v[196:199], a[152:155], v[100:103], v[196:199]
v_max3_f32 v36, v48, v49, v50
v_max3_f32 v37, v52, v53, v54
v_max3_f32 v38, v56, v57, v58
buffer_load_dwordx4 v29, s[32:35], s94 offen offset:1024 nt lds
v_mfma_f32_16x16x32_bf16 v[200:203], a[152:155], v[104:107], v[200:203]
v_max3_f32 v36, v36, v51, v60
v_max3_f32 v37, v37, v55, v64
v_mfma_f32_16x16x32_bf16 v[204:207], a[156:159], v[96:99], v[204:207]
v_max3_f32 v38, v38, v59, v68
v_max3_f32 v36, v36, v61, v62
v_max3_f32 v37, v37, v65, v66
buffer_load_dwordx4 v28, s[32:35], s94 offen offset:2048 nt lds
v_mfma_f32_16x16x32_bf16 v[208:211], a[156:159], v[100:103], v[208:211]
v_max3_f32 v38, v38, v69, v70
v_max_f32 v36, v36, v63
v_mfma_f32_16x16x32_bf16 v[212:215], a[156:159], v[104:107], v[212:215]
v_max_f32 v37, v37, v67
v_max_f32 v38, v38, v71
v_max3_f32 v39, v36, v37, v38
buffer_load_dwordx4 v29, s[32:35], s94 offen offset:3072 nt lds
v_cmp_lt_f32 vcc, s87, v39
s_cbranch_vccz L_fast16
s_call_b64 s[90:91], L_rescale0
L_fast16:
s_waitcnt lgkmcnt(0)
s_mov_b32 s79, 20000
L_cchk:
v_readfirstlane_b32 s95, v14
s_nop 3
s_cmp_eq_u32 s95, 256
s_cbranch_scc1 L_cok
s_sleep 2
buffer_load_dword v14, v15, s[36:39], 0 offen sc1
s_waitcnt vmcnt(0)
s_sub_u32 s79, s79, 1
s_cmp_lg_u32 s79, 0
s_cbranch_scc1 L_cchk
L_cok:
buffer_load_dword v13, v15, s[4:7], s8 offen sc1
v_mfma_f32_16x16x32_bf16 v[72:75], a[96:99], a[0:3], 0
v_exp_f32 v48, v48
v_mfma_f32_16x16x32_bf16 v[76:79], a[96:99], a[16:19], 0
v_exp_f32 v49, v49
v_exp_f32 v50, v50
v_mfma_f32_16x16x32_bf16 v[80:83], a[96:99], a[32:35], 0
v_exp_f32 v51, v51
v_mfma_f32_16x16x32_bf16 v[84:87], a[100:103], a[0:3], 0
v_exp_f32 v60, v60
v_mfma_f32_16x16x32_bf16 v[88:91], a[100:103], a[16:19], 0
v_exp_f32 v61, v61
v_mfma_f32_16x16x32_bf16 v[92:95], a[100:103], a[32:35], 0
v_exp_f32 v62, v62
v_exp_f32 v63, v63
v_mfma_f32_16x16x32_bf16 v[72:75], a[104:107], a[4:7], v[72:75]
v_exp_f32 v52, v52
v_mfma_f32_16x16x32_bf16 v[76:79], a[104:107], a[20:23], v[76:79]
v_exp_f32 v53, v53
v_mfma_f32_16x16x32_bf16 v[80:83], a[104:107], a[36:39], v[80:83]
v_exp_f32 v54, v54
v_mfma_f32_16x16x32_bf16 v[84:87], a[108:111], a[4:7], v[84:87]
v_exp_f32 v55, v55
v_exp_f32 v64, v64
v_mfma_f32_16x16x32_bf16 v[88:91], a[108:111], a[20:23], v[88:91]
v_exp_f32 v65, v65
s_waitcnt vmcnt(17)
ds_read_b64_tr_b16 a[128:129], v16 offset:24576
ds_read_b64_tr_b16 a[130:131], v16 offset:28672
ds_read_b64_tr_b16 a[132:133], v17 offset:24576
ds_read_b64_tr_b16 a[134:135], v17 offset:28672
ds_read_b64_tr_b16 a[136:137], v18 offset:24576
ds_read_b64_tr_b16 a[138:139], v18 offset:28672
ds_read_b64_tr_b16 a[140:141], v19 offset:24576
ds_read_b64_tr_b16 a[142:143], v19 offset:28672
ds_read_b64_tr_b16 a[144:145], v20 offset:24576
ds_read_b64_tr_b16 a[146:147], v20 offset:28672
ds_read_b64_tr_b16 a[148:149], v21 offset:24576
ds_read_b64_tr_b16 a[150:151], v21 offset:28672
ds_read_b64_tr_b16 a[152:153], v22 offset:24576
ds_read_b64_tr_b16 a[154:155], v22 offset:28672
ds_read_b64_tr_b16 a[156:157], v23 offset:24576
ds_read_b64_tr_b16 a[158:159], v23 offset:28672
v_mfma_f32_16x16x32_bf16 v[92:95], a[108:111], a[36:39], v[92:95]
v_exp_f32 v66, v66
v_mfma_f32_16x16x32_bf16 v[72:75], a[112:115], a[8:11], v[72:75]
v_exp_f32 v67, v67
v_cvt_pk_bf16_f32 v96, v48, v49
v_mfma_f32_16x16x32_bf16 v[76:79], a[112:115], a[24:27], v[76:79]
v_cvt_pk_bf16_f32 v97, v50, v51
v_cvt_pk_bf16_f32 v98, v60, v61
v_mfma_f32_16x16x32_bf16 v[80:83], a[112:115], a[40:43], v[80:83]
v_cvt_pk_bf16_f32 v99, v62, v63
v_exp_f32 v56, v56
v_mfma_f32_16x16x32_bf16 v[84:87], a[116:119], a[8:11], v[84:87]
v_exp_f32 v57, v57
v_mfma_f32_16x16x32_bf16 v[88:91], a[116:119], a[24:27], v[88:91]
v_exp_f32 v58, v58
v_mfma_f32_16x16x32_bf16 v[92:95], a[116:119], a[40:43], v[92:95]
v_exp_f32 v59, v59
v_exp_f32 v68, v68
v_mfma_f32_16x16x32_bf16 v[72:75], a[120:123], a[12:15], v[72:75]
v_exp_f32 v69, v69
v_mfma_f32_16x16x32_bf16 v[76:79], a[120:123], a[28:31], v[76:79]
v_exp_f32 v70, v70
v_mfma_f32_16x16x32_bf16 v[80:83], a[120:123], a[44:47], v[80:83]
v_exp_f32 v71, v71
v_cvt_pk_bf16_f32 v100, v52, v53
v_mfma_f32_16x16x32_bf16 v[84:87], a[124:127], a[12:15], v[84:87]
v_cvt_pk_bf16_f32 v101, v54, v55
v_cvt_pk_bf16_f32 v102, v64, v65
v_mfma_f32_16x16x32_bf16 v[88:91], a[124:127], a[28:31], v[88:91]
v_cvt_pk_bf16_f32 v103, v66, v67
v_cvt_pk_bf16_f32 v104, v56, v57
v_cvt_pk_bf16_f32 v105, v58, v59
v_mfma_f32_16x16x32_bf16 v[92:95], a[124:127], a[44:47], v[92:95]
v_cvt_pk_bf16_f32 v106, v68, v69
v_cvt_pk_bf16_f32 v107, v70, v71
s_waitcnt lgkmcnt(0)
v_mfma_f32_16x16x32_bf16 v[120:123], a[128:131], v[96:99], v[120:123]
v_add_f32 v31, v31, v48
v_add_f32 v33, v33, v52
v_add_f32 v35, v35, v56
v_mfma_f32_16x16x32_bf16 v[124:127], a[128:131], v[100:103], v[124:127]
v_add_f32 v31, v31, v49
v_add_f32 v33, v33, v53
s_add_u32 s85, s2, 1
s_and_b32 s85, s85, 3
s_lshl_b32 s85, s85, 15
s_add_u32 s85, s85, s93
s_add_u32 m0, s77, 24576
s_add_u32 s94, s85, 0
buffer_load_dwordx4 v218, s[44:47], s94 offen offset:0 lds
v_mfma_f32_16x16x32_bf16 v[128:131], a[128:131], v[104:107], v[128:131]
v_add_f32 v35, v35, v57
v_add_f32 v31, v31, v50
v_add_f32 v33, v33, v54
v_mfma_f32_16x16x32_bf16 v[132:135], a[132:135], v[96:99], v[132:135]
v_add_f32 v35, v35, v58
v_add_f32 v31, v31, v51
v_mfma_f32_16x16x32_bf16 v[136:139], a[132:135], v[100:103], v[136:139]
v_add_f32 v33, v33, v55
v_add_f32 v35, v35, v59
v_add_f32 v31, v31, v60
s_add_u32 s94, s85, 3072
buffer_load_dwordx4 v219, s[44:47], s94 offen offset:1024 lds
v_mfma_f32_16x16x32_bf16 v[140:143], a[132:135], v[104:107], v[140:143]
v_add_f32 v33, v33, v64
v_add_f32 v35, v35, v68
v_mfma_f32_16x16x32_bf16 v[144:147], a[136:139], v[96:99], v[144:147]
v_add_f32 v31, v31, v61
v_add_f32 v33, v33, v65
v_add_f32 v35, v35, v69
v_mfma_f32_16x16x32_bf16 v[148:151], a[136:139], v[100:103], v[148:151]
v_add_f32 v31, v31, v62
v_add_f32 v33, v33, v66
s_add_u32 s94, s85, 6144
buffer_load_dwordx4 v218, s[44:47], s94 offen offset:2048 lds
v_mfma_f32_16x16x32_bf16 v[152:155], a[136:139], v[104:107], v[152:155]
v_add_f32 v35, v35, v70
v_add_f32 v31, v31, v63
v_add_f32 v33, v33, v67
v_mfma_f32_16x16x32_bf16 v[156:159], a[140:143], v[96:99], v[156:159]
v_add_f32 v35, v35, v71
v_fma_f32 v72, v72, s89, -v30
v_mfma_f32_16x16x32_bf16 v[160:163], a[140:143], v[100:103], v[160:163]
v_fma_f32 v73, v73, s89, -v30
v_fma_f32 v74, v74, s89, -v30
v_fma_f32 v75, v75, s89, -v30
v_mfma_f32_16x16x32_bf16 v[164:167], a[140:143], v[104:107], v[164:167]
v_fma_f32 v76, v76, s89, -v32
v_fma_f32 v77, v77, s89, -v32
v_fma_f32 v78, v78, s89, -v32
v_mfma_f32_16x16x32_bf16 v[168:171], a[144:147], v[96:99], v[168:171]
v_fma_f32 v79, v79, s89, -v32
v_fma_f32 v80, v80, s89, -v34
v_mfma_f32_16x16x32_bf16 v[172:175], a[144:147], v[100:103], v[172:175]
v_fma_f32 v81, v81, s89, -v34
v_fma_f32 v82, v82, s89, -v34
v_fma_f32 v83, v83, s89, -v34
s_add_u32 s94, s85, 9216
buffer_load_dwordx4 v219, s[44:47], s94 offen offset:3072 lds
v_mfma_f32_16x16x32_bf16 v[176:179], a[144:147], v[104:107], v[176:179]
v_fma_f32 v84, v84, s89, -v30
v_fma_f32 v85, v85, s89, -v30
v_mfma_f32_16x16x32_bf16 v[180:183], a[148:151], v[96:99], v[180:183]
v_fma_f32 v86, v86, s89, -v30
v_fma_f32 v87, v87, s89, -v30
v_fma_f32 v88, v88, s89, -v32
v_mfma_f32_16x16x32_bf16 v[184:187], a[148:151], v[100:103], v[184:187]
v_fma_f32 v89, v89, s89, -v32
v_fma_f32 v90, v90, s89, -v32
s_add_u32 m0, s77, 28672
s_add_u32 s94, s85, 16384
buffer_load_dwordx4 v218, s[44:47], s94 offen offset:0 lds
v_mfma_f32_16x16x32_bf16 v[188:191], a[148:151], v[104:107], v[188:191]
v_fma_f32 v91, v91, s89, -v32
v_fma_f32 v92, v92, s89, -v34
v_fma_f32 v93, v93, s89, -v34
v_mfma_f32_16x16x32_bf16 v[192:195], a[152:155], v[96:99], v[192:195]
v_fma_f32 v94, v94, s89, -v34
v_fma_f32 v95, v95, s89, -v34
v_mfma_f32_16x16x32_bf16 v[196:199], a[152:155], v[100:103], v[196:199]
v_max3_f32 v36, v72, v73, v74
v_max3_f32 v37, v76, v77, v78
v_max3_f32 v38, v80, v81, v82
s_add_u32 s94, s85, 19456
buffer_load_dwordx4 v219, s[44:47], s94 offen offset:1024 lds
v_mfma_f32_16x16x32_bf16 v[200:203], a[152:155], v[104:107], v[200:203]
v_max3_f32 v36, v36, v75, v84
v_max3_f32 v37, v37, v79, v88
v_mfma_f32_16x16x32_bf16 v[204:207], a[156:159], v[96:99], v[204:207]
v_max3_f32 v38, v38, v83, v92
v_max3_f32 v36, v36, v85, v86
v_max3_f32 v37, v37, v89, v90
s_add_u32 s94, s85, 22528
buffer_load_dwordx4 v218, s[44:47], s94 offen offset:2048 lds
v_mfma_f32_16x16x32_bf16 v[208:211], a[156:159], v[100:103], v[208:211]
v_max3_f32 v38, v38, v93, v94
v_max_f32 v36, v36, v87
v_mfma_f32_16x16x32_bf16 v[212:215], a[156:159], v[104:107], v[212:215]
v_max_f32 v37, v37, v91
v_max_f32 v38, v38, v95
v_max3_f32 v39, v36, v37, v38
s_add_u32 s94, s85, 25600
buffer_load_dwordx4 v219, s[44:47], s94 offen offset:3072 lds
v_cmp_lt_f32 vcc, s87, v39
s_cbranch_vccz L_fast17
s_call_b64 s[90:91], L_rescale1
L_fast17:
s_waitcnt lgkmcnt(0)
s_waitcnt vmcnt(9)
ds_read_b64_tr_b16 a[128:129], v16 offset:8192
ds_read_b64_tr_b16 a[130:131], v16 offset:12288
ds_read_b64_tr_b16 a[132:133], v17 offset:8192
ds_read_b64_tr_b16 a[134:135], v17 offset:12288
ds_read_b64_tr_b16 a[136:137], v18 offset:8192
ds_read_b64_tr_b16 a[138:139], v18 offset:12288
ds_read_b64_tr_b16 a[140:141], v19 offset:8192
ds_read_b64_tr_b16 a[142:143], v19 offset:12288
ds_read_b64_tr_b16 a[144:145], v20 offset:8192
ds_read_b64_tr_b16 a[146:147], v20 offset:12288
ds_read_b64_tr_b16 a[148:149], v21 offset:8192
ds_read_b64_tr_b16 a[150:151], v21 offset:12288
ds_read_b64_tr_b16 a[152:153], v22 offset:8192
ds_read_b64_tr_b16 a[154:155], v22 offset:12288
ds_read_b64_tr_b16 a[156:157], v23 offset:8192
ds_read_b64_tr_b16 a[158:159], v23 offset:12288
v_exp_f32 v72, v72
v_exp_f32 v73, v73
v_exp_f32 v74, v74
v_exp_f32 v75, v75
v_exp_f32 v84, v84
v_exp_f32 v85, v85
v_exp_f32 v86, v86
v_exp_f32 v87, v87
v_exp_f32 v76, v76
v_exp_f32 v77, v77
v_exp_f32 v78, v78
v_exp_f32 v79, v79
v_exp_f32 v88, v88
v_exp_f32 v89, v89
v_exp_f32 v90, v90
v_exp_f32 v91, v91
v_cvt_pk_bf16_f32 v96, v72, v73
v_cvt_pk_bf16_f32 v97, v74, v75
v_cvt_pk_bf16_f32 v98, v84, v85
v_cvt_pk_bf16_f32 v99, v86, v87
v_exp_f32 v80, v80
v_exp_f32 v81, v81
v_exp_f32 v82, v82
v_exp_f32 v83, v83
v_exp_f32 v92, v92
v_exp_f32 v93, v93
v_exp_f32 v94, v94
v_exp_f32 v95, v95
v_cvt_pk_bf16_f32 v100, v76, v77
v_cvt_pk_bf16_f32 v101, v78, v79
v_cvt_pk_bf16_f32 v102, v88, v89
v_cvt_pk_bf16_f32 v103, v90, v91
v_cvt_pk_bf16_f32 v104, v80, v81
v_cvt_pk_bf16_f32 v105, v82, v83
v_cvt_pk_bf16_f32 v106, v92, v93
v_cvt_pk_bf16_f32 v107, v94, v95
s_waitcnt lgkmcnt(0)
v_mfma_f32_16x16x32_bf16 v[120:123], a[128:131], v[96:99], v[120:123]
v_add_f32 v31, v31, v72
v_mfma_f32_16x16x32_bf16 v[124:127], a[128:131], v[100:103], v[124:127]
v_add_f32 v33, v33, v76
v_mfma_f32_16x16x32_bf16 v[128:131], a[128:131], v[104:107], v[128:131]
v_add_f32 v35, v35, v80
v_mfma_f32_16x16x32_bf16 v[132:135], a[132:135], v[96:99], v[132:135]
v_add_f32 v31, v31, v73
v_mfma_f32_16x16x32_bf16 v[136:139], a[132:135], v[100:103], v[136:139]
v_add_f32 v33, v33, v77
v_mfma_f32_16x16x32_bf16 v[140:143], a[132:135], v[104:107], v[140:143]
v_add_f32 v35, v35, v81
v_mfma_f32_16x16x32_bf16 v[144:147], a[136:139], v[96:99], v[144:147]
v_add_f32 v31, v31, v74
v_mfma_f32_16x16x32_bf16 v[148:151], a[136:139], v[100:103], v[148:151]
v_add_f32 v33, v33, v78
v_mfma_f32_16x16x32_bf16 v[152:155], a[136:139], v[104:107], v[152:155]
v_add_f32 v35, v35, v82
v_mfma_f32_16x16x32_bf16 v[156:159], a[140:143], v[96:99], v[156:159]
v_add_f32 v31, v31, v75
v_mfma_f32_16x16x32_bf16 v[160:163], a[140:143], v[100:103], v[160:163]
v_add_f32 v33, v33, v79
v_mfma_f32_16x16x32_bf16 v[164:167], a[140:143], v[104:107], v[164:167]
v_add_f32 v35, v35, v83
v_mfma_f32_16x16x32_bf16 v[168:171], a[144:147], v[96:99], v[168:171]
v_add_f32 v31, v31, v84
v_mfma_f32_16x16x32_bf16 v[172:175], a[144:147], v[100:103], v[172:175]
v_add_f32 v33, v33, v88
v_mfma_f32_16x16x32_bf16 v[176:179], a[144:147], v[104:107], v[176:179]
v_add_f32 v35, v35, v92
v_mfma_f32_16x16x32_bf16 v[180:183], a[148:151], v[96:99], v[180:183]
v_add_f32 v31, v31, v85
v_mfma_f32_16x16x32_bf16 v[184:187], a[148:151], v[100:103], v[184:187]
v_add_f32 v33, v33, v89
v_mfma_f32_16x16x32_bf16 v[188:191], a[148:151], v[104:107], v[188:191]
v_add_f32 v35, v35, v93
v_mfma_f32_16x16x32_bf16 v[192:195], a[152:155], v[96:99], v[192:195]
v_add_f32 v31, v31, v86
v_mfma_f32_16x16x32_bf16 v[196:199], a[152:155], v[100:103], v[196:199]
v_add_f32 v33, v33, v90
v_mfma_f32_16x16x32_bf16 v[200:203], a[152:155], v[104:107], v[200:203]
v_add_f32 v35, v35, v94
v_mfma_f32_16x16x32_bf16 v[204:207], a[156:159], v[96:99], v[204:207]
v_add_f32 v31, v31, v87
v_mfma_f32_16x16x32_bf16 v[208:211], a[156:159], v[100:103], v[208:211]
v_add_f32 v33, v33, v91
v_mfma_f32_16x16x32_bf16 v[212:215], a[156:159], v[104:107], v[212:215]
v_add_f32 v35, v35, v95
s_waitcnt vmcnt(8)
s_mov_b32 s79, 20000
L_qchk:
v_readfirstlane_b32 s95, v13
s_nop 3
s_cmp_eq_u32 s95, 1
s_cbranch_scc1 L_qok
s_sleep 2
buffer_load_dword v13, v15, s[4:7], s8 offen sc1
s_waitcnt vmcnt(0)
s_sub_u32 s79, s79, 1
s_cmp_lg_u32 s79, 0
s_cbranch_scc1 L_qchk
L_qok:
s_mov_b32 s95, 0
buffer_load_dwordx4 a[0:3], v220, s[64:67], s95 offen offset:0 sc1
buffer_load_dwordx4 a[16:19], v220, s[64:67], s95 offen offset:1024 sc1
buffer_load_dwordx4 a[32:35], v220, s[64:67], s95 offen offset:2048 sc1
buffer_load_dwordx4 a[4:7], v220, s[64:67], s95 offen offset:3072 sc1
s_mov_b32 s95, 4096
buffer_load_dwordx4 a[20:23], v220, s[64:67], s95 offen offset:0 sc1
buffer_load_dwordx4 a[36:39], v220, s[64:67], s95 offen offset:1024 sc1
buffer_load_dwordx4 a[8:11], v220, s[64:67], s95 offen offset:2048 sc1
buffer_load_dwordx4 a[24:27], v220, s[64:67], s95 offen offset:3072 sc1
s_mov_b32 s95, 8192
buffer_load_dwordx4 a[40:43], v220, s[64:67], s95 offen offset:0 sc1
buffer_load_dwordx4 a[12:15], v220, s[64:67], s95 offen offset:1024 sc1
buffer_load_dwordx4 a[28:31], v220, s[64:67], s95 offen offset:2048 sc1
buffer_load_dwordx4 a[44:47], v220, s[64:67], s95 offen offset:3072 sc1
s_mov_b32 s96, 0
s_mov_b32 s84, 0
v_mov_b32 v44, v31
v_mov_b32 v45, v33
v_mov_b32 v46, v35
s_nop 0
v_permlane32_swap_b32 v31, v44
v_permlane32_swap_b32 v33, v45
v_permlane32_swap_b32 v35, v46
s_nop 0
v_add_f32 v31, v31, v44
v_add_f32 v33, v33, v45
v_add_f32 v35, v35, v46
v_mov_b32 v44, v31
v_mov_b32 v45, v33
v_mov_b32 v46, v35
s_nop 0
v_permlane16_swap_b32 v31, v44
v_permlane16_swap_b32 v33, v45
v_permlane16_swap_b32 v35, v46
s_nop 0
v_add_f32 v31, v31, v44
v_add_f32 v33, v33, v45
v_add_f32 v35, v35, v46
v_and_b32 v36, 15, v0
v_lshlrev_b32 v36, 3, v36
s_lshl_b32 s79, s76, 13
s_add_u32 s79, s79, 137216
v_add_u32 v37, s79, v36
ds_write_b64 v37, v[30:31] offset:0
ds_write_b64 v37, v[32:33] offset:128
ds_write_b64 v37, v[34:35] offset:256
s_waitcnt lgkmcnt(0)
s_barrier
v_and_b32 v36, 15, v0
v_lshlrev_b32 v36, 3, v36
s_sub_u32 s79, s76, 0
s_and_b32 s79, s79, 3
s_lshl_b32 s79, s79, 13
s_add_u32 s79, s79, 137216
v_add_u32 v37, s79, v36
s_sub_u32 s79, s76, 1
s_and_b32 s79, s79, 3
s_lshl_b32 s79, s79, 13
s_add_u32 s79, s79, 137216
v_add_u32 v38, s79, v36
s_sub_u32 s79, s76, 2
s_and_b32 s79, s79, 3
s_lshl_b32 s79, s79, 13
s_add_u32 s79, s79, 137216
v_add_u32 v39, s79, v36
s_sub_u32 s79, s76, 3
s_and_b32 s79, s79, 3
s_lshl_b32 s79, s79, 13
s_add_u32 s79, s79, 137216
v_add_u32 v40, s79, v36
ds_read_b64 v[48:49], v37 offset:0
ds_read_b64 v[50:51], v37 offset:128
ds_read_b64 v[52:53], v37 offset:256
ds_read_b64 v[54:55], v38 offset:0
ds_read_b64 v[56:57], v38 offset:128
ds_read_b64 v[58:59], v38 offset:256
ds_read_b64 v[60:61], v39 offset:0
ds_read_b64 v[62:63], v39 offset:128
ds_read_b64 v[64:65], v39 offset:256
ds_read_b64 v[66:67], v40 offset:0
ds_read_b64 v[68:69], v40 offset:128
ds_read_b64 v[70:71], v40 offset:256
s_add_u32 s79, s76, 1
s_and_b32 s79, s79, 3
s_lshl_b32 s79, s79, 15
v_add_u32 v42, s79, v220
s_add_u32 s79, s76, 2
s_and_b32 s79, s79, 3
s_lshl_b32 s79, s79, 15
v_add_u32 v43, s79, v220
s_add_u32 s79, s76, 3
s_and_b32 s79, s79, 3
s_lshl_b32 s79, s79, 13
s_add_u32 s79, s79, 131072
v_add_u32 v44, s79, v220
ds_write_b128 v42, v[144:147] offset:0
ds_write_b128 v42, v[148:151] offset:1024
ds_write_b128 v42, v[152:155] offset:2048
ds_write_b128 v42, v[156:159] offset:3072
ds_write_b128 v42, v[160:163] offset:4096
ds_write_b128 v42, v[164:167] offset:5120
ds_write_b128 v43, v[168:171] offset:8192
ds_write_b128 v43, v[172:175] offset:9216
ds_write_b128 v43, v[176:179] offset:10240
ds_write_b128 v43, v[180:183] offset:11264
ds_write_b128 v43, v[184:187] offset:12288
ds_write_b128 v43, v[188:191] offset:13312
ds_write_b128 v44, v[192:195] offset:0
ds_write_b128 v44, v[196:199] offset:1024
ds_write_b128 v44, v[200:203] offset:2048
ds_write_b128 v44, v[204:207] offset:3072
ds_write_b128 v44, v[208:211] offset:4096
ds_write_b128 v44, v[212:215] offset:5120
s_waitcnt lgkmcnt(15)
v_max3_f32 v36, v48, v54, v60
v_max_f32 v36, v36, v66
v_sub_f32 v48, v48, v36
v_sub_f32 v54, v54, v36
v_sub_f32 v60, v60, v36
v_sub_f32 v66, v66, v36
v_exp_f32 v48, v48
v_exp_f32 v54, v54
v_exp_f32 v60, v60
v_exp_f32 v66, v66
s_nop 0
v_mul_f32 v37, v48, v49
v_fma_f32 v37, v54, v55, v37
v_fma_f32 v37, v60, v61, v37
v_fma_f32 v37, v66, v67, v37
v_rcp_f32 v37, v37
s_nop 0
v_mul_f32 v1, v48, v37
v_mul_f32 v4, v54, v37
v_mul_f32 v7, v60, v37
v_mul_f32 v10, v66, v37
v_max3_f32 v36, v50, v56, v62
v_max_f32 v36, v36, v68
v_sub_f32 v50, v50, v36
v_sub_f32 v56, v56, v36
v_sub_f32 v62, v62, v36
v_sub_f32 v68, v68, v36
v_exp_f32 v50, v50
v_exp_f32 v56, v56
v_exp_f32 v62, v62
v_exp_f32 v68, v68
s_nop 0
v_mul_f32 v37, v50, v51
v_fma_f32 v37, v56, v57, v37
v_fma_f32 v37, v62, v63, v37
v_fma_f32 v37, v68, v69, v37
v_rcp_f32 v37, v37
s_nop 0
v_mul_f32 v2, v50, v37
v_mul_f32 v5, v56, v37
v_mul_f32 v8, v62, v37
v_mul_f32 v11, v68, v37
v_max3_f32 v36, v52, v58, v64
v_max_f32 v36, v36, v70
v_sub_f32 v52, v52, v36
v_sub_f32 v58, v58, v36
v_sub_f32 v64, v64, v36
v_sub_f32 v70, v70, v36
v_exp_f32 v52, v52
v_exp_f32 v58, v58
v_exp_f32 v64, v64
v_exp_f32 v70, v70
s_nop 0
v_mul_f32 v37, v52, v53
v_fma_f32 v37, v58, v59, v37
v_fma_f32 v37, v64, v65, v37
v_fma_f32 v37, v70, v71, v37
v_rcp_f32 v37, v37
s_nop 0
v_mul_f32 v3, v52, v37
v_mul_f32 v6, v58, v37
v_mul_f32 v9, v64, v37
v_mul_f32 v12, v70, v37
v_add_u32 v38, s77, v220
s_lshl_b32 s79, s76, 13
s_add_u32 s79, s79, 131072
v_add_u32 v39, s79, v220
s_waitcnt lgkmcnt(0)
s_barrier
ds_read_b128 v[48:51], v38 offset:0
ds_read_b128 v[52:55], v38 offset:1024
ds_read_b128 v[56:59], v38 offset:2048
ds_read_b128 v[60:63], v38 offset:3072
ds_read_b128 v[64:67], v38 offset:4096
ds_read_b128 v[68:71], v38 offset:5120
ds_read_b128 v[72:75], v38 offset:8192
ds_read_b128 v[76:79], v38 offset:9216
ds_read_b128 v[80:83], v38 offset:10240
ds_read_b128 v[84:87], v38 offset:11264
ds_read_b128 v[88:91], v38 offset:12288
ds_read_b128 v[92:95], v38 offset:13312
ds_read_b128 v[96:99], v39 offset:0
ds_read_b128 v[100:103], v39 offset:1024
ds_read_b128 v[104:107], v39 offset:2048
ds_read_b128 v[108:111], v39 offset:3072
ds_read_b128 v[112:115], v39 offset:4096
ds_read_b128 v[116:119], v39 offset:5120
v_add_u32 v40, s79, v220
v_mul_f32 v120, v120, v1
v_mul_f32 v121, v121, v1
v_mul_f32 v122, v122, v1
v_mul_f32 v123, v123, v1
v_mul_f32 v124, v124, v2
v_mul_f32 v125, v125, v2
v_mul_f32 v126, v126, v2
v_mul_f32 v127, v127, v2
v_mul_f32 v128, v128, v3
v_mul_f32 v129, v129, v3
v_mul_f32 v130, v130, v3
v_mul_f32 v131, v131, v3
v_mul_f32 v132, v132, v1
v_mul_f32 v133, v133, v1
v_mul_f32 v134, v134, v1
v_mul_f32 v135, v135, v1
v_mul_f32 v136, v136, v2
v_mul_f32 v137, v137, v2
v_mul_f32 v138, v138, v2
v_mul_f32 v139, v139, v2
v_mul_f32 v140, v140, v3
v_mul_f32 v141, v141, v3
v_mul_f32 v142, v142, v3
v_mul_f32 v143, v143, v3
s_waitcnt lgkmcnt(12)
v_fmac_f32 v120, v48, v4
v_fmac_f32 v121, v49, v4
v_fmac_f32 v122, v50, v4
v_fmac_f32 v123, v51, v4
v_fmac_f32 v124, v52, v5
v_fmac_f32 v125, v53, v5
v_fmac_f32 v126, v54, v5
v_fmac_f32 v127, v55, v5
v_fmac_f32 v128, v56, v6
v_fmac_f32 v129, v57, v6
v_fmac_f32 v130, v58, v6
v_fmac_f32 v131, v59, v6
v_fmac_f32 v132, v60, v4
v_fmac_f32 v133, v61, v4
v_fmac_f32 v134, v62, v4
v_fmac_f32 v135, v63, v4
v_fmac_f32 v136, v64, v5
v_fmac_f32 v137, v65, v5
v_fmac_f32 v138, v66, v5
v_fmac_f32 v139, v67, v5
v_fmac_f32 v140, v68, v6
v_fmac_f32 v141, v69, v6
v_fmac_f32 v142, v70, v6
v_fmac_f32 v143, v71, v6
s_waitcnt lgkmcnt(6)
v_fmac_f32 v120, v72, v7
v_fmac_f32 v121, v73, v7
v_fmac_f32 v122, v74, v7
v_fmac_f32 v123, v75, v7
v_fmac_f32 v124, v76, v8
v_fmac_f32 v125, v77, v8
v_fmac_f32 v126, v78, v8
v_fmac_f32 v127, v79, v8
v_fmac_f32 v128, v80, v9
v_fmac_f32 v129, v81, v9
v_fmac_f32 v130, v82, v9
v_fmac_f32 v131, v83, v9
v_fmac_f32 v132, v84, v7
v_fmac_f32 v133, v85, v7
v_fmac_f32 v134, v86, v7
v_fmac_f32 v135, v87, v7
v_fmac_f32 v136, v88, v8
v_fmac_f32 v137, v89, v8
v_fmac_f32 v138, v90, v8
v_fmac_f32 v139, v91, v8
v_fmac_f32 v140, v92, v9
v_fmac_f32 v141, v93, v9
v_fmac_f32 v142, v94, v9
v_fmac_f32 v143, v95, v9
s_waitcnt lgkmcnt(0)
v_fmac_f32 v120, v96, v10
v_fmac_f32 v121, v97, v10
v_fmac_f32 v122, v98, v10
v_fmac_f32 v123, v99, v10
v_fmac_f32 v124, v100, v11
v_fmac_f32 v125, v101, v11
v_fmac_f32 v126, v102, v11
v_fmac_f32 v127, v103, v11
v_fmac_f32 v128, v104, v12
v_fmac_f32 v129, v105, v12
v_fmac_f32 v130, v106, v12
v_fmac_f32 v131, v107, v12
v_fmac_f32 v132, v108, v10
v_fmac_f32 v133, v109, v10
v_fmac_f32 v134, v110, v10
v_fmac_f32 v135, v111, v10
v_fmac_f32 v136, v112, v11
v_fmac_f32 v137, v113, v11
v_fmac_f32 v138, v114, v11
v_fmac_f32 v139, v115, v11
v_fmac_f32 v140, v116, v12
v_fmac_f32 v141, v117, v12
v_fmac_f32 v142, v118, v12
v_fmac_f32 v143, v119, v12
v_cvt_pk_bf16_f32 v48, v120, v121
v_cvt_pk_bf16_f32 v49, v122, v123
v_cvt_pk_bf16_f32 v50, v124, v125
v_cvt_pk_bf16_f32 v51, v126, v127
v_cvt_pk_bf16_f32 v52, v128, v129
v_cvt_pk_bf16_f32 v53, v130, v131
v_cvt_pk_bf16_f32 v54, v132, v133
v_cvt_pk_bf16_f32 v55, v134, v135
v_cvt_pk_bf16_f32 v56, v136, v137
v_cvt_pk_bf16_f32 v57, v138, v139
v_cvt_pk_bf16_f32 v58, v140, v141
v_cvt_pk_bf16_f32 v59, v142, v143
ds_write_b64 v40, v[48:49] offset:0
ds_write_b64 v40, v[50:51] offset:1024
ds_write_b64 v40, v[52:53] offset:2048
ds_write_b64 v40, v[54:55] offset:8
ds_write_b64 v40, v[56:57] offset:1032
ds_write_b64 v40, v[58:59] offset:2056
s_add_u32 s85, s2, 2
s_and_b32 s85, s85, 3
s_lshl_b32 s85, s85, 15
s_add_u32 s85, s85, s93
s_add_u32 m0, s77, 0
s_add_u32 s94, s85, 0
buffer_load_dwordx4 v218, s[44:47], s94 offen offset:0 lds
s_add_u32 s94, s85, 3072
buffer_load_dwordx4 v219, s[44:47], s94 offen offset:1024 lds
s_add_u32 s94, s85, 6144
buffer_load_dwordx4 v218, s[44:47], s94 offen offset:2048 lds
s_add_u32 s94, s85, 9216
buffer_load_dwordx4 v219, s[44:47], s94 offen offset:3072 lds
s_add_u32 s79, s2, 0
s_and_b32 s79, s79, 3
s_lshl_b32 s79, s79, 13
s_add_u32 s79, s79, 131072
v_add_u32 v41, s79, v220
s_add_u32 s79, s2, 1
s_and_b32 s79, s79, 3
s_lshl_b32 s79, s79, 13
s_add_u32 s79, s79, 131072
v_add_u32 v42, s79, v220
s_add_u32 s79, s2, 2
s_and_b32 s79, s79, 3
s_lshl_b32 s79, s79, 13
s_add_u32 s79, s79, 131072
v_add_u32 v43, s79, v220
s_add_u32 s79, s2, 3
s_and_b32 s79, s79, 3
s_lshl_b32 s79, s79, 13
s_add_u32 s79, s79, 131072
v_add_u32 v44, s79, v220
s_waitcnt lgkmcnt(0)
s_barrier
ds_read_b128 a[48:51], v41 offset:0
ds_read_b128 a[64:67], v41 offset:1024
ds_read_b128 a[80:83], v41 offset:2048
ds_read_b128 a[52:55], v42 offset:0
ds_read_b128 a[68:71], v42 offset:1024
ds_read_b128 a[84:87], v42 offset:2048
ds_read_b128 a[56:59], v43 offset:0
ds_read_b128 a[72:75], v43 offset:1024
ds_read_b128 a[88:91], v43 offset:2048
ds_read_b128 a[60:63], v44 offset:0
ds_read_b128 a[76:79], v44 offset:1024
ds_read_b128 a[92:95], v44 offset:2048
s_add_u32 m0, s77, 4096
s_add_u32 s94, s85, 16384
buffer_load_dwordx4 v218, s[44:47], s94 offen offset:0 lds
s_add_u32 s94, s85, 19456
buffer_load_dwordx4 v219, s[44:47], s94 offen offset:1024 lds
s_add_u32 s94, s85, 22528
buffer_load_dwordx4 v218, s[44:47], s94 offen offset:2048 lds
s_add_u32 s94, s85, 25600
buffer_load_dwordx4 v219, s[44:47], s94 offen offset:3072 lds
s_waitcnt lgkmcnt(0)
ds_read_b64_tr_b16 a[128:129], v16 offset:16384
ds_read_b64_tr_b16 a[130:131], v16 offset:20480
ds_read_b64_tr_b16 a[132:133], v17 offset:16384
ds_read_b64_tr_b16 a[134:135], v17 offset:20480
ds_read_b64_tr_b16 a[136:137], v18 offset:16384
ds_read_b64_tr_b16 a[138:139], v18 offset:20480
ds_read_b64_tr_b16 a[140:141], v19 offset:16384
ds_read_b64_tr_b16 a[142:143], v19 offset:20480
ds_read_b64_tr_b16 a[144:145], v20 offset:16384
ds_read_b64_tr_b16 a[146:147], v20 offset:20480
ds_read_b64_tr_b16 a[148:149], v21 offset:16384
ds_read_b64_tr_b16 a[150:151], v21 offset:20480
ds_read_b64_tr_b16 a[152:153], v22 offset:16384
ds_read_b64_tr_b16 a[154:155], v22 offset:20480
ds_read_b64_tr_b16 a[156:157], v23 offset:16384
ds_read_b64_tr_b16 a[158:159], v23 offset:20480
s_waitcnt lgkmcnt(0)
v_mfma_f32_16x16x32_bf16 v[120:123], a[128:131], a[48:51], 0
v_mfma_f32_16x16x32_bf16 v[124:127], a[128:131], a[64:67], 0
v_mfma_f32_16x16x32_bf16 v[128:131], a[128:131], a[80:83], 0
s_add_u32 s85, s2, 3
s_and_b32 s85, s85, 3
s_lshl_b32 s85, s85, 15
s_add_u32 s85, s85, s93
s_add_u32 m0, s77, 8192
s_add_u32 s94, s85, 0
buffer_load_dwordx4 v218, s[44:47], s94 offen offset:0 lds
v_mfma_f32_16x16x32_bf16 v[132:135], a[132:135], a[48:51], 0
v_mfma_f32_16x16x32_bf16 v[136:139], a[132:135], a[64:67], 0
v_mfma_f32_16x16x32_bf16 v[140:143], a[132:135], a[80:83], 0
s_add_u32 s94, s85, 3072
buffer_load_dwordx4 v219, s[44:47], s94 offen offset:1024 lds
v_mfma_f32_16x16x32_bf16 v[144:147], a[136:139], a[48:51], 0
v_mfma_f32_16x16x32_bf16 v[148:151], a[136:139], a[64:67], 0
v_mfma_f32_16x16x32_bf16 v[152:155], a[136:139], a[80:83], 0
s_add_u32 s94, s85, 6144
buffer_load_dwordx4 v218, s[44:47], s94 offen offset:2048 lds
s_waitcnt vmcnt(23)
ds_read_b64_tr_b16 a[96:97], v16 offset:24576
ds_read_b64_tr_b16 a[98:99], v16 offset:28672
ds_read_b64_tr_b16 a[100:101], v17 offset:24576
ds_read_b64_tr_b16 a[102:103], v17 offset:28672
ds_read_b64_tr_b16 a[104:105], v18 offset:24576
ds_read_b64_tr_b16 a[106:107], v18 offset:28672
ds_read_b64_tr_b16 a[108:109], v19 offset:24576
ds_read_b64_tr_b16 a[110:111], v19 offset:28672
ds_read_b64_tr_b16 a[112:113], v20 offset:24576
ds_read_b64_tr_b16 a[114:115], v20 offset:28672
ds_read_b64_tr_b16 a[116:117], v21 offset:24576
ds_read_b64_tr_b16 a[118:119], v21 offset:28672
ds_read_b64_tr_b16 a[120:121], v22 offset:24576
ds_read_b64_tr_b16 a[122:123], v22 offset:28672
ds_read_b64_tr_b16 a[124:125], v23 offset:24576
ds_read_b64_tr_b16 a[126:127], v23 offset:28672
v_mfma_f32_16x16x32_bf16 v[156:159], a[140:143], a[48:51], 0
v_mfma_f32_16x16x32_bf16 v[160:163], a[140:143], a[64:67], 0
v_mfma_f32_16x16x32_bf16 v[164:167], a[140:143], a[80:83], 0
s_add_u32 s94, s85, 9216
buffer_load_dwordx4 v219, s[44:47], s94 offen offset:3072 lds
v_mfma_f32_16x16x32_bf16 v[168:171], a[144:147], a[48:51], 0
v_mfma_f32_16x16x32_bf16 v[172:175], a[144:147], a[64:67], 0
v_mfma_f32_16x16x32_bf16 v[176:179], a[144:147], a[80:83], 0
s_add_u32 m0, s77, 12288
s_add_u32 s94, s85, 16384
buffer_load_dwordx4 v218, s[44:47], s94 offen offset:0 lds
v_mfma_f32_16x16x32_bf16 v[180:183], a[148:151], a[48:51], 0
v_mfma_f32_16x16x32_bf16 v[184:187], a[148:151], a[64:67], 0
v_mfma_f32_16x16x32_bf16 v[188:191], a[148:151], a[80:83], 0
s_add_u32 s94, s85, 19456
buffer_load_dwordx4 v219, s[44:47], s94 offen offset:1024 lds
v_mfma_f32_16x16x32_bf16 v[192:195], a[152:155], a[48:51], 0
v_mfma_f32_16x16x32_bf16 v[196:199], a[152:155], a[64:67], 0
v_mfma_f32_16x16x32_bf16 v[200:203], a[152:155], a[80:83], 0
s_add_u32 s94, s85, 22528
buffer_load_dwordx4 v218, s[44:47], s94 offen offset:2048 lds
v_mfma_f32_16x16x32_bf16 v[204:207], a[156:159], a[48:51], 0
v_mfma_f32_16x16x32_bf16 v[208:211], a[156:159], a[64:67], 0
v_mfma_f32_16x16x32_bf16 v[212:215], a[156:159], a[80:83], 0
s_add_u32 s94, s85, 25600
buffer_load_dwordx4 v219, s[44:47], s94 offen offset:3072 lds
s_waitcnt lgkmcnt(0)
v_mfma_f32_16x16x32_bf16 v[120:123], a[96:99], a[52:55], v[120:123]
v_mfma_f32_16x16x32_bf16 v[124:127], a[96:99], a[68:71], v[124:127]
v_mfma_f32_16x16x32_bf16 v[128:131], a[96:99], a[84:87], v[128:131]
s_add_u32 s98, s96, s97
s_and_b32 s98, s98, 3
s_and_b32 s78, s96, -4
s_or_b32 s78, s78, s98
s_lshl_b32 s78, s78, 15
s_add_u32 s78, s78, s99
s_add_u32 s96, s96, 1
s_add_u32 m0, s77, 16384
s_add_u32 s94, s78, 0
buffer_load_dwordx4 v28, s[52:55], s94 offen offset:0 nt lds
v_mfma_f32_16x16x32_bf16 v[132:135], a[100:103], a[52:55], v[132:135]
v_mfma_f32_16x16x32_bf16 v[136:139], a[100:103], a[68:71], v[136:139]
v_mfma_f32_16x16x32_bf16 v[140:143], a[100:103], a[84:87], v[140:143]
buffer_load_dwordx4 v29, s[52:55], s94 offen offset:1024 nt lds
v_mfma_f32_16x16x32_bf16 v[144:147], a[104:107], a[52:55], v[144:147]
v_mfma_f32_16x16x32_bf16 v[148:151], a[104:107], a[68:71], v[148:151]
v_mfma_f32_16x16x32_bf16 v[152:155], a[104:107], a[84:87], v[152:155]
buffer_load_dwordx4 v28, s[52:55], s94 offen offset:2048 nt lds
s_waitcnt vmcnt(11)
ds_read_b64_tr_b16 a[128:129], v16 offset:0
ds_read_b64_tr_b16 a[130:131], v16 offset:4096
ds_read_b64_tr_b16 a[132:133], v17 offset:0
ds_read_b64_tr_b16 a[134:135], v17 offset:4096
ds_read_b64_tr_b16 a[136:137], v18 offset:0
ds_read_b64_tr_b16 a[138:139], v18 offset:4096
ds_read_b64_tr_b16 a[140:141], v19 offset:0
ds_read_b64_tr_b16 a[142:143], v19 offset:4096
ds_read_b64_tr_b16 a[144:145], v20 offset:0
ds_read_b64_tr_b16 a[146:147], v20 offset:4096
ds_read_b64_tr_b16 a[148:149], v21 offset:0
ds_read_b64_tr_b16 a[150:151], v21 offset:4096
ds_read_b64_tr_b16 a[152:153], v22 offset:0
ds_read_b64_tr_b16 a[154:155], v22 offset:4096
ds_read_b64_tr_b16 a[156:157], v23 offset:0
ds_read_b64_tr_b16 a[158:159], v23 offset:4096
v_mfma_f32_16x16x32_bf16 v[156:159], a[108:111], a[52:55], v[156:159]
v_mfma_f32_16x16x32_bf16 v[160:163], a[108:111], a[68:71], v[160:163]
v_mfma_f32_16x16x32_bf16 v[164:167], a[108:111], a[84:87], v[164:167]
buffer_load_dwordx4 v29, s[52:55], s94 offen offset:3072 nt lds
v_mfma_f32_16x16x32_bf16 v[168:171], a[112:115], a[52:55], v[168:171]
v_mfma_f32_16x16x32_bf16 v[172:175], a[112:115], a[68:71], v[172:175]
v_mfma_f32_16x16x32_bf16 v[176:179], a[112:115], a[84:87], v[176:179]
s_add_u32 m0, s77, 20480
s_add_u32 s94, s78, 4096
buffer_load_dwordx4 v28, s[52:55], s94 offen offset:0 nt lds
v_mfma_f32_16x16x32_bf16 v[180:183], a[116:119], a[52:55], v[180:183]
v_mfma_f32_16x16x32_bf16 v[184:187], a[116:119], a[68:71], v[184:187]
v_mfma_f32_16x16x32_bf16 v[188:191], a[116:119], a[84:87], v[188:191]
buffer_load_dwordx4 v29, s[52:55], s94 offen offset:1024 nt lds
v_mfma_f32_16x16x32_bf16 v[192:195], a[120:123], a[52:55], v[192:195]
v_mfma_f32_16x16x32_bf16 v[196:199], a[120:123], a[68:71], v[196:199]
v_mfma_f32_16x16x32_bf16 v[200:203], a[120:123], a[84:87], v[200:203]
buffer_load_dwordx4 v28, s[52:55], s94 offen offset:2048 nt lds
v_mfma_f32_16x16x32_bf16 v[204:207], a[124:127], a[52:55], v[204:207]
v_mfma_f32_16x16x32_bf16 v[208:211], a[124:127], a[68:71], v[208:211]
v_mfma_f32_16x16x32_bf16 v[212:215], a[124:127], a[84:87], v[212:215]
buffer_load_dwordx4 v29, s[52:55], s94 offen offset:3072 nt lds
s_waitcnt lgkmcnt(0)
v_mfma_f32_16x16x32_bf16 v[120:123], a[128:131], a[56:59], v[120:123]
v_mfma_f32_16x16x32_bf16 v[124:127], a[128:131], a[72:75], v[124:127]
v_mfma_f32_16x16x32_bf16 v[128:131], a[128:131], a[88:91], v[128:131]
s_add_u32 s98, s84, s97
s_and_b32 s98, s98, 3
s_and_b32 s83, s84, -4
s_or_b32 s83, s83, s98
s_lshl_b32 s83, s83, 15
s_add_u32 s83, s83, s99
s_add_u32 s84, s84, 1
s_add_u32 m0, s77, 24576
s_add_u32 s94, s83, 0
buffer_load_dwordx4 v28, s[56:59], s94 offen offset:0 nt lds
v_mfma_f32_16x16x32_bf16 v[132:135], a[132:135], a[56:59], v[132:135]
v_mfma_f32_16x16x32_bf16 v[136:139], a[132:135], a[72:75], v[136:139]
v_mfma_f32_16x16x32_bf16 v[140:143], a[132:135], a[88:91], v[140:143]
buffer_load_dwordx4 v29, s[56:59], s94 offen offset:1024 nt lds
v_mfma_f32_16x16x32_bf16 v[144:147], a[136:139], a[56:59], v[144:147]
v_mfma_f32_16x16x32_bf16 v[148:151], a[136:139], a[72:75], v[148:151]
v_mfma_f32_16x16x32_bf16 v[152:155], a[136:139], a[88:91], v[152:155]
buffer_load_dwordx4 v28, s[56:59], s94 offen offset:2048 nt lds
s_waitcnt vmcnt(11)
ds_read_b64_tr_b16 a[96:97], v16 offset:8192
ds_read_b64_tr_b16 a[98:99], v16 offset:12288
ds_read_b64_tr_b16 a[100:101], v17 offset:8192
ds_read_b64_tr_b16 a[102:103], v17 offset:12288
ds_read_b64_tr_b16 a[104:105], v18 offset:8192
ds_read_b64_tr_b16 a[106:107], v18 offset:12288
ds_read_b64_tr_b16 a[108:109], v19 offset:8192
ds_read_b64_tr_b16 a[110:111], v19 offset:12288
ds_read_b64_tr_b16 a[112:113], v20 offset:8192
ds_read_b64_tr_b16 a[114:115], v20 offset:12288
ds_read_b64_tr_b16 a[116:117], v21 offset:8192
ds_read_b64_tr_b16 a[118:119], v21 offset:12288
ds_read_b64_tr_b16 a[120:121], v22 offset:8192
ds_read_b64_tr_b16 a[122:123], v22 offset:12288
ds_read_b64_tr_b16 a[124:125], v23 offset:8192
ds_read_b64_tr_b16 a[126:127], v23 offset:12288
v_mfma_f32_16x16x32_bf16 v[156:159], a[140:143], a[56:59], v[156:159]
v_mfma_f32_16x16x32_bf16 v[160:163], a[140:143], a[72:75], v[160:163]
v_mfma_f32_16x16x32_bf16 v[164:167], a[140:143], a[88:91], v[164:167]
buffer_load_dwordx4 v29, s[56:59], s94 offen offset:3072 nt lds
v_mfma_f32_16x16x32_bf16 v[168:171], a[144:147], a[56:59], v[168:171]
v_mfma_f32_16x16x32_bf16 v[172:175], a[144:147], a[72:75], v[172:175]
v_mfma_f32_16x16x32_bf16 v[176:179], a[144:147], a[88:91], v[176:179]
s_add_u32 m0, s77, 28672
s_add_u32 s94, s83, 4096
buffer_load_dwordx4 v28, s[56:59], s94 offen offset:0 nt lds
v_mfma_f32_16x16x32_bf16 v[180:183], a[148:151], a[56:59], v[180:183]
v_mfma_f32_16x16x32_bf16 v[184:187], a[148:151], a[72:75], v[184:187]
v_mfma_f32_16x16x32_bf16 v[188:191], a[148:151], a[88:91], v[188:191]
buffer_load_dwordx4 v29, s[56:59], s94 offen offset:1024 nt lds
v_mfma_f32_16x16x32_bf16 v[192:195], a[152:155], a[56:59], v[192:195]
v_mfma_f32_16x16x32_bf16 v[196:199], a[152:155], a[72:75], v[196:199]
v_mfma_f32_16x16x32_bf16 v[200:203], a[152:155], a[88:91], v[200:203]
buffer_load_dwordx4 v28, s[56:59], s94 offen offset:2048 nt lds
v_mfma_f32_16x16x32_bf16 v[204:207], a[156:159], a[56:59], v[204:207]
v_mfma_f32_16x16x32_bf16 v[208:211], a[156:159], a[72:75], v[208:211]
v_mfma_f32_16x16x32_bf16 v[212:215], a[156:159], a[88:91], v[212:215]
buffer_load_dwordx4 v29, s[56:59], s94 offen offset:3072 nt lds
s_waitcnt lgkmcnt(0)
v_mfma_f32_16x16x32_bf16 v[120:123], a[96:99], a[60:63], v[120:123]
v_mfma_f32_16x16x32_bf16 v[124:127], a[96:99], a[76:79], v[124:127]
v_mfma_f32_16x16x32_bf16 v[128:131], a[96:99], a[92:95], v[128:131]
s_add_u32 s98, s96, s97
s_and_b32 s98, s98, 3
s_and_b32 s78, s96, -4
s_or_b32 s78, s78, s98
s_lshl_b32 s78, s78, 15
s_add_u32 s78, s78, s99
s_add_u32 s96, s96, 1
s_add_u32 m0, s77, 0
s_add_u32 s94, s78, 0
buffer_load_dwordx4 v28, s[52:55], s94 offen offset:0 nt lds
v_mfma_f32_16x16x32_bf16 v[132:135], a[100:103], a[60:63], v[132:135]
v_mfma_f32_16x16x32_bf16 v[136:139], a[100:103], a[76:79], v[136:139]
v_mfma_f32_16x16x32_bf16 v[140:143], a[100:103], a[92:95], v[140:143]
buffer_load_dwordx4 v29, s[52:55], s94 offen offset:1024 nt lds
v_mfma_f32_16x16x32_bf16 v[144:147], a[104:107], a[60:63], v[144:147]
v_mfma_f32_16x16x32_bf16 v[148:151], a[104:107], a[76:79], v[148:151]
v_mfma_f32_16x16x32_bf16 v[152:155], a[104:107], a[92:95], v[152:155]
buffer_load_dwordx4 v28, s[52:55], s94 offen offset:2048 nt lds
v_mfma_f32_16x16x32_bf16 v[156:159], a[108:111], a[60:63], v[156:159]
v_mfma_f32_16x16x32_bf16 v[160:163], a[108:111], a[76:79], v[160:163]
v_mfma_f32_16x16x32_bf16 v[164:167], a[108:111], a[92:95], v[164:167]
buffer_load_dwordx4 v29, s[52:55], s94 offen offset:3072 nt lds
v_mfma_f32_16x16x32_bf16 v[168:171], a[112:115], a[60:63], v[168:171]
v_mfma_f32_16x16x32_bf16 v[172:175], a[112:115], a[76:79], v[172:175]
v_mfma_f32_16x16x32_bf16 v[176:179], a[112:115], a[92:95], v[176:179]
s_add_u32 m0, s77, 4096
s_add_u32 s94, s78, 4096
buffer_load_dwordx4 v28, s[52:55], s94 offen offset:0 nt lds
v_mfma_f32_16x16x32_bf16 v[180:183], a[116:119], a[60:63], v[180:183]
v_mfma_f32_16x16x32_bf16 v[184:187], a[116:119], a[76:79], v[184:187]
v_mfma_f32_16x16x32_bf16 v[188:191], a[116:119], a[92:95], v[188:191]
buffer_load_dwordx4 v29, s[52:55], s94 offen offset:1024 nt lds
v_mfma_f32_16x16x32_bf16 v[192:195], a[120:123], a[60:63], v[192:195]
v_mfma_f32_16x16x32_bf16 v[196:199], a[120:123], a[76:79], v[196:199]
v_mfma_f32_16x16x32_bf16 v[200:203], a[120:123], a[92:95], v[200:203]
buffer_load_dwordx4 v28, s[52:55], s94 offen offset:2048 nt lds
v_mfma_f32_16x16x32_bf16 v[204:207], a[124:127], a[60:63], v[204:207]
v_mfma_f32_16x16x32_bf16 v[208:211], a[124:127], a[76:79], v[208:211]
v_mfma_f32_16x16x32_bf16 v[212:215], a[124:127], a[92:95], v[212:215]
buffer_load_dwordx4 v29, s[52:55], s94 offen offset:3072 nt lds
s_nop 7
v_accvgpr_write_b32 a160, v120
v_accvgpr_write_b32 a161, v121
v_accvgpr_write_b32 a162, v122
v_accvgpr_write_b32 a163, v123
v_accvgpr_write_b32 a164, v124
v_accvgpr_write_b32 a165, v125
v_accvgpr_write_b32 a166, v126
v_accvgpr_write_b32 a167, v127
v_accvgpr_write_b32 a168, v128
v_accvgpr_write_b32 a169, v129
v_accvgpr_write_b32 a170, v130
v_accvgpr_write_b32 a171, v131
v_accvgpr_write_b32 a172, v132
v_accvgpr_write_b32 a173, v133
v_accvgpr_write_b32 a174, v134
v_accvgpr_write_b32 a175, v135
v_accvgpr_write_b32 a176, v136
v_accvgpr_write_b32 a177, v137
v_accvgpr_write_b32 a178, v138
v_accvgpr_write_b32 a179, v139
v_accvgpr_write_b32 a180, v140
v_accvgpr_write_b32 a181, v141
v_accvgpr_write_b32 a182, v142
v_accvgpr_write_b32 a183, v143
v_accvgpr_write_b32 a184, v144
v_accvgpr_write_b32 a185, v145
v_accvgpr_write_b32 a186, v146
v_accvgpr_write_b32 a187, v147
v_accvgpr_write_b32 a188, v148
v_accvgpr_write_b32 a189, v149
v_accvgpr_write_b32 a190, v150
v_accvgpr_write_b32 a191, v151
v_accvgpr_write_b32 a192, v152
v_accvgpr_write_b32 a193, v153
v_accvgpr_write_b32 a194, v154
v_accvgpr_write_b32 a195, v155
v_accvgpr_write_b32 a196, v156
v_accvgpr_write_b32 a197, v157
v_accvgpr_write_b32 a198, v158
v_accvgpr_write_b32 a199, v159
v_accvgpr_write_b32 a200, v160
v_accvgpr_write_b32 a201, v161
v_accvgpr_write_b32 a202, v162
v_accvgpr_write_b32 a203, v163
v_accvgpr_write_b32 a204, v164
v_accvgpr_write_b32 a205, v165
v_accvgpr_write_b32 a206, v166
v_accvgpr_write_b32 a207, v167
v_accvgpr_write_b32 a208, v168
v_accvgpr_write_b32 a209, v169
v_accvgpr_write_b32 a210, v170
v_accvgpr_write_b32 a211, v171
v_accvgpr_write_b32 a212, v172
v_accvgpr_write_b32 a213, v173
v_accvgpr_write_b32 a214, v174
v_accvgpr_write_b32 a215, v175
v_accvgpr_write_b32 a216, v176
v_accvgpr_write_b32 a217, v177
v_accvgpr_write_b32 a218, v178
v_accvgpr_write_b32 a219, v179
v_accvgpr_write_b32 a220, v180
v_accvgpr_write_b32 a221, v181
v_accvgpr_write_b32 a222, v182
v_accvgpr_write_b32 a223, v183
v_accvgpr_write_b32 a224, v184
v_accvgpr_write_b32 a225, v185
v_accvgpr_write_b32 a226, v186
v_accvgpr_write_b32 a227, v187
v_accvgpr_write_b32 a228, v188
v_accvgpr_write_b32 a229, v189
v_accvgpr_write_b32 a230, v190
v_accvgpr_write_b32 a231, v191
v_accvgpr_write_b32 a232, v192
v_accvgpr_write_b32 a233, v193
v_accvgpr_write_b32 a234, v194
v_accvgpr_write_b32 a235, v195
v_accvgpr_write_b32 a236, v196
v_accvgpr_write_b32 a237, v197
v_accvgpr_write_b32 a238, v198
v_accvgpr_write_b32 a239, v199
v_accvgpr_write_b32 a240, v200
v_accvgpr_write_b32 a241, v201
v_accvgpr_write_b32 a242, v202
v_accvgpr_write_b32 a243, v203
v_accvgpr_write_b32 a244, v204
v_accvgpr_write_b32 a245, v205
v_accvgpr_write_b32 a246, v206
v_accvgpr_write_b32 a247, v207
v_accvgpr_write_b32 a248, v208
v_accvgpr_write_b32 a249, v209
v_accvgpr_write_b32 a250, v210
v_accvgpr_write_b32 a251, v211
v_accvgpr_write_b32 a252, v212
v_accvgpr_write_b32 a253, v213
v_accvgpr_write_b32 a254, v214
v_accvgpr_write_b32 a255, v215
s_waitcnt vmcnt(16)
ds_read_b128 a[96:99], v24 offset:16384
ds_read_b128 a[100:103], v24 offset:20480
ds_read_b128 a[104:107], v25 offset:16384
ds_read_b128 a[108:111], v25 offset:20480
ds_read_b128 a[112:115], v26 offset:16384
ds_read_b128 a[116:119], v26 offset:20480
ds_read_b128 a[120:123], v27 offset:16384
ds_read_b128 a[124:127], v27 offset:20480
v_mov_b32 v120, 0
v_mov_b32 v121, 0
v_mov_b32 v122, 0
v_mov_b32 v123, 0
v_mov_b32 v124, 0
v_mov_b32 v125, 0
v_mov_b32 v126, 0
v_mov_b32 v127, 0
v_mov_b32 v128, 0
v_mov_b32 v129, 0
v_mov_b32 v130, 0
v_mov_b32 v131, 0
v_mov_b32 v132, 0
v_mov_b32 v133, 0
v_mov_b32 v134, 0
v_mov_b32 v135, 0
v_mov_b32 v136, 0
v_mov_b32 v137, 0
v_mov_b32 v138, 0
v_mov_b32 v139, 0
v_mov_b32 v140, 0
v_mov_b32 v141, 0
v_mov_b32 v142, 0
v_mov_b32 v143, 0
v_mov_b32 v144, 0
v_mov_b32 v145, 0
v_mov_b32 v146, 0
v_mov_b32 v147, 0
v_mov_b32 v148, 0
v_mov_b32 v149, 0
v_mov_b32 v150, 0
v_mov_b32 v151, 0
v_mov_b32 v152, 0
v_mov_b32 v153, 0
v_mov_b32 v154, 0
v_mov_b32 v155, 0
v_mov_b32 v156, 0
v_mov_b32 v157, 0
v_mov_b32 v158, 0
v_mov_b32 v159, 0
v_mov_b32 v160, 0
v_mov_b32 v161, 0
v_mov_b32 v162, 0
v_mov_b32 v163, 0
v_mov_b32 v164, 0
v_mov_b32 v165, 0
v_mov_b32 v166, 0
v_mov_b32 v167, 0
v_mov_b32 v168, 0
v_mov_b32 v169, 0
v_mov_b32 v170, 0
v_mov_b32 v171, 0
v_mov_b32 v172, 0
v_mov_b32 v173, 0
v_mov_b32 v174, 0
v_mov_b32 v175, 0
v_mov_b32 v176, 0
v_mov_b32 v177, 0
v_mov_b32 v178, 0
v_mov_b32 v179, 0
v_mov_b32 v180, 0
v_mov_b32 v181, 0
v_mov_b32 v182, 0
v_mov_b32 v183, 0
v_mov_b32 v184, 0
v_mov_b32 v185, 0
v_mov_b32 v186, 0
v_mov_b32 v187, 0
v_mov_b32 v188, 0
v_mov_b32 v189, 0
v_mov_b32 v190, 0
v_mov_b32 v191, 0
v_mov_b32 v192, 0
v_mov_b32 v193, 0
v_mov_b32 v194, 0
v_mov_b32 v195, 0
v_mov_b32 v196, 0
v_mov_b32 v197, 0
v_mov_b32 v198, 0
v_mov_b32 v199, 0
v_mov_b32 v200, 0
v_mov_b32 v201, 0
v_mov_b32 v202, 0
v_mov_b32 v203, 0
v_mov_b32 v204, 0
v_mov_b32 v205, 0
v_mov_b32 v206, 0
v_mov_b32 v207, 0
v_mov_b32 v208, 0
v_mov_b32 v209, 0
v_mov_b32 v210, 0
v_mov_b32 v211, 0
v_mov_b32 v212, 0
v_mov_b32 v213, 0
v_mov_b32 v214, 0
v_mov_b32 v215, 0
v_mov_b32 v30, 0
v_mov_b32 v31, 0
v_mov_b32 v32, 0
v_mov_b32 v33, 0
v_mov_b32 v34, 0
v_mov_b32 v35, 0
s_mov_b32 s87, 0xff800000
s_mov_b32 s88, 0xff800000
s_waitcnt lgkmcnt(0)
v_mfma_f32_16x16x32_bf16 v[48:51], a[96:99], a[0:3], 0
v_mfma_f32_16x16x32_bf16 v[52:55], a[96:99], a[16:19], 0
v_mfma_f32_16x16x32_bf16 v[56:59], a[96:99], a[32:35], 0
s_add_u32 s98, s96, s97
s_and_b32 s98, s98, 3
s_and_b32 s78, s96, -4
s_or_b32 s78, s78, s98
s_lshl_b32 s78, s78, 15
s_add_u32 s78, s78, s99
s_add_u32 s96, s96, 1
s_add_u32 m0, s77, 16384
s_add_u32 s94, s78, 0
buffer_load_dwordx4 v28, s[52:55], s94 offen offset:0 nt lds
v_mfma_f32_16x16x32_bf16 v[60:63], a[100:103], a[0:3], 0
v_mfma_f32_16x16x32_bf16 v[64:67], a[100:103], a[16:19], 0
v_mfma_f32_16x16x32_bf16 v[68:71], a[100:103], a[32:35], 0
buffer_load_dwordx4 v29, s[52:55], s94 offen offset:1024 nt lds
v_mfma_f32_16x16x32_bf16 v[48:51], a[104:107], a[4:7], v[48:51]
v_mfma_f32_16x16x32_bf16 v[52:55], a[104:107], a[20:23], v[52:55]
v_mfma_f32_16x16x32_bf16 v[56:59], a[104:107], a[36:39], v[56:59]
buffer_load_dwordx4 v28, s[52:55], s94 offen offset:2048 nt lds
v_mfma_f32_16x16x32_bf16 v[60:63], a[108:111], a[4:7], v[60:63]
v_mfma_f32_16x16x32_bf16 v[64:67], a[108:111], a[20:23], v[64:67]
v_mfma_f32_16x16x32_bf16 v[68:71], a[108:111], a[36:39], v[68:71]
buffer_load_dwordx4 v29, s[52:55], s94 offen offset:3072 nt lds
v_mfma_f32_16x16x32_bf16 v[48:51], a[112:115], a[8:11], v[48:51]
v_mfma_f32_16x16x32_bf16 v[52:55], a[112:115], a[24:27], v[52:55]
v_mfma_f32_16x16x32_bf16 v[56:59], a[112:115], a[40:43], v[56:59]
s_add_u32 m0, s77, 20480
s_add_u32 s94, s78, 4096
buffer_load_dwordx4 v28, s[52:55], s94 offen offset:0 nt lds
v_mfma_f32_16x16x32_bf16 v[60:63], a[116:119], a[8:11], v[60:63]
v_mfma_f32_16x16x32_bf16 v[64:67], a[116:119], a[24:27], v[64:67]
v_mfma_f32_16x16x32_bf16 v[68:71], a[116:119], a[40:43], v[68:71]
buffer_load_dwordx4 v29, s[52:55], s94 offen offset:1024 nt lds
v_mfma_f32_16x16x32_bf16 v[48:51], a[120:123], a[12:15], v[48:51]
v_mfma_f32_16x16x32_bf16 v[52:55], a[120:123], a[28:31], v[52:55]
v_mfma_f32_16x16x32_bf16 v[56:59], a[120:123], a[44:47], v[56:59]
buffer_load_dwordx4 v28, s[52:55], s94 offen offset:2048 nt lds
v_mfma_f32_16x16x32_bf16 v[60:63], a[124:127], a[12:15], v[60:63]
v_mfma_f32_16x16x32_bf16 v[64:67], a[124:127], a[28:31], v[64:67]
v_mfma_f32_16x16x32_bf16 v[68:71], a[124:127], a[44:47], v[68:71]
buffer_load_dwordx4 v29, s[52:55], s94 offen offset:3072 nt lds
s_waitcnt vmcnt(8)
ds_read_b128 a[96:99], v24 offset:0
ds_read_b128 a[100:103], v24 offset:4096
ds_read_b128 a[104:107], v25 offset:0
ds_read_b128 a[108:111], v25 offset:4096
ds_read_b128 a[112:115], v26 offset:0
ds_read_b128 a[116:119], v26 offset:4096
ds_read_b128 a[120:123], v27 offset:0
ds_read_b128 a[124:127], v27 offset:4096
s_add_u32 s98, s84, s97
s_and_b32 s98, s98, 3
s_and_b32 s83, s84, -4
s_or_b32 s83, s83, s98
s_lshl_b32 s83, s83, 15
s_add_u32 s83, s83, s99
s_add_u32 s84, s84, 1
s_add_u32 m0, s77, 8192
s_add_u32 s94, s83, 0
buffer_load_dwordx4 v28, s[56:59], s94 offen offset:0 nt lds
buffer_load_dwordx4 v29, s[56:59], s94 offen offset:1024 nt lds
buffer_load_dwordx4 v28, s[56:59], s94 offen offset:2048 nt lds
buffer_load_dwordx4 v29, s[56:59], s94 offen offset:3072 nt lds
s_add_u32 m0, s77, 12288
s_add_u32 s94, s83, 4096
buffer_load_dwordx4 v28, s[56:59], s94 offen offset:0 nt lds
buffer_load_dwordx4 v29, s[56:59], s94 offen offset:1024 nt lds
buffer_load_dwordx4 v28, s[56:59], s94 offen offset:2048 nt lds
buffer_load_dwordx4 v29, s[56:59], s94 offen offset:3072 nt lds
s_nop 3
v_fma_f32 v48, v48, s89, -v30
v_fma_f32 v49, v49, s89, -v30
v_fma_f32 v50, v50, s89, -v30
v_fma_f32 v51, v51, s89, -v30
v_fma_f32 v52, v52, s89, -v32
v_fma_f32 v53, v53, s89, -v32
v_fma_f32 v54, v54, s89, -v32
v_fma_f32 v55, v55, s89, -v32
v_fma_f32 v56, v56, s89, -v34
v_fma_f32 v57, v57, s89, -v34
v_fma_f32 v58, v58, s89, -v34
v_fma_f32 v59, v59, s89, -v34
v_fma_f32 v60, v60, s89, -v30
v_fma_f32 v61, v61, s89, -v30
v_fma_f32 v62, v62, s89, -v30
v_fma_f32 v63, v63, s89, -v30
v_fma_f32 v64, v64, s89, -v32
v_fma_f32 v65, v65, s89, -v32
v_fma_f32 v66, v66, s89, -v32
v_fma_f32 v67, v67, s89, -v32
v_fma_f32 v68, v68, s89, -v34
v_fma_f32 v69, v69, s89, -v34
v_fma_f32 v70, v70, s89, -v34
v_fma_f32 v71, v71, s89, -v34
v_max3_f32 v36, v48, v49, v50
v_max3_f32 v37, v52, v53, v54
v_max3_f32 v38, v56, v57, v58
v_max3_f32 v36, v36, v51, v60
v_max3_f32 v37, v37, v55, v64
v_max3_f32 v38, v38, v59, v68
v_max3_f32 v36, v36, v61, v62
v_max3_f32 v37, v37, v65, v66
v_max3_f32 v38, v38, v69, v70
v_max_f32 v36, v36, v63
v_max_f32 v37, v37, v67
v_max_f32 v38, v38, v71
v_max3_f32 v39, v36, v37, v38
v_cmp_lt_f32 vcc, s87, v39
s_cbranch_vccz L_fast18
s_call_b64 s[90:91], L_rescale0
L_fast18:
s_mov_b32 s86, 6
L_loopB2:
s_waitcnt lgkmcnt(0)
v_mfma_f32_16x16x32_bf16 v[72:75], a[96:99], a[0:3], 0
v_exp_f32 v48, v48
v_mfma_f32_16x16x32_bf16 v[76:79], a[96:99], a[16:19], 0
v_exp_f32 v49, v49
v_exp_f32 v50, v50
s_add_u32 s98, s96, s97
s_and_b32 s98, s98, 3
s_and_b32 s78, s96, -4
s_or_b32 s78, s78, s98
s_lshl_b32 s78, s78, 15
s_add_u32 s78, s78, s99
s_add_u32 s96, s96, 1
s_add_u32 m0, s77, 0
s_add_u32 s94, s78, 0
buffer_load_dwordx4 v28, s[52:55], s94 offen offset:0 nt lds
v_mfma_f32_16x16x32_bf16 v[80:83], a[96:99], a[32:35], 0
v_exp_f32 v51, v51
v_mfma_f32_16x16x32_bf16 v[84:87], a[100:103], a[0:3], 0
v_exp_f32 v60, v60
v_mfma_f32_16x16x32_bf16 v[88:91], a[100:103], a[16:19], 0
v_exp_f32 v61, v61
buffer_load_dwordx4 v29, s[52:55], s94 offen offset:1024 nt lds
v_mfma_f32_16x16x32_bf16 v[92:95], a[100:103], a[32:35], 0
v_exp_f32 v62, v62
v_exp_f32 v63, v63
v_mfma_f32_16x16x32_bf16 v[72:75], a[104:107], a[4:7], v[72:75]
v_exp_f32 v52, v52
v_mfma_f32_16x16x32_bf16 v[76:79], a[104:107], a[20:23], v[76:79]
v_exp_f32 v53, v53
buffer_load_dwordx4 v28, s[52:55], s94 offen offset:2048 nt lds
v_mfma_f32_16x16x32_bf16 v[80:83], a[104:107], a[36:39], v[80:83]
v_exp_f32 v54, v54
v_mfma_f32_16x16x32_bf16 v[84:87], a[108:111], a[4:7], v[84:87]
v_exp_f32 v55, v55
v_exp_f32 v64, v64
v_mfma_f32_16x16x32_bf16 v[88:91], a[108:111], a[20:23], v[88:91]
v_exp_f32 v65, v65
s_waitcnt vmcnt(19)
ds_read_b64_tr_b16 a[128:129], v16 offset:24576
ds_read_b64_tr_b16 a[130:131], v16 offset:28672
ds_read_b64_tr_b16 a[132:133], v17 offset:24576
ds_read_b64_tr_b16 a[134:135], v17 offset:28672
ds_read_b64_tr_b16 a[136:137], v18 offset:24576
ds_read_b64_tr_b16 a[138:139], v18 offset:28672
ds_read_b64_tr_b16 a[140:141], v19 offset:24576
ds_read_b64_tr_b16 a[142:143], v19 offset:28672
ds_read_b64_tr_b16 a[144:145], v20 offset:24576
ds_read_b64_tr_b16 a[146:147], v20 offset:28672
ds_read_b64_tr_b16 a[148:149], v21 offset:24576
ds_read_b64_tr_b16 a[150:151], v21 offset:28672
ds_read_b64_tr_b16 a[152:153], v22 offset:24576
ds_read_b64_tr_b16 a[154:155], v22 offset:28672
ds_read_b64_tr_b16 a[156:157], v23 offset:24576
ds_read_b64_tr_b16 a[158:159], v23 offset:28672
v_mfma_f32_16x16x32_bf16 v[92:95], a[108:111], a[36:39], v[92:95]
v_exp_f32 v66, v66
v_mfma_f32_16x16x32_bf16 v[72:75], a[112:115], a[8:11], v[72:75]
v_exp_f32 v67, v67
v_cvt_pk_bf16_f32 v96, v48, v49
v_mfma_f32_16x16x32_bf16 v[76:79], a[112:115], a[24:27], v[76:79]
v_cvt_pk_bf16_f32 v97, v50, v51
v_cvt_pk_bf16_f32 v98, v60, v61
buffer_load_dwordx4 v29, s[52:55], s94 offen offset:3072 nt lds
v_mfma_f32_16x16x32_bf16 v[80:83], a[112:115], a[40:43], v[80:83]
v_cvt_pk_bf16_f32 v99, v62, v63
v_exp_f32 v56, v56
v_mfma_f32_16x16x32_bf16 v[84:87], a[116:119], a[8:11], v[84:87]
v_exp_f32 v57, v57
v_mfma_f32_16x16x32_bf16 v[88:91], a[116:119], a[24:27], v[88:91]
v_exp_f32 v58, v58
s_add_u32 m0, s77, 4096
s_add_u32 s94, s78, 4096
buffer_load_dwordx4 v28, s[52:55], s94 offen offset:0 nt lds
v_mfma_f32_16x16x32_bf16 v[92:95], a[116:119], a[40:43], v[92:95]
v_exp_f32 v59, v59
v_exp_f32 v68, v68
v_mfma_f32_16x16x32_bf16 v[72:75], a[120:123], a[12:15], v[72:75]
v_exp_f32 v69, v69
v_mfma_f32_16x16x32_bf16 v[76:79], a[120:123], a[28:31], v[76:79]
v_exp_f32 v70, v70
buffer_load_dwordx4 v29, s[52:55], s94 offen offset:1024 nt lds
v_mfma_f32_16x16x32_bf16 v[80:83], a[120:123], a[44:47], v[80:83]
v_exp_f32 v71, v71
v_cvt_pk_bf16_f32 v100, v52, v53
v_mfma_f32_16x16x32_bf16 v[84:87], a[124:127], a[12:15], v[84:87]
v_cvt_pk_bf16_f32 v101, v54, v55
v_cvt_pk_bf16_f32 v102, v64, v65
buffer_load_dwordx4 v28, s[52:55], s94 offen offset:2048 nt lds
v_mfma_f32_16x16x32_bf16 v[88:91], a[124:127], a[28:31], v[88:91]
v_cvt_pk_bf16_f32 v103, v66, v67
v_cvt_pk_bf16_f32 v104, v56, v57
v_cvt_pk_bf16_f32 v105, v58, v59
v_mfma_f32_16x16x32_bf16 v[92:95], a[124:127], a[44:47], v[92:95]
v_cvt_pk_bf16_f32 v106, v68, v69
v_cvt_pk_bf16_f32 v107, v70, v71
buffer_load_dwordx4 v29, s[52:55], s94 offen offset:3072 nt lds
s_waitcnt lgkmcnt(0)
v_mfma_f32_16x16x32_bf16 v[120:123], a[128:131], v[96:99], v[120:123]
v_add_f32 v31, v31, v48
v_add_f32 v33, v33, v52
v_add_f32 v35, v35, v56
v_mfma_f32_16x16x32_bf16 v[124:127], a[128:131], v[100:103], v[124:127]
v_add_f32 v31, v31, v49
v_add_f32 v33, v33, v53
s_add_u32 s98, s84, s97
s_and_b32 s98, s98, 3
s_and_b32 s83, s84, -4
s_or_b32 s83, s83, s98
s_lshl_b32 s83, s83, 15
s_add_u32 s83, s83, s99
s_add_u32 s84, s84, 1
s_add_u32 m0, s77, 24576
s_add_u32 s94, s83, 0
buffer_load_dwordx4 v28, s[56:59], s94 offen offset:0 nt lds
v_mfma_f32_16x16x32_bf16 v[128:131], a[128:131], v[104:107], v[128:131]
v_add_f32 v35, v35, v57
v_add_f32 v31, v31, v50
v_add_f32 v33, v33, v54
v_mfma_f32_16x16x32_bf16 v[132:135], a[132:135], v[96:99], v[132:135]
v_add_f32 v35, v35, v58
v_add_f32 v31, v31, v51
v_mfma_f32_16x16x32_bf16 v[136:139], a[132:135], v[100:103], v[136:139]
v_add_f32 v33, v33, v55
v_add_f32 v35, v35, v59
v_add_f32 v31, v31, v60
buffer_load_dwordx4 v29, s[56:59], s94 offen offset:1024 nt lds
v_mfma_f32_16x16x32_bf16 v[140:143], a[132:135], v[104:107], v[140:143]
v_add_f32 v33, v33, v64
v_add_f32 v35, v35, v68
v_mfma_f32_16x16x32_bf16 v[144:147], a[136:139], v[96:99], v[144:147]
v_add_f32 v31, v31, v61
v_add_f32 v33, v33, v65
v_add_f32 v35, v35, v69
v_mfma_f32_16x16x32_bf16 v[148:151], a[136:139], v[100:103], v[148:151]
v_add_f32 v31, v31, v62
v_add_f32 v33, v33, v66
buffer_load_dwordx4 v28, s[56:59], s94 offen offset:2048 nt lds
v_mfma_f32_16x16x32_bf16 v[152:155], a[136:139], v[104:107], v[152:155]
v_add_f32 v35, v35, v70
v_add_f32 v31, v31, v63
v_add_f32 v33, v33, v67
v_mfma_f32_16x16x32_bf16 v[156:159], a[140:143], v[96:99], v[156:159]
v_add_f32 v35, v35, v71
v_fma_f32 v72, v72, s89, -v30
v_mfma_f32_16x16x32_bf16 v[160:163], a[140:143], v[100:103], v[160:163]
v_fma_f32 v73, v73, s89, -v30
v_fma_f32 v74, v74, s89, -v30
v_fma_f32 v75, v75, s89, -v30
s_waitcnt vmcnt(19)
ds_read_b128 a[96:99], v24 offset:16384
ds_read_b128 a[100:103], v24 offset:20480
ds_read_b128 a[104:107], v25 offset:16384
ds_read_b128 a[108:111], v25 offset:20480
ds_read_b128 a[112:115], v26 offset:16384
ds_read_b128 a[116:119], v26 offset:20480
ds_read_b128 a[120:123], v27 offset:16384
ds_read_b128 a[124:127], v27 offset:20480
v_mfma_f32_16x16x32_bf16 v[164:167], a[140:143], v[104:107], v[164:167]
v_fma_f32 v76, v76, s89, -v32
v_fma_f32 v77, v77, s89, -v32
v_fma_f32 v78, v78, s89, -v32
v_mfma_f32_16x16x32_bf16 v[168:171], a[144:147], v[96:99], v[168:171]
v_fma_f32 v79, v79, s89, -v32
v_fma_f32 v80, v80, s89, -v34
v_mfma_f32_16x16x32_bf16 v[172:175], a[144:147], v[100:103], v[172:175]
v_fma_f32 v81, v81, s89, -v34
v_fma_f32 v82, v82, s89, -v34
v_fma_f32 v83, v83, s89, -v34
buffer_load_dwordx4 v29, s[56:59], s94 offen offset:3072 nt lds
v_mfma_f32_16x16x32_bf16 v[176:179], a[144:147], v[104:107], v[176:179]
v_fma_f32 v84, v84, s89, -v30
v_fma_f32 v85, v85, s89, -v30
v_mfma_f32_16x16x32_bf16 v[180:183], a[148:151], v[96:99], v[180:183]
v_fma_f32 v86, v86, s89, -v30
v_fma_f32 v87, v87, s89, -v30
v_fma_f32 v88, v88, s89, -v32
v_mfma_f32_16x16x32_bf16 v[184:187], a[148:151], v[100:103], v[184:187]
v_fma_f32 v89, v89, s89, -v32
v_fma_f32 v90, v90, s89, -v32
s_add_u32 m0, s77, 28672
s_add_u32 s94, s83, 4096
buffer_load_dwordx4 v28, s[56:59], s94 offen offset:0 nt lds
v_mfma_f32_16x16x32_bf16 v[188:191], a[148:151], v[104:107], v[188:191]
v_fma_f32 v91, v91, s89, -v32
v_fma_f32 v92, v92, s89, -v34
v_fma_f32 v93, v93, s89, -v34
v_mfma_f32_16x16x32_bf16 v[192:195], a[152:155], v[96:99], v[192:195]
v_fma_f32 v94, v94, s89, -v34
v_fma_f32 v95, v95, s89, -v34
v_mfma_f32_16x16x32_bf16 v[196:199], a[152:155], v[100:103], v[196:199]
v_max3_f32 v36, v72, v73, v74
v_max3_f32 v37, v76, v77, v78
v_max3_f32 v38, v80, v81, v82
buffer_load_dwordx4 v29, s[56:59], s94 offen offset:1024 nt lds
v_mfma_f32_16x16x32_bf16 v[200:203], a[152:155], v[104:107], v[200:203]
v_max3_f32 v36, v36, v75, v84
v_max3_f32 v37, v37, v79, v88
v_mfma_f32_16x16x32_bf16 v[204:207], a[156:159], v[96:99], v[204:207]
v_max3_f32 v38, v38, v83, v92
v_max3_f32 v36, v36, v85, v86
v_max3_f32 v37, v37, v89, v90
buffer_load_dwordx4 v28, s[56:59], s94 offen offset:2048 nt lds
v_mfma_f32_16x16x32_bf16 v[208:211], a[156:159], v[100:103], v[208:211]
v_max3_f32 v38, v38, v93, v94
v_max_f32 v36, v36, v87
v_mfma_f32_16x16x32_bf16 v[212:215], a[156:159], v[104:107], v[212:215]
v_max_f32 v37, v37, v91
v_max_f32 v38, v38, v95
v_max3_f32 v39, v36, v37, v38
buffer_load_dwordx4 v29, s[56:59], s94 offen offset:3072 nt lds
v_cmp_lt_f32 vcc, s87, v39
s_cbranch_vccz L_fast19
s_call_b64 s[90:91], L_rescale1
L_fast19:
s_waitcnt lgkmcnt(0)
v_mfma_f32_16x16x32_bf16 v[48:51], a[96:99], a[0:3], 0
v_exp_f32 v72, v72
v_mfma_f32_16x16x32_bf16 v[52:55], a[96:99], a[16:19], 0
v_exp_f32 v73, v73
v_exp_f32 v74, v74
s_add_u32 s98, s96, s97
s_and_b32 s98, s98, 3
s_and_b32 s78, s96, -4
s_or_b32 s78, s78, s98
s_lshl_b32 s78, s78, 15
s_add_u32 s78, s78, s99
s_add_u32 s96, s96, 1
s_add_u32 m0, s77, 16384
s_add_u32 s94, s78, 0
buffer_load_dwordx4 v28, s[52:55], s94 offen offset:0 nt lds
v_mfma_f32_16x16x32_bf16 v[56:59], a[96:99], a[32:35], 0
v_exp_f32 v75, v75
v_mfma_f32_16x16x32_bf16 v[60:63], a[100:103], a[0:3], 0
v_exp_f32 v84, v84
v_mfma_f32_16x16x32_bf16 v[64:67], a[100:103], a[16:19], 0
v_exp_f32 v85, v85
buffer_load_dwordx4 v29, s[52:55], s94 offen offset:1024 nt lds
v_mfma_f32_16x16x32_bf16 v[68:71], a[100:103], a[32:35], 0
v_exp_f32 v86, v86
v_exp_f32 v87, v87
v_mfma_f32_16x16x32_bf16 v[48:51], a[104:107], a[4:7], v[48:51]
v_exp_f32 v76, v76
v_mfma_f32_16x16x32_bf16 v[52:55], a[104:107], a[20:23], v[52:55]
v_exp_f32 v77, v77
buffer_load_dwordx4 v28, s[52:55], s94 offen offset:2048 nt lds
v_mfma_f32_16x16x32_bf16 v[56:59], a[104:107], a[36:39], v[56:59]
v_exp_f32 v78, v78
v_mfma_f32_16x16x32_bf16 v[60:63], a[108:111], a[4:7], v[60:63]
v_exp_f32 v79, v79
v_exp_f32 v88, v88
v_mfma_f32_16x16x32_bf16 v[64:67], a[108:111], a[20:23], v[64:67]
v_exp_f32 v89, v89
s_waitcnt vmcnt(19)
ds_read_b64_tr_b16 a[128:129], v16 offset:8192
ds_read_b64_tr_b16 a[130:131], v16 offset:12288
ds_read_b64_tr_b16 a[132:133], v17 offset:8192
ds_read_b64_tr_b16 a[134:135], v17 offset:12288
ds_read_b64_tr_b16 a[136:137], v18 offset:8192
ds_read_b64_tr_b16 a[138:139], v18 offset:12288
ds_read_b64_tr_b16 a[140:141], v19 offset:8192
ds_read_b64_tr_b16 a[142:143], v19 offset:12288
ds_read_b64_tr_b16 a[144:145], v20 offset:8192
ds_read_b64_tr_b16 a[146:147], v20 offset:12288
ds_read_b64_tr_b16 a[148:149], v21 offset:8192
ds_read_b64_tr_b16 a[150:151], v21 offset:12288
ds_read_b64_tr_b16 a[152:153], v22 offset:8192
ds_read_b64_tr_b16 a[154:155], v22 offset:12288
ds_read_b64_tr_b16 a[156:157], v23 offset:8192
ds_read_b64_tr_b16 a[158:159], v23 offset:12288
v_mfma_f32_16x16x32_bf16 v[68:71], a[108:111], a[36:39], v[68:71]
v_exp_f32 v90, v90
v_mfma_f32_16x16x32_bf16 v[48:51], a[112:115], a[8:11], v[48:51]
v_exp_f32 v91, v91
v_cvt_pk_bf16_f32 v96, v72, v73
v_mfma_f32_16x16x32_bf16 v[52:55], a[112:115], a[24:27], v[52:55]
v_cvt_pk_bf16_f32 v97, v74, v75
v_cvt_pk_bf16_f32 v98, v84, v85
buffer_load_dwordx4 v29, s[52:55], s94 offen offset:3072 nt lds
v_mfma_f32_16x16x32_bf16 v[56:59], a[112:115], a[40:43], v[56:59]
v_cvt_pk_bf16_f32 v99, v86, v87
v_exp_f32 v80, v80
v_mfma_f32_16x16x32_bf16 v[60:63], a[116:119], a[8:11], v[60:63]
v_exp_f32 v81, v81
v_mfma_f32_16x16x32_bf16 v[64:67], a[116:119], a[24:27], v[64:67]
v_exp_f32 v82, v82
s_add_u32 m0, s77, 20480
s_add_u32 s94, s78, 4096
buffer_load_dwordx4 v28, s[52:55], s94 offen offset:0 nt lds
v_mfma_f32_16x16x32_bf16 v[68:71], a[116:119], a[40:43], v[68:71]
v_exp_f32 v83, v83
v_exp_f32 v92, v92
v_mfma_f32_16x16x32_bf16 v[48:51], a[120:123], a[12:15], v[48:51]
v_exp_f32 v93, v93
v_mfma_f32_16x16x32_bf16 v[52:55], a[120:123], a[28:31], v[52:55]
v_exp_f32 v94, v94
buffer_load_dwordx4 v29, s[52:55], s94 offen offset:1024 nt lds
v_mfma_f32_16x16x32_bf16 v[56:59], a[120:123], a[44:47], v[56:59]
v_exp_f32 v95, v95
v_cvt_pk_bf16_f32 v100, v76, v77
v_mfma_f32_16x16x32_bf16 v[60:63], a[124:127], a[12:15], v[60:63]
v_cvt_pk_bf16_f32 v101, v78, v79
v_cvt_pk_bf16_f32 v102, v88, v89
buffer_load_dwordx4 v28, s[52:55], s94 offen offset:2048 nt lds
v_mfma_f32_16x16x32_bf16 v[64:67], a[124:127], a[28:31], v[64:67]
v_cvt_pk_bf16_f32 v103, v90, v91
v_cvt_pk_bf16_f32 v104, v80, v81
v_cvt_pk_bf16_f32 v105, v82, v83
v_mfma_f32_16x16x32_bf16 v[68:71], a[124:127], a[44:47], v[68:71]
v_cvt_pk_bf16_f32 v106, v92, v93
v_cvt_pk_bf16_f32 v107, v94, v95
buffer_load_dwordx4 v29, s[52:55], s94 offen offset:3072 nt lds
s_waitcnt lgkmcnt(0)
v_mfma_f32_16x16x32_bf16 v[120:123], a[128:131], v[96:99], v[120:123]
v_add_f32 v31, v31, v72
v_add_f32 v33, v33, v76
v_add_f32 v35, v35, v80
v_mfma_f32_16x16x32_bf16 v[124:127], a[128:131], v[100:103], v[124:127]
v_add_f32 v31, v31, v73
v_add_f32 v33, v33, v77
s_add_u32 s98, s84, s97
s_and_b32 s98, s98, 3
s_and_b32 s83, s84, -4
s_or_b32 s83, s83, s98
s_lshl_b32 s83, s83, 15
s_add_u32 s83, s83, s99
s_add_u32 s84, s84, 1
s_add_u32 m0, s77, 8192
s_add_u32 s94, s83, 0
buffer_load_dwordx4 v28, s[56:59], s94 offen offset:0 nt lds
v_mfma_f32_16x16x32_bf16 v[128:131], a[128:131], v[104:107], v[128:131]
v_add_f32 v35, v35, v81
v_add_f32 v31, v31, v74
v_add_f32 v33, v33, v78
v_mfma_f32_16x16x32_bf16 v[132:135], a[132:135], v[96:99], v[132:135]
v_add_f32 v35, v35, v82
v_add_f32 v31, v31, v75
v_mfma_f32_16x16x32_bf16 v[136:139], a[132:135], v[100:103], v[136:139]
v_add_f32 v33, v33, v79
v_add_f32 v35, v35, v83
v_add_f32 v31, v31, v84
buffer_load_dwordx4 v29, s[56:59], s94 offen offset:1024 nt lds
v_mfma_f32_16x16x32_bf16 v[140:143], a[132:135], v[104:107], v[140:143]
v_add_f32 v33, v33, v88
v_add_f32 v35, v35, v92
v_mfma_f32_16x16x32_bf16 v[144:147], a[136:139], v[96:99], v[144:147]
v_add_f32 v31, v31, v85
v_add_f32 v33, v33, v89
v_add_f32 v35, v35, v93
v_mfma_f32_16x16x32_bf16 v[148:151], a[136:139], v[100:103], v[148:151]
v_add_f32 v31, v31, v86
v_add_f32 v33, v33, v90
buffer_load_dwordx4 v28, s[56:59], s94 offen offset:2048 nt lds
v_mfma_f32_16x16x32_bf16 v[152:155], a[136:139], v[104:107], v[152:155]
v_add_f32 v35, v35, v94
v_add_f32 v31, v31, v87
v_add_f32 v33, v33, v91
v_mfma_f32_16x16x32_bf16 v[156:159], a[140:143], v[96:99], v[156:159]
v_add_f32 v35, v35, v95
v_fma_f32 v48, v48, s89, -v30
v_mfma_f32_16x16x32_bf16 v[160:163], a[140:143], v[100:103], v[160:163]
v_fma_f32 v49, v49, s89, -v30
v_fma_f32 v50, v50, s89, -v30
v_fma_f32 v51, v51, s89, -v30
s_waitcnt vmcnt(19)
ds_read_b128 a[96:99], v24 offset:0
ds_read_b128 a[100:103], v24 offset:4096
ds_read_b128 a[104:107], v25 offset:0
ds_read_b128 a[108:111], v25 offset:4096
ds_read_b128 a[112:115], v26 offset:0
ds_read_b128 a[116:119], v26 offset:4096
ds_read_b128 a[120:123], v27 offset:0
ds_read_b128 a[124:127], v27 offset:4096
v_mfma_f32_16x16x32_bf16 v[164:167], a[140:143], v[104:107], v[164:167]
v_fma_f32 v52, v52, s89, -v32
v_fma_f32 v53, v53, s89, -v32
v_fma_f32 v54, v54, s89, -v32
v_mfma_f32_16x16x32_bf16 v[168:171], a[144:147], v[96:99], v[168:171]
v_fma_f32 v55, v55, s89, -v32
v_fma_f32 v56, v56, s89, -v34
v_mfma_f32_16x16x32_bf16 v[172:175], a[144:147], v[100:103], v[172:175]
v_fma_f32 v57, v57, s89, -v34
v_fma_f32 v58, v58, s89, -v34
v_fma_f32 v59, v59, s89, -v34
buffer_load_dwordx4 v29, s[56:59], s94 offen offset:3072 nt lds
v_mfma_f32_16x16x32_bf16 v[176:179], a[144:147], v[104:107], v[176:179]
v_fma_f32 v60, v60, s89, -v30
v_fma_f32 v61, v61, s89, -v30
v_mfma_f32_16x16x32_bf16 v[180:183], a[148:151], v[96:99], v[180:183]
v_fma_f32 v62, v62, s89, -v30
v_fma_f32 v63, v63, s89, -v30
v_fma_f32 v64, v64, s89, -v32
v_mfma_f32_16x16x32_bf16 v[184:187], a[148:151], v[100:103], v[184:187]
v_fma_f32 v65, v65, s89, -v32
v_fma_f32 v66, v66, s89, -v32
s_add_u32 m0, s77, 12288
s_add_u32 s94, s83, 4096
buffer_load_dwordx4 v28, s[56:59], s94 offen offset:0 nt lds
v_mfma_f32_16x16x32_bf16 v[188:191], a[148:151], v[104:107], v[188:191]
v_fma_f32 v67, v67, s89, -v32
v_fma_f32 v68, v68, s89, -v34
v_fma_f32 v69, v69, s89, -v34
v_mfma_f32_16x16x32_bf16 v[192:195], a[152:155], v[96:99], v[192:195]
v_fma_f32 v70, v70, s89, -v34
v_fma_f32 v71, v71, s89, -v34
v_mfma_f32_16x16x32_bf16 v[196:199], a[152:155], v[100:103], v[196:199]
v_max3_f32 v36, v48, v49, v50
v_max3_f32 v37, v52, v53, v54
v_max3_f32 v38, v56, v57, v58
buffer_load_dwordx4 v29, s[56:59], s94 offen offset:1024 nt lds
v_mfma_f32_16x16x32_bf16 v[200:203], a[152:155], v[104:107], v[200:203]
v_max3_f32 v36, v36, v51, v60
v_max3_f32 v37, v37, v55, v64
v_mfma_f32_16x16x32_bf16 v[204:207], a[156:159], v[96:99], v[204:207]
v_max3_f32 v38, v38, v59, v68
v_max3_f32 v36, v36, v61, v62
v_max3_f32 v37, v37, v65, v66
buffer_load_dwordx4 v28, s[56:59], s94 offen offset:2048 nt lds
v_mfma_f32_16x16x32_bf16 v[208:211], a[156:159], v[100:103], v[208:211]
v_max3_f32 v38, v38, v69, v70
v_max_f32 v36, v36, v63
v_mfma_f32_16x16x32_bf16 v[212:215], a[156:159], v[104:107], v[212:215]
v_max_f32 v37, v37, v67
v_max_f32 v38, v38, v71
v_max3_f32 v39, v36, v37, v38
buffer_load_dwordx4 v29, s[56:59], s94 offen offset:3072 nt lds
v_cmp_lt_f32 vcc, s87, v39
s_cbranch_vccz L_fast20
s_call_b64 s[90:91], L_rescale0
L_fast20:
s_sub_u32 s86, s86, 1
s_cmp_lg_u32 s86, 0
s_cbranch_scc1 L_loopB2
s_waitcnt lgkmcnt(0)
v_mfma_f32_16x16x32_bf16 v[72:75], a[96:99], a[0:3], 0
v_exp_f32 v48, v48
v_mfma_f32_16x16x32_bf16 v[76:79], a[96:99], a[16:19], 0
v_exp_f32 v49, v49
v_exp_f32 v50, v50
s_add_u32 s98, s96, s97
s_and_b32 s98, s98, 3
s_and_b32 s78, s96, -4
s_or_b32 s78, s78, s98
s_lshl_b32 s78, s78, 15
s_add_u32 s78, s78, s99
s_add_u32 s96, s96, 1
s_add_u32 m0, s77, 0
s_add_u32 s94, s78, 0
buffer_load_dwordx4 v28, s[52:55], s94 offen offset:0 nt lds
v_mfma_f32_16x16x32_bf16 v[80:83], a[96:99], a[32:35], 0
v_exp_f32 v51, v51
v_mfma_f32_16x16x32_bf16 v[84:87], a[100:103], a[0:3], 0
v_exp_f32 v60, v60
v_mfma_f32_16x16x32_bf16 v[88:91], a[100:103], a[16:19], 0
v_exp_f32 v61, v61
buffer_load_dwordx4 v29, s[52:55], s94 offen offset:1024 nt lds
v_mfma_f32_16x16x32_bf16 v[92:95], a[100:103], a[32:35], 0
v_exp_f32 v62, v62
v_exp_f32 v63, v63
v_mfma_f32_16x16x32_bf16 v[72:75], a[104:107], a[4:7], v[72:75]
v_exp_f32 v52, v52
v_mfma_f32_16x16x32_bf16 v[76:79], a[104:107], a[20:23], v[76:79]
v_exp_f32 v53, v53
buffer_load_dwordx4 v28, s[52:55], s94 offen offset:2048 nt lds
v_mfma_f32_16x16x32_bf16 v[80:83], a[104:107], a[36:39], v[80:83]
v_exp_f32 v54, v54
v_mfma_f32_16x16x32_bf16 v[84:87], a[108:111], a[4:7], v[84:87]
v_exp_f32 v55, v55
v_exp_f32 v64, v64
v_mfma_f32_16x16x32_bf16 v[88:91], a[108:111], a[20:23], v[88:91]
v_exp_f32 v65, v65
s_waitcnt vmcnt(19)
ds_read_b64_tr_b16 a[128:129], v16 offset:24576
ds_read_b64_tr_b16 a[130:131], v16 offset:28672
ds_read_b64_tr_b16 a[132:133], v17 offset:24576
ds_read_b64_tr_b16 a[134:135], v17 offset:28672
ds_read_b64_tr_b16 a[136:137], v18 offset:24576
ds_read_b64_tr_b16 a[138:139], v18 offset:28672
ds_read_b64_tr_b16 a[140:141], v19 offset:24576
ds_read_b64_tr_b16 a[142:143], v19 offset:28672
ds_read_b64_tr_b16 a[144:145], v20 offset:24576
ds_read_b64_tr_b16 a[146:147], v20 offset:28672
ds_read_b64_tr_b16 a[148:149], v21 offset:24576
ds_read_b64_tr_b16 a[150:151], v21 offset:28672
ds_read_b64_tr_b16 a[152:153], v22 offset:24576
ds_read_b64_tr_b16 a[154:155], v22 offset:28672
ds_read_b64_tr_b16 a[156:157], v23 offset:24576
ds_read_b64_tr_b16 a[158:159], v23 offset:28672
v_mfma_f32_16x16x32_bf16 v[92:95], a[108:111], a[36:39], v[92:95]
v_exp_f32 v66, v66
v_mfma_f32_16x16x32_bf16 v[72:75], a[112:115], a[8:11], v[72:75]
v_exp_f32 v67, v67
v_cvt_pk_bf16_f32 v96, v48, v49
v_mfma_f32_16x16x32_bf16 v[76:79], a[112:115], a[24:27], v[76:79]
v_cvt_pk_bf16_f32 v97, v50, v51
v_cvt_pk_bf16_f32 v98, v60, v61
buffer_load_dwordx4 v29, s[52:55], s94 offen offset:3072 nt lds
v_mfma_f32_16x16x32_bf16 v[80:83], a[112:115], a[40:43], v[80:83]
v_cvt_pk_bf16_f32 v99, v62, v63
v_exp_f32 v56, v56
v_mfma_f32_16x16x32_bf16 v[84:87], a[116:119], a[8:11], v[84:87]
v_exp_f32 v57, v57
v_mfma_f32_16x16x32_bf16 v[88:91], a[116:119], a[24:27], v[88:91]
v_exp_f32 v58, v58
s_add_u32 m0, s77, 4096
s_add_u32 s94, s78, 4096
buffer_load_dwordx4 v28, s[52:55], s94 offen offset:0 nt lds
v_mfma_f32_16x16x32_bf16 v[92:95], a[116:119], a[40:43], v[92:95]
v_exp_f32 v59, v59
v_exp_f32 v68, v68
v_mfma_f32_16x16x32_bf16 v[72:75], a[120:123], a[12:15], v[72:75]
v_exp_f32 v69, v69
v_mfma_f32_16x16x32_bf16 v[76:79], a[120:123], a[28:31], v[76:79]
v_exp_f32 v70, v70
buffer_load_dwordx4 v29, s[52:55], s94 offen offset:1024 nt lds
v_mfma_f32_16x16x32_bf16 v[80:83], a[120:123], a[44:47], v[80:83]
v_exp_f32 v71, v71
v_cvt_pk_bf16_f32 v100, v52, v53
v_mfma_f32_16x16x32_bf16 v[84:87], a[124:127], a[12:15], v[84:87]
v_cvt_pk_bf16_f32 v101, v54, v55
v_cvt_pk_bf16_f32 v102, v64, v65
buffer_load_dwordx4 v28, s[52:55], s94 offen offset:2048 nt lds
v_mfma_f32_16x16x32_bf16 v[88:91], a[124:127], a[28:31], v[88:91]
v_cvt_pk_bf16_f32 v103, v66, v67
v_cvt_pk_bf16_f32 v104, v56, v57
v_cvt_pk_bf16_f32 v105, v58, v59
v_mfma_f32_16x16x32_bf16 v[92:95], a[124:127], a[44:47], v[92:95]
v_cvt_pk_bf16_f32 v106, v68, v69
v_cvt_pk_bf16_f32 v107, v70, v71
buffer_load_dwordx4 v29, s[52:55], s94 offen offset:3072 nt lds
s_waitcnt lgkmcnt(0)
v_mfma_f32_16x16x32_bf16 v[120:123], a[128:131], v[96:99], v[120:123]
v_add_f32 v31, v31, v48
v_add_f32 v33, v33, v52
v_add_f32 v35, v35, v56
v_mfma_f32_16x16x32_bf16 v[124:127], a[128:131], v[100:103], v[124:127]
v_add_f32 v31, v31, v49
v_add_f32 v33, v33, v53
s_add_u32 s98, s84, s97
s_and_b32 s98, s98, 3
s_and_b32 s83, s84, -4
s_or_b32 s83, s83, s98
s_lshl_b32 s83, s83, 15
s_add_u32 s83, s83, s99
s_add_u32 s84, s84, 1
s_add_u32 m0, s77, 24576
s_add_u32 s94, s83, 0
buffer_load_dwordx4 v28, s[56:59], s94 offen offset:0 nt lds
v_mfma_f32_16x16x32_bf16 v[128:131], a[128:131], v[104:107], v[128:131]
v_add_f32 v35, v35, v57
v_add_f32 v31, v31, v50
v_add_f32 v33, v33, v54
v_mfma_f32_16x16x32_bf16 v[132:135], a[132:135], v[96:99], v[132:135]
v_add_f32 v35, v35, v58
v_add_f32 v31, v31, v51
v_mfma_f32_16x16x32_bf16 v[136:139], a[132:135], v[100:103], v[136:139]
v_add_f32 v33, v33, v55
v_add_f32 v35, v35, v59
v_add_f32 v31, v31, v60
buffer_load_dwordx4 v29, s[56:59], s94 offen offset:1024 nt lds
v_mfma_f32_16x16x32_bf16 v[140:143], a[132:135], v[104:107], v[140:143]
v_add_f32 v33, v33, v64
v_add_f32 v35, v35, v68
v_mfma_f32_16x16x32_bf16 v[144:147], a[136:139], v[96:99], v[144:147]
v_add_f32 v31, v31, v61
v_add_f32 v33, v33, v65
v_add_f32 v35, v35, v69
v_mfma_f32_16x16x32_bf16 v[148:151], a[136:139], v[100:103], v[148:151]
v_add_f32 v31, v31, v62
v_add_f32 v33, v33, v66
buffer_load_dwordx4 v28, s[56:59], s94 offen offset:2048 nt lds
v_mfma_f32_16x16x32_bf16 v[152:155], a[136:139], v[104:107], v[152:155]
v_add_f32 v35, v35, v70
v_add_f32 v31, v31, v63
v_add_f32 v33, v33, v67
v_mfma_f32_16x16x32_bf16 v[156:159], a[140:143], v[96:99], v[156:159]
v_add_f32 v35, v35, v71
v_fma_f32 v72, v72, s89, -v30
v_mfma_f32_16x16x32_bf16 v[160:163], a[140:143], v[100:103], v[160:163]
v_fma_f32 v73, v73, s89, -v30
v_fma_f32 v74, v74, s89, -v30
v_fma_f32 v75, v75, s89, -v30
s_waitcnt vmcnt(19)
ds_read_b128 a[96:99], v24 offset:16384
ds_read_b128 a[100:103], v24 offset:20480
ds_read_b128 a[104:107], v25 offset:16384
ds_read_b128 a[108:111], v25 offset:20480
ds_read_b128 a[112:115], v26 offset:16384
ds_read_b128 a[116:119], v26 offset:20480
ds_read_b128 a[120:123], v27 offset:16384
ds_read_b128 a[124:127], v27 offset:20480
v_mfma_f32_16x16x32_bf16 v[164:167], a[140:143], v[104:107], v[164:167]
v_fma_f32 v76, v76, s89, -v32
v_fma_f32 v77, v77, s89, -v32
v_fma_f32 v78, v78, s89, -v32
v_mfma_f32_16x16x32_bf16 v[168:171], a[144:147], v[96:99], v[168:171]
v_fma_f32 v79, v79, s89, -v32
v_fma_f32 v80, v80, s89, -v34
v_mfma_f32_16x16x32_bf16 v[172:175], a[144:147], v[100:103], v[172:175]
v_fma_f32 v81, v81, s89, -v34
v_fma_f32 v82, v82, s89, -v34
v_fma_f32 v83, v83, s89, -v34
buffer_load_dwordx4 v29, s[56:59], s94 offen offset:3072 nt lds
v_mfma_f32_16x16x32_bf16 v[176:179], a[144:147], v[104:107], v[176:179]
v_fma_f32 v84, v84, s89, -v30
v_fma_f32 v85, v85, s89, -v30
v_mfma_f32_16x16x32_bf16 v[180:183], a[148:151], v[96:99], v[180:183]
v_fma_f32 v86, v86, s89, -v30
v_fma_f32 v87, v87, s89, -v30
v_fma_f32 v88, v88, s89, -v32
v_mfma_f32_16x16x32_bf16 v[184:187], a[148:151], v[100:103], v[184:187]
v_fma_f32 v89, v89, s89, -v32
v_fma_f32 v90, v90, s89, -v32
s_add_u32 m0, s77, 28672
s_add_u32 s94, s83, 4096
buffer_load_dwordx4 v28, s[56:59], s94 offen offset:0 nt lds
v_mfma_f32_16x16x32_bf16 v[188:191], a[148:151], v[104:107], v[188:191]
v_fma_f32 v91, v91, s89, -v32
v_fma_f32 v92, v92, s89, -v34
v_fma_f32 v93, v93, s89, -v34
v_mfma_f32_16x16x32_bf16 v[192:195], a[152:155], v[96:99], v[192:195]
v_fma_f32 v94, v94, s89, -v34
v_fma_f32 v95, v95, s89, -v34
v_mfma_f32_16x16x32_bf16 v[196:199], a[152:155], v[100:103], v[196:199]
v_max3_f32 v36, v72, v73, v74
v_max3_f32 v37, v76, v77, v78
v_max3_f32 v38, v80, v81, v82
buffer_load_dwordx4 v29, s[56:59], s94 offen offset:1024 nt lds
v_mfma_f32_16x16x32_bf16 v[200:203], a[152:155], v[104:107], v[200:203]
v_max3_f32 v36, v36, v75, v84
v_max3_f32 v37, v37, v79, v88
v_mfma_f32_16x16x32_bf16 v[204:207], a[156:159], v[96:99], v[204:207]
v_max3_f32 v38, v38, v83, v92
v_max3_f32 v36, v36, v85, v86
v_max3_f32 v37, v37, v89, v90
buffer_load_dwordx4 v28, s[56:59], s94 offen offset:2048 nt lds
v_mfma_f32_16x16x32_bf16 v[208:211], a[156:159], v[100:103], v[208:211]
v_max3_f32 v38, v38, v93, v94
v_max_f32 v36, v36, v87
v_mfma_f32_16x16x32_bf16 v[212:215], a[156:159], v[104:107], v[212:215]
v_max_f32 v37, v37, v91
v_max_f32 v38, v38, v95
v_max3_f32 v39, v36, v37, v38
buffer_load_dwordx4 v29, s[56:59], s94 offen offset:3072 nt lds
v_cmp_lt_f32 vcc, s87, v39
s_cbranch_vccz L_fast21
s_call_b64 s[90:91], L_rescale1
L_fast21:
s_waitcnt lgkmcnt(0)
v_mfma_f32_16x16x32_bf16 v[48:51], a[96:99], a[0:3], 0
v_exp_f32 v72, v72
v_mfma_f32_16x16x32_bf16 v[52:55], a[96:99], a[16:19], 0
v_exp_f32 v73, v73
v_exp_f32 v74, v74
s_add_u32 s85, s2, 0
s_and_b32 s85, s85, 3
s_lshl_b32 s85, s85, 15
s_add_u32 s85, s85, s93
s_add_u32 m0, s77, 16384
s_add_u32 s94, s85, 0
buffer_load_dwordx4 v218, s[68:71], s94 offen offset:0 lds
v_mfma_f32_16x16x32_bf16 v[56:59], a[96:99], a[32:35], 0
v_exp_f32 v75, v75
v_mfma_f32_16x16x32_bf16 v[60:63], a[100:103], a[0:3], 0
v_exp_f32 v84, v84
v_mfma_f32_16x16x32_bf16 v[64:67], a[100:103], a[16:19], 0
v_exp_f32 v85, v85
s_add_u32 s94, s85, 3072
buffer_load_dwordx4 v219, s[68:71], s94 offen offset:1024 lds
v_mfma_f32_16x16x32_bf16 v[68:71], a[100:103], a[32:35], 0
v_exp_f32 v86, v86
v_exp_f32 v87, v87
v_mfma_f32_16x16x32_bf16 v[48:51], a[104:107], a[4:7], v[48:51]
v_exp_f32 v76, v76
v_mfma_f32_16x16x32_bf16 v[52:55], a[104:107], a[20:23], v[52:55]
v_exp_f32 v77, v77
s_add_u32 s94, s85, 6144
buffer_load_dwordx4 v218, s[68:71], s94 offen offset:2048 lds
v_mfma_f32_16x16x32_bf16 v[56:59], a[104:107], a[36:39], v[56:59]
v_exp_f32 v78, v78
v_mfma_f32_16x16x32_bf16 v[60:63], a[108:111], a[4:7], v[60:63]
v_exp_f32 v79, v79
v_exp_f32 v88, v88
v_mfma_f32_16x16x32_bf16 v[64:67], a[108:111], a[20:23], v[64:67]
v_exp_f32 v89, v89
s_waitcnt vmcnt(19)
ds_read_b64_tr_b16 a[128:129], v16 offset:8192
ds_read_b64_tr_b16 a[130:131], v16 offset:12288
ds_read_b64_tr_b16 a[132:133], v17 offset:8192
ds_read_b64_tr_b16 a[134:135], v17 offset:12288
ds_read_b64_tr_b16 a[136:137], v18 offset:8192
ds_read_b64_tr_b16 a[138:139], v18 offset:12288
ds_read_b64_tr_b16 a[140:141], v19 offset:8192
ds_read_b64_tr_b16 a[142:143], v19 offset:12288
ds_read_b64_tr_b16 a[144:145], v20 offset:8192
ds_read_b64_tr_b16 a[146:147], v20 offset:12288
ds_read_b64_tr_b16 a[148:149], v21 offset:8192
ds_read_b64_tr_b16 a[150:151], v21 offset:12288
ds_read_b64_tr_b16 a[152:153], v22 offset:8192
ds_read_b64_tr_b16 a[154:155], v22 offset:12288
ds_read_b64_tr_b16 a[156:157], v23 offset:8192
ds_read_b64_tr_b16 a[158:159], v23 offset:12288
v_mfma_f32_16x16x32_bf16 v[68:71], a[108:111], a[36:39], v[68:71]
v_exp_f32 v90, v90
v_mfma_f32_16x16x32_bf16 v[48:51], a[112:115], a[8:11], v[48:51]
v_exp_f32 v91, v91
v_cvt_pk_bf16_f32 v96, v72, v73
v_mfma_f32_16x16x32_bf16 v[52:55], a[112:115], a[24:27], v[52:55]
v_cvt_pk_bf16_f32 v97, v74, v75
v_cvt_pk_bf16_f32 v98, v84, v85
s_add_u32 s94, s85, 9216
buffer_load_dwordx4 v219, s[68:71], s94 offen offset:3072 lds
v_mfma_f32_16x16x32_bf16 v[56:59], a[112:115], a[40:43], v[56:59]
v_cvt_pk_bf16_f32 v99, v86, v87
v_exp_f32 v80, v80
v_mfma_f32_16x16x32_bf16 v[60:63], a[116:119], a[8:11], v[60:63]
v_exp_f32 v81, v81
v_mfma_f32_16x16x32_bf16 v[64:67], a[116:119], a[24:27], v[64:67]
v_exp_f32 v82, v82
s_add_u32 m0, s77, 20480
s_add_u32 s94, s85, 16384
buffer_load_dwordx4 v218, s[68:71], s94 offen offset:0 lds
v_mfma_f32_16x16x32_bf16 v[68:71], a[116:119], a[40:43], v[68:71]
v_exp_f32 v83, v83
v_exp_f32 v92, v92
v_mfma_f32_16x16x32_bf16 v[48:51], a[120:123], a[12:15], v[48:51]
v_exp_f32 v93, v93
v_mfma_f32_16x16x32_bf16 v[52:55], a[120:123], a[28:31], v[52:55]
v_exp_f32 v94, v94
s_add_u32 s94, s85, 19456
buffer_load_dwordx4 v219, s[68:71], s94 offen offset:1024 lds
v_mfma_f32_16x16x32_bf16 v[56:59], a[120:123], a[44:47], v[56:59]
v_exp_f32 v95, v95
v_cvt_pk_bf16_f32 v100, v76, v77
v_mfma_f32_16x16x32_bf16 v[60:63], a[124:127], a[12:15], v[60:63]
v_cvt_pk_bf16_f32 v101, v78, v79
v_cvt_pk_bf16_f32 v102, v88, v89
s_add_u32 s94, s85, 22528
buffer_load_dwordx4 v218, s[68:71], s94 offen offset:2048 lds
v_mfma_f32_16x16x32_bf16 v[64:67], a[124:127], a[28:31], v[64:67]
v_cvt_pk_bf16_f32 v103, v90, v91
v_cvt_pk_bf16_f32 v104, v80, v81
v_cvt_pk_bf16_f32 v105, v82, v83
v_mfma_f32_16x16x32_bf16 v[68:71], a[124:127], a[44:47], v[68:71]
v_cvt_pk_bf16_f32 v106, v92, v93
v_cvt_pk_bf16_f32 v107, v94, v95
s_add_u32 s94, s85, 25600
buffer_load_dwordx4 v219, s[68:71], s94 offen offset:3072 lds
s_waitcnt lgkmcnt(0)
v_mfma_f32_16x16x32_bf16 v[120:123], a[128:131], v[96:99], v[120:123]
v_add_f32 v31, v31, v72
v_add_f32 v33, v33, v76
v_add_f32 v35, v35, v80
v_mfma_f32_16x16x32_bf16 v[124:127], a[128:131], v[100:103], v[124:127]
v_add_f32 v31, v31, v73
v_add_f32 v33, v33, v77
s_add_u32 s98, s84, s97
s_and_b32 s98, s98, 3
s_and_b32 s83, s84, -4
s_or_b32 s83, s83, s98
s_lshl_b32 s83, s83, 15
s_add_u32 s83, s83, s99
s_add_u32 s84, s84, 1
s_add_u32 m0, s77, 8192
s_add_u32 s94, s83, 0
buffer_load_dwordx4 v28, s[56:59], s94 offen offset:0 nt lds
v_mfma_f32_16x16x32_bf16 v[128:131], a[128:131], v[104:107], v[128:131]
v_add_f32 v35, v35, v81
v_add_f32 v31, v31, v74
v_add_f32 v33, v33, v78
v_mfma_f32_16x16x32_bf16 v[132:135], a[132:135], v[96:99], v[132:135]
v_add_f32 v35, v35, v82
v_add_f32 v31, v31, v75
v_mfma_f32_16x16x32_bf16 v[136:139], a[132:135], v[100:103], v[136:139]
v_add_f32 v33, v33, v79
v_add_f32 v35, v35, v83
v_add_f32 v31, v31, v84
buffer_load_dwordx4 v29, s[56:59], s94 offen offset:1024 nt lds
v_mfma_f32_16x16x32_bf16 v[140:143], a[132:135], v[104:107], v[140:143]
v_add_f32 v33, v33, v88
v_add_f32 v35, v35, v92
v_mfma_f32_16x16x32_bf16 v[144:147], a[136:139], v[96:99], v[144:147]
v_add_f32 v31, v31, v85
v_add_f32 v33, v33, v89
v_add_f32 v35, v35, v93
v_mfma_f32_16x16x32_bf16 v[148:151], a[136:139], v[100:103], v[148:151]
v_add_f32 v31, v31, v86
v_add_f32 v33, v33, v90
buffer_load_dwordx4 v28, s[56:59], s94 offen offset:2048 nt lds
v_mfma_f32_16x16x32_bf16 v[152:155], a[136:139], v[104:107], v[152:155]
v_add_f32 v35, v35, v94
v_add_f32 v31, v31, v87
v_add_f32 v33, v33, v91
v_mfma_f32_16x16x32_bf16 v[156:159], a[140:143], v[96:99], v[156:159]
v_add_f32 v35, v35, v95
v_fma_f32 v48, v48, s89, -v30
v_mfma_f32_16x16x32_bf16 v[160:163], a[140:143], v[100:103], v[160:163]
v_fma_f32 v49, v49, s89, -v30
v_fma_f32 v50, v50, s89, -v30
v_fma_f32 v51, v51, s89, -v30
s_waitcnt vmcnt(19)
ds_read_b128 a[96:99], v24 offset:0
ds_read_b128 a[100:103], v24 offset:4096
ds_read_b128 a[104:107], v25 offset:0
ds_read_b128 a[108:111], v25 offset:4096
ds_read_b128 a[112:115], v26 offset:0
ds_read_b128 a[116:119], v26 offset:4096
ds_read_b128 a[120:123], v27 offset:0
ds_read_b128 a[124:127], v27 offset:4096
v_mfma_f32_16x16x32_bf16 v[164:167], a[140:143], v[104:107], v[164:167]
v_fma_f32 v52, v52, s89, -v32
v_fma_f32 v53, v53, s89, -v32
v_fma_f32 v54, v54, s89, -v32
v_mfma_f32_16x16x32_bf16 v[168:171], a[144:147], v[96:99], v[168:171]
v_fma_f32 v55, v55, s89, -v32
v_fma_f32 v56, v56, s89, -v34
v_mfma_f32_16x16x32_bf16 v[172:175], a[144:147], v[100:103], v[172:175]
v_fma_f32 v57, v57, s89, -v34
v_fma_f32 v58, v58, s89, -v34
v_fma_f32 v59, v59, s89, -v34
buffer_load_dwordx4 v29, s[56:59], s94 offen offset:3072 nt lds
v_mfma_f32_16x16x32_bf16 v[176:179], a[144:147], v[104:107], v[176:179]
v_fma_f32 v60, v60, s89, -v30
v_fma_f32 v61, v61, s89, -v30
v_mfma_f32_16x16x32_bf16 v[180:183], a[148:151], v[96:99], v[180:183]
v_fma_f32 v62, v62, s89, -v30
v_fma_f32 v63, v63, s89, -v30
v_fma_f32 v64, v64, s89, -v32
v_mfma_f32_16x16x32_bf16 v[184:187], a[148:151], v[100:103], v[184:187]
v_fma_f32 v65, v65, s89, -v32
v_fma_f32 v66, v66, s89, -v32
s_add_u32 m0, s77, 12288
s_add_u32 s94, s83, 4096
buffer_load_dwordx4 v28, s[56:59], s94 offen offset:0 nt lds
v_mfma_f32_16x16x32_bf16 v[188:191], a[148:151], v[104:107], v[188:191]
v_fma_f32 v67, v67, s89, -v32
v_fma_f32 v68, v68, s89, -v34
v_fma_f32 v69, v69, s89, -v34
v_mfma_f32_16x16x32_bf16 v[192:195], a[152:155], v[96:99], v[192:195]
v_fma_f32 v70, v70, s89, -v34
v_fma_f32 v71, v71, s89, -v34
v_mfma_f32_16x16x32_bf16 v[196:199], a[152:155], v[100:103], v[196:199]
v_max3_f32 v36, v48, v49, v50
v_max3_f32 v37, v52, v53, v54
v_max3_f32 v38, v56, v57, v58
buffer_load_dwordx4 v29, s[56:59], s94 offen offset:1024 nt lds
v_mfma_f32_16x16x32_bf16 v[200:203], a[152:155], v[104:107], v[200:203]
v_max3_f32 v36, v36, v51, v60
v_max3_f32 v37, v37, v55, v64
v_mfma_f32_16x16x32_bf16 v[204:207], a[156:159], v[96:99], v[204:207]
v_max3_f32 v38, v38, v59, v68
v_max3_f32 v36, v36, v61, v62
v_max3_f32 v37, v37, v65, v66
buffer_load_dwordx4 v28, s[56:59], s94 offen offset:2048 nt lds
v_mfma_f32_16x16x32_bf16 v[208:211], a[156:159], v[100:103], v[208:211]
v_max3_f32 v38, v38, v69, v70
v_max_f32 v36, v36, v63
v_mfma_f32_16x16x32_bf16 v[212:215], a[156:159], v[104:107], v[212:215]
v_max_f32 v37, v37, v67
v_max_f32 v38, v38, v71
v_max3_f32 v39, v36, v37, v38
buffer_load_dwordx4 v29, s[56:59], s94 offen offset:3072 nt lds
v_cmp_lt_f32 vcc, s87, v39
s_cbranch_vccz L_fast22
s_call_b64 s[90:91], L_rescale0
L_fast22:
s_waitcnt lgkmcnt(0)
v_mfma_f32_16x16x32_bf16 v[72:75], a[96:99], a[0:3], 0
v_exp_f32 v48, v48
v_mfma_f32_16x16x32_bf16 v[76:79], a[96:99], a[16:19], 0
v_exp_f32 v49, v49
v_exp_f32 v50, v50
v_mfma_f32_16x16x32_bf16 v[80:83], a[96:99], a[32:35], 0
v_exp_f32 v51, v51
v_mfma_f32_16x16x32_bf16 v[84:87], a[100:103], a[0:3], 0
v_exp_f32 v60, v60
v_mfma_f32_16x16x32_bf16 v[88:91], a[100:103], a[16:19], 0
v_exp_f32 v61, v61
v_mfma_f32_16x16x32_bf16 v[92:95], a[100:103], a[32:35], 0
v_exp_f32 v62, v62
v_exp_f32 v63, v63
v_mfma_f32_16x16x32_bf16 v[72:75], a[104:107], a[4:7], v[72:75]
v_exp_f32 v52, v52
v_mfma_f32_16x16x32_bf16 v[76:79], a[104:107], a[20:23], v[76:79]
v_exp_f32 v53, v53
v_mfma_f32_16x16x32_bf16 v[80:83], a[104:107], a[36:39], v[80:83]
v_exp_f32 v54, v54
v_mfma_f32_16x16x32_bf16 v[84:87], a[108:111], a[4:7], v[84:87]
v_exp_f32 v55, v55
v_exp_f32 v64, v64
v_mfma_f32_16x16x32_bf16 v[88:91], a[108:111], a[20:23], v[88:91]
v_exp_f32 v65, v65
s_waitcnt vmcnt(16)
ds_read_b64_tr_b16 a[128:129], v16 offset:24576
ds_read_b64_tr_b16 a[130:131], v16 offset:28672
ds_read_b64_tr_b16 a[132:133], v17 offset:24576
ds_read_b64_tr_b16 a[134:135], v17 offset:28672
ds_read_b64_tr_b16 a[136:137], v18 offset:24576
ds_read_b64_tr_b16 a[138:139], v18 offset:28672
ds_read_b64_tr_b16 a[140:141], v19 offset:24576
ds_read_b64_tr_b16 a[142:143], v19 offset:28672
ds_read_b64_tr_b16 a[144:145], v20 offset:24576
ds_read_b64_tr_b16 a[146:147], v20 offset:28672
ds_read_b64_tr_b16 a[148:149], v21 offset:24576
ds_read_b64_tr_b16 a[150:151], v21 offset:28672
ds_read_b64_tr_b16 a[152:153], v22 offset:24576
ds_read_b64_tr_b16 a[154:155], v22 offset:28672
ds_read_b64_tr_b16 a[156:157], v23 offset:24576
ds_read_b64_tr_b16 a[158:159], v23 offset:28672
v_mfma_f32_16x16x32_bf16 v[92:95], a[108:111], a[36:39], v[92:95]
v_exp_f32 v66, v66
v_mfma_f32_16x16x32_bf16 v[72:75], a[112:115], a[8:11], v[72:75]
v_exp_f32 v67, v67
v_cvt_pk_bf16_f32 v96, v48, v49
v_mfma_f32_16x16x32_bf16 v[76:79], a[112:115], a[24:27], v[76:79]
v_cvt_pk_bf16_f32 v97, v50, v51
v_cvt_pk_bf16_f32 v98, v60, v61
v_mfma_f32_16x16x32_bf16 v[80:83], a[112:115], a[40:43], v[80:83]
v_cvt_pk_bf16_f32 v99, v62, v63
v_exp_f32 v56, v56
v_mfma_f32_16x16x32_bf16 v[84:87], a[116:119], a[8:11], v[84:87]
v_exp_f32 v57, v57
v_mfma_f32_16x16x32_bf16 v[88:91], a[116:119], a[24:27], v[88:91]
v_exp_f32 v58, v58
v_mfma_f32_16x16x32_bf16 v[92:95], a[116:119], a[40:43], v[92:95]
v_exp_f32 v59, v59
v_exp_f32 v68, v68
v_mfma_f32_16x16x32_bf16 v[72:75], a[120:123], a[12:15], v[72:75]
v_exp_f32 v69, v69
v_mfma_f32_16x16x32_bf16 v[76:79], a[120:123], a[28:31], v[76:79]
v_exp_f32 v70, v70
v_mfma_f32_16x16x32_bf16 v[80:83], a[120:123], a[44:47], v[80:83]
v_exp_f32 v71, v71
v_cvt_pk_bf16_f32 v100, v52, v53
v_mfma_f32_16x16x32_bf16 v[84:87], a[124:127], a[12:15], v[84:87]
v_cvt_pk_bf16_f32 v101, v54, v55
v_cvt_pk_bf16_f32 v102, v64, v65
v_mfma_f32_16x16x32_bf16 v[88:91], a[124:127], a[28:31], v[88:91]
v_cvt_pk_bf16_f32 v103, v66, v67
v_cvt_pk_bf16_f32 v104, v56, v57
v_cvt_pk_bf16_f32 v105, v58, v59
v_mfma_f32_16x16x32_bf16 v[92:95], a[124:127], a[44:47], v[92:95]
v_cvt_pk_bf16_f32 v106, v68, v69
v_cvt_pk_bf16_f32 v107, v70, v71
s_waitcnt lgkmcnt(0)
v_mfma_f32_16x16x32_bf16 v[120:123], a[128:131], v[96:99], v[120:123]
v_add_f32 v31, v31, v48
v_add_f32 v33, v33, v52
v_add_f32 v35, v35, v56
v_mfma_f32_16x16x32_bf16 v[124:127], a[128:131], v[100:103], v[124:127]
v_add_f32 v31, v31, v49
v_add_f32 v33, v33, v53
s_add_u32 s85, s2, 1
s_and_b32 s85, s85, 3
s_lshl_b32 s85, s85, 15
s_add_u32 s85, s85, s93
s_add_u32 m0, s77, 24576
s_add_u32 s94, s85, 0
buffer_load_dwordx4 v218, s[68:71], s94 offen offset:0 lds
v_mfma_f32_16x16x32_bf16 v[128:131], a[128:131], v[104:107], v[128:131]
v_add_f32 v35, v35, v57
v_add_f32 v31, v31, v50
v_add_f32 v33, v33, v54
v_mfma_f32_16x16x32_bf16 v[132:135], a[132:135], v[96:99], v[132:135]
v_add_f32 v35, v35, v58
v_add_f32 v31, v31, v51
v_mfma_f32_16x16x32_bf16 v[136:139], a[132:135], v[100:103], v[136:139]
v_add_f32 v33, v33, v55
v_add_f32 v35, v35, v59
v_add_f32 v31, v31, v60
s_add_u32 s94, s85, 3072
buffer_load_dwordx4 v219, s[68:71], s94 offen offset:1024 lds
v_mfma_f32_16x16x32_bf16 v[140:143], a[132:135], v[104:107], v[140:143]
v_add_f32 v33, v33, v64
v_add_f32 v35, v35, v68
v_mfma_f32_16x16x32_bf16 v[144:147], a[136:139], v[96:99], v[144:147]
v_add_f32 v31, v31, v61
v_add_f32 v33, v33, v65
v_add_f32 v35, v35, v69
v_mfma_f32_16x16x32_bf16 v[148:151], a[136:139], v[100:103], v[148:151]
v_add_f32 v31, v31, v62
v_add_f32 v33, v33, v66
s_add_u32 s94, s85, 6144
buffer_load_dwordx4 v218, s[68:71], s94 offen offset:2048 lds
v_mfma_f32_16x16x32_bf16 v[152:155], a[136:139], v[104:107], v[152:155]
v_add_f32 v35, v35, v70
v_add_f32 v31, v31, v63
v_add_f32 v33, v33, v67
v_mfma_f32_16x16x32_bf16 v[156:159], a[140:143], v[96:99], v[156:159]
v_add_f32 v35, v35, v71
v_fma_f32 v72, v72, s89, -v30
v_mfma_f32_16x16x32_bf16 v[160:163], a[140:143], v[100:103], v[160:163]
v_fma_f32 v73, v73, s89, -v30
v_fma_f32 v74, v74, s89, -v30
v_fma_f32 v75, v75, s89, -v30
v_mfma_f32_16x16x32_bf16 v[164:167], a[140:143], v[104:107], v[164:167]
v_fma_f32 v76, v76, s89, -v32
v_fma_f32 v77, v77, s89, -v32
v_fma_f32 v78, v78, s89, -v32
v_mfma_f32_16x16x32_bf16 v[168:171], a[144:147], v[96:99], v[168:171]
v_fma_f32 v79, v79, s89, -v32
v_fma_f32 v80, v80, s89, -v34
v_mfma_f32_16x16x32_bf16 v[172:175], a[144:147], v[100:103], v[172:175]
v_fma_f32 v81, v81, s89, -v34
v_fma_f32 v82, v82, s89, -v34
v_fma_f32 v83, v83, s89, -v34
s_add_u32 s94, s85, 9216
buffer_load_dwordx4 v219, s[68:71], s94 offen offset:3072 lds
v_mfma_f32_16x16x32_bf16 v[176:179], a[144:147], v[104:107], v[176:179]
v_fma_f32 v84, v84, s89, -v30
v_fma_f32 v85, v85, s89, -v30
v_mfma_f32_16x16x32_bf16 v[180:183], a[148:151], v[96:99], v[180:183]
v_fma_f32 v86, v86, s89, -v30
v_fma_f32 v87, v87, s89, -v30
v_fma_f32 v88, v88, s89, -v32
v_mfma_f32_16x16x32_bf16 v[184:187], a[148:151], v[100:103], v[184:187]
v_fma_f32 v89, v89, s89, -v32
v_fma_f32 v90, v90, s89, -v32
s_add_u32 m0, s77, 28672
s_add_u32 s94, s85, 16384
buffer_load_dwordx4 v218, s[68:71], s94 offen offset:0 lds
v_mfma_f32_16x16x32_bf16 v[188:191], a[148:151], v[104:107], v[188:191]
v_fma_f32 v91, v91, s89, -v32
v_fma_f32 v92, v92, s89, -v34
v_fma_f32 v93, v93, s89, -v34
v_mfma_f32_16x16x32_bf16 v[192:195], a[152:155], v[96:99], v[192:195]
v_fma_f32 v94, v94, s89, -v34
v_fma_f32 v95, v95, s89, -v34
v_mfma_f32_16x16x32_bf16 v[196:199], a[152:155], v[100:103], v[196:199]
v_max3_f32 v36, v72, v73, v74
v_max3_f32 v37, v76, v77, v78
v_max3_f32 v38, v80, v81, v82
s_add_u32 s94, s85, 19456
buffer_load_dwordx4 v219, s[68:71], s94 offen offset:1024 lds
v_mfma_f32_16x16x32_bf16 v[200:203], a[152:155], v[104:107], v[200:203]
v_max3_f32 v36, v36, v75, v84
v_max3_f32 v37, v37, v79, v88
v_mfma_f32_16x16x32_bf16 v[204:207], a[156:159], v[96:99], v[204:207]
v_max3_f32 v38, v38, v83, v92
v_max3_f32 v36, v36, v85, v86
v_max3_f32 v37, v37, v89, v90
s_add_u32 s94, s85, 22528
buffer_load_dwordx4 v218, s[68:71], s94 offen offset:2048 lds
v_mfma_f32_16x16x32_bf16 v[208:211], a[156:159], v[100:103], v[208:211]
v_max3_f32 v38, v38, v93, v94
v_max_f32 v36, v36, v87
v_mfma_f32_16x16x32_bf16 v[212:215], a[156:159], v[104:107], v[212:215]
v_max_f32 v37, v37, v91
v_max_f32 v38, v38, v95
v_max3_f32 v39, v36, v37, v38
s_add_u32 s94, s85, 25600
buffer_load_dwordx4 v219, s[68:71], s94 offen offset:3072 lds
v_cmp_lt_f32 vcc, s87, v39
s_cbranch_vccz L_fast23
s_call_b64 s[90:91], L_rescale1
L_fast23:
s_waitcnt lgkmcnt(0)
s_waitcnt vmcnt(8)
ds_read_b64_tr_b16 a[128:129], v16 offset:8192
ds_read_b64_tr_b16 a[130:131], v16 offset:12288
ds_read_b64_tr_b16 a[132:133], v17 offset:8192
ds_read_b64_tr_b16 a[134:135], v17 offset:12288
ds_read_b64_tr_b16 a[136:137], v18 offset:8192
ds_read_b64_tr_b16 a[138:139], v18 offset:12288
ds_read_b64_tr_b16 a[140:141], v19 offset:8192
ds_read_b64_tr_b16 a[142:143], v19 offset:12288
ds_read_b64_tr_b16 a[144:145], v20 offset:8192
ds_read_b64_tr_b16 a[146:147], v20 offset:12288
ds_read_b64_tr_b16 a[148:149], v21 offset:8192
ds_read_b64_tr_b16 a[150:151], v21 offset:12288
ds_read_b64_tr_b16 a[152:153], v22 offset:8192
ds_read_b64_tr_b16 a[154:155], v22 offset:12288
ds_read_b64_tr_b16 a[156:157], v23 offset:8192
ds_read_b64_tr_b16 a[158:159], v23 offset:12288
v_exp_f32 v72, v72
v_exp_f32 v73, v73
v_exp_f32 v74, v74
v_exp_f32 v75, v75
v_exp_f32 v84, v84
v_exp_f32 v85, v85
v_exp_f32 v86, v86
v_exp_f32 v87, v87
v_exp_f32 v76, v76
v_exp_f32 v77, v77
v_exp_f32 v78, v78
v_exp_f32 v79, v79
v_exp_f32 v88, v88
v_exp_f32 v89, v89
v_exp_f32 v90, v90
v_exp_f32 v91, v91
v_cvt_pk_bf16_f32 v96, v72, v73
v_cvt_pk_bf16_f32 v97, v74, v75
v_cvt_pk_bf16_f32 v98, v84, v85
v_cvt_pk_bf16_f32 v99, v86, v87
v_exp_f32 v80, v80
v_exp_f32 v81, v81
v_exp_f32 v82, v82
v_exp_f32 v83, v83
v_exp_f32 v92, v92
v_exp_f32 v93, v93
v_exp_f32 v94, v94
v_exp_f32 v95, v95
v_cvt_pk_bf16_f32 v100, v76, v77
v_cvt_pk_bf16_f32 v101, v78, v79
v_cvt_pk_bf16_f32 v102, v88, v89
v_cvt_pk_bf16_f32 v103, v90, v91
v_cvt_pk_bf16_f32 v104, v80, v81
v_cvt_pk_bf16_f32 v105, v82, v83
v_cvt_pk_bf16_f32 v106, v92, v93
v_cvt_pk_bf16_f32 v107, v94, v95
s_waitcnt lgkmcnt(0)
v_mfma_f32_16x16x32_bf16 v[120:123], a[128:131], v[96:99], v[120:123]
v_add_f32 v31, v31, v72
v_mfma_f32_16x16x32_bf16 v[124:127], a[128:131], v[100:103], v[124:127]
v_add_f32 v33, v33, v76
v_mfma_f32_16x16x32_bf16 v[128:131], a[128:131], v[104:107], v[128:131]
v_add_f32 v35, v35, v80
v_mfma_f32_16x16x32_bf16 v[132:135], a[132:135], v[96:99], v[132:135]
v_add_f32 v31, v31, v73
v_mfma_f32_16x16x32_bf16 v[136:139], a[132:135], v[100:103], v[136:139]
v_add_f32 v33, v33, v77
v_mfma_f32_16x16x32_bf16 v[140:143], a[132:135], v[104:107], v[140:143]
v_add_f32 v35, v35, v81
v_mfma_f32_16x16x32_bf16 v[144:147], a[136:139], v[96:99], v[144:147]
v_add_f32 v31, v31, v74
v_mfma_f32_16x16x32_bf16 v[148:151], a[136:139], v[100:103], v[148:151]
v_add_f32 v33, v33, v78
v_mfma_f32_16x16x32_bf16 v[152:155], a[136:139], v[104:107], v[152:155]
v_add_f32 v35, v35, v82
v_mfma_f32_16x16x32_bf16 v[156:159], a[140:143], v[96:99], v[156:159]
v_add_f32 v31, v31, v75
v_mfma_f32_16x16x32_bf16 v[160:163], a[140:143], v[100:103], v[160:163]
v_add_f32 v33, v33, v79
v_mfma_f32_16x16x32_bf16 v[164:167], a[140:143], v[104:107], v[164:167]
v_add_f32 v35, v35, v83
v_mfma_f32_16x16x32_bf16 v[168:171], a[144:147], v[96:99], v[168:171]
v_add_f32 v31, v31, v84
v_mfma_f32_16x16x32_bf16 v[172:175], a[144:147], v[100:103], v[172:175]
v_add_f32 v33, v33, v88
v_mfma_f32_16x16x32_bf16 v[176:179], a[144:147], v[104:107], v[176:179]
v_add_f32 v35, v35, v92
v_mfma_f32_16x16x32_bf16 v[180:183], a[148:151], v[96:99], v[180:183]
v_add_f32 v31, v31, v85
v_mfma_f32_16x16x32_bf16 v[184:187], a[148:151], v[100:103], v[184:187]
v_add_f32 v33, v33, v89
v_mfma_f32_16x16x32_bf16 v[188:191], a[148:151], v[104:107], v[188:191]
v_add_f32 v35, v35, v93
v_mfma_f32_16x16x32_bf16 v[192:195], a[152:155], v[96:99], v[192:195]
v_add_f32 v31, v31, v86
v_mfma_f32_16x16x32_bf16 v[196:199], a[152:155], v[100:103], v[196:199]
v_add_f32 v33, v33, v90
v_mfma_f32_16x16x32_bf16 v[200:203], a[152:155], v[104:107], v[200:203]
v_add_f32 v35, v35, v94
v_mfma_f32_16x16x32_bf16 v[204:207], a[156:159], v[96:99], v[204:207]
v_add_f32 v31, v31, v87
v_mfma_f32_16x16x32_bf16 v[208:211], a[156:159], v[100:103], v[208:211]
v_add_f32 v33, v33, v91
v_mfma_f32_16x16x32_bf16 v[212:215], a[156:159], v[104:107], v[212:215]
v_add_f32 v35, v35, v95
v_mov_b32 v44, v31
v_mov_b32 v45, v33
v_mov_b32 v46, v35
s_nop 0
v_permlane32_swap_b32 v31, v44
v_permlane32_swap_b32 v33, v45
v_permlane32_swap_b32 v35, v46
s_nop 0
v_add_f32 v31, v31, v44
v_add_f32 v33, v33, v45
v_add_f32 v35, v35, v46
v_mov_b32 v44, v31
v_mov_b32 v45, v33
v_mov_b32 v46, v35
s_nop 0
v_permlane16_swap_b32 v31, v44
v_permlane16_swap_b32 v33, v45
v_permlane16_swap_b32 v35, v46
s_nop 0
v_add_f32 v31, v31, v44
v_add_f32 v33, v33, v45
v_add_f32 v35, v35, v46
v_and_b32 v36, 15, v0
v_lshlrev_b32 v36, 3, v36
s_lshl_b32 s79, s76, 13
s_add_u32 s79, s79, 137216
v_add_u32 v37, s79, v36
ds_write_b64 v37, v[30:31] offset:0
ds_write_b64 v37, v[32:33] offset:128
ds_write_b64 v37, v[34:35] offset:256
s_waitcnt lgkmcnt(0)
s_barrier
v_and_b32 v36, 15, v0
v_lshlrev_b32 v36, 3, v36
s_sub_u32 s79, s76, 0
s_and_b32 s79, s79, 3
s_lshl_b32 s79, s79, 13
s_add_u32 s79, s79, 137216
v_add_u32 v37, s79, v36
s_sub_u32 s79, s76, 1
s_and_b32 s79, s79, 3
s_lshl_b32 s79, s79, 13
s_add_u32 s79, s79, 137216
v_add_u32 v38, s79, v36
s_sub_u32 s79, s76, 2
s_and_b32 s79, s79, 3
s_lshl_b32 s79, s79, 13
s_add_u32 s79, s79, 137216
v_add_u32 v39, s79, v36
s_sub_u32 s79, s76, 3
s_and_b32 s79, s79, 3
s_lshl_b32 s79, s79, 13
s_add_u32 s79, s79, 137216
v_add_u32 v40, s79, v36
ds_read_b64 v[48:49], v37 offset:0
ds_read_b64 v[50:51], v37 offset:128
ds_read_b64 v[52:53], v37 offset:256
ds_read_b64 v[54:55], v38 offset:0
ds_read_b64 v[56:57], v38 offset:128
ds_read_b64 v[58:59], v38 offset:256
ds_read_b64 v[60:61], v39 offset:0
ds_read_b64 v[62:63], v39 offset:128
ds_read_b64 v[64:65], v39 offset:256
ds_read_b64 v[66:67], v40 offset:0
ds_read_b64 v[68:69], v40 offset:128
ds_read_b64 v[70:71], v40 offset:256
s_add_u32 s79, s76, 1
s_and_b32 s79, s79, 3
s_lshl_b32 s79, s79, 15
v_add_u32 v42, s79, v220
s_add_u32 s79, s76, 2
s_and_b32 s79, s79, 3
s_lshl_b32 s79, s79, 15
v_add_u32 v43, s79, v220
s_add_u32 s79, s76, 3
s_and_b32 s79, s79, 3
s_lshl_b32 s79, s79, 13
s_add_u32 s79, s79, 131072
v_add_u32 v44, s79, v220
ds_write_b128 v42, v[144:147] offset:0
ds_write_b128 v42, v[148:151] offset:1024
ds_write_b128 v42, v[152:155] offset:2048
ds_write_b128 v42, v[156:159] offset:3072
ds_write_b128 v42, v[160:163] offset:4096
ds_write_b128 v42, v[164:167] offset:5120
ds_write_b128 v43, v[168:171] offset:8192
ds_write_b128 v43, v[172:175] offset:9216
ds_write_b128 v43, v[176:179] offset:10240
ds_write_b128 v43, v[180:183] offset:11264
ds_write_b128 v43, v[184:187] offset:12288
ds_write_b128 v43, v[188:191] offset:13312
ds_write_b128 v44, v[192:195] offset:0
ds_write_b128 v44, v[196:199] offset:1024
ds_write_b128 v44, v[200:203] offset:2048
ds_write_b128 v44, v[204:207] offset:3072
ds_write_b128 v44, v[208:211] offset:4096
ds_write_b128 v44, v[212:215] offset:5120
s_waitcnt lgkmcnt(15)
v_max3_f32 v36, v48, v54, v60
v_max_f32 v36, v36, v66
v_sub_f32 v48, v48, v36
v_sub_f32 v54, v54, v36
v_sub_f32 v60, v60, v36
v_sub_f32 v66, v66, v36
v_exp_f32 v48, v48
v_exp_f32 v54, v54
v_exp_f32 v60, v60
v_exp_f32 v66, v66
s_nop 0
v_mul_f32 v37, v48, v49
v_fma_f32 v37, v54, v55, v37
v_fma_f32 v37, v60, v61, v37
v_fma_f32 v37, v66, v67, v37
v_rcp_f32 v37, v37
s_nop 0
v_mul_f32 v1, v48, v37
v_mul_f32 v4, v54, v37
v_mul_f32 v7, v60, v37
v_mul_f32 v10, v66, v37
v_max3_f32 v36, v50, v56, v62
v_max_f32 v36, v36, v68
v_sub_f32 v50, v50, v36
v_sub_f32 v56, v56, v36
v_sub_f32 v62, v62, v36
v_sub_f32 v68, v68, v36
v_exp_f32 v50, v50
v_exp_f32 v56, v56
v_exp_f32 v62, v62
v_exp_f32 v68, v68
s_nop 0
v_mul_f32 v37, v50, v51
v_fma_f32 v37, v56, v57, v37
v_fma_f32 v37, v62, v63, v37
v_fma_f32 v37, v68, v69, v37
v_rcp_f32 v37, v37
s_nop 0
v_mul_f32 v2, v50, v37
v_mul_f32 v5, v56, v37
v_mul_f32 v8, v62, v37
v_mul_f32 v11, v68, v37
v_max3_f32 v36, v52, v58, v64
v_max_f32 v36, v36, v70
v_sub_f32 v52, v52, v36
v_sub_f32 v58, v58, v36
v_sub_f32 v64, v64, v36
v_sub_f32 v70, v70, v36
v_exp_f32 v52, v52
v_exp_f32 v58, v58
v_exp_f32 v64, v64
v_exp_f32 v70, v70
s_nop 0
v_mul_f32 v37, v52, v53
v_fma_f32 v37, v58, v59, v37
v_fma_f32 v37, v64, v65, v37
v_fma_f32 v37, v70, v71, v37
v_rcp_f32 v37, v37
s_nop 0
v_mul_f32 v3, v52, v37
v_mul_f32 v6, v58, v37
v_mul_f32 v9, v64, v37
v_mul_f32 v12, v70, v37
v_add_u32 v38, s77, v220
s_lshl_b32 s79, s76, 13
s_add_u32 s79, s79, 131072
v_add_u32 v39, s79, v220
s_waitcnt lgkmcnt(0)
s_barrier
ds_read_b128 v[48:51], v38 offset:0
ds_read_b128 v[52:55], v38 offset:1024
ds_read_b128 v[56:59], v38 offset:2048
ds_read_b128 v[60:63], v38 offset:3072
ds_read_b128 v[64:67], v38 offset:4096
ds_read_b128 v[68:71], v38 offset:5120
ds_read_b128 v[72:75], v38 offset:8192
ds_read_b128 v[76:79], v38 offset:9216
ds_read_b128 v[80:83], v38 offset:10240
ds_read_b128 v[84:87], v38 offset:11264
ds_read_b128 v[88:91], v38 offset:12288
ds_read_b128 v[92:95], v38 offset:13312
ds_read_b128 v[96:99], v39 offset:0
ds_read_b128 v[100:103], v39 offset:1024
ds_read_b128 v[104:107], v39 offset:2048
ds_read_b128 v[108:111], v39 offset:3072
ds_read_b128 v[112:115], v39 offset:4096
ds_read_b128 v[116:119], v39 offset:5120
v_add_u32 v40, s79, v220
v_mul_f32 v120, v120, v1
v_mul_f32 v121, v121, v1
v_mul_f32 v122, v122, v1
v_mul_f32 v123, v123, v1
v_mul_f32 v124, v124, v2
v_mul_f32 v125, v125, v2
v_mul_f32 v126, v126, v2
v_mul_f32 v127, v127, v2
v_mul_f32 v128, v128, v3
v_mul_f32 v129, v129, v3
v_mul_f32 v130, v130, v3
v_mul_f32 v131, v131, v3
v_mul_f32 v132, v132, v1
v_mul_f32 v133, v133, v1
v_mul_f32 v134, v134, v1
v_mul_f32 v135, v135, v1
v_mul_f32 v136, v136, v2
v_mul_f32 v137, v137, v2
v_mul_f32 v138, v138, v2
v_mul_f32 v139, v139, v2
v_mul_f32 v140, v140, v3
v_mul_f32 v141, v141, v3
v_mul_f32 v142, v142, v3
v_mul_f32 v143, v143, v3
s_waitcnt lgkmcnt(12)
v_fmac_f32 v120, v48, v4
v_fmac_f32 v121, v49, v4
v_fmac_f32 v122, v50, v4
v_fmac_f32 v123, v51, v4
v_fmac_f32 v124, v52, v5
v_fmac_f32 v125, v53, v5
v_fmac_f32 v126, v54, v5
v_fmac_f32 v127, v55, v5
v_fmac_f32 v128, v56, v6
v_fmac_f32 v129, v57, v6
v_fmac_f32 v130, v58, v6
v_fmac_f32 v131, v59, v6
v_fmac_f32 v132, v60, v4
v_fmac_f32 v133, v61, v4
v_fmac_f32 v134, v62, v4
v_fmac_f32 v135, v63, v4
v_fmac_f32 v136, v64, v5
v_fmac_f32 v137, v65, v5
v_fmac_f32 v138, v66, v5
v_fmac_f32 v139, v67, v5
v_fmac_f32 v140, v68, v6
v_fmac_f32 v141, v69, v6
v_fmac_f32 v142, v70, v6
v_fmac_f32 v143, v71, v6
s_waitcnt lgkmcnt(6)
v_fmac_f32 v120, v72, v7
v_fmac_f32 v121, v73, v7
v_fmac_f32 v122, v74, v7
v_fmac_f32 v123, v75, v7
v_fmac_f32 v124, v76, v8
v_fmac_f32 v125, v77, v8
v_fmac_f32 v126, v78, v8
v_fmac_f32 v127, v79, v8
v_fmac_f32 v128, v80, v9
v_fmac_f32 v129, v81, v9
v_fmac_f32 v130, v82, v9
v_fmac_f32 v131, v83, v9
v_fmac_f32 v132, v84, v7
v_fmac_f32 v133, v85, v7
v_fmac_f32 v134, v86, v7
v_fmac_f32 v135, v87, v7
v_fmac_f32 v136, v88, v8
v_fmac_f32 v137, v89, v8
v_fmac_f32 v138, v90, v8
v_fmac_f32 v139, v91, v8
v_fmac_f32 v140, v92, v9
v_fmac_f32 v141, v93, v9
v_fmac_f32 v142, v94, v9
v_fmac_f32 v143, v95, v9
s_waitcnt lgkmcnt(0)
v_fmac_f32 v120, v96, v10
v_fmac_f32 v121, v97, v10
v_fmac_f32 v122, v98, v10
v_fmac_f32 v123, v99, v10
v_fmac_f32 v124, v100, v11
v_fmac_f32 v125, v101, v11
v_fmac_f32 v126, v102, v11
v_fmac_f32 v127, v103, v11
v_fmac_f32 v128, v104, v12
v_fmac_f32 v129, v105, v12
v_fmac_f32 v130, v106, v12
v_fmac_f32 v131, v107, v12
v_fmac_f32 v132, v108, v10
v_fmac_f32 v133, v109, v10
v_fmac_f32 v134, v110, v10
v_fmac_f32 v135, v111, v10
v_fmac_f32 v136, v112, v11
v_fmac_f32 v137, v113, v11
v_fmac_f32 v138, v114, v11
v_fmac_f32 v139, v115, v11
v_fmac_f32 v140, v116, v12
v_fmac_f32 v141, v117, v12
v_fmac_f32 v142, v118, v12
v_fmac_f32 v143, v119, v12
v_cvt_pk_bf16_f32 v48, v120, v121
v_cvt_pk_bf16_f32 v49, v122, v123
v_cvt_pk_bf16_f32 v50, v124, v125
v_cvt_pk_bf16_f32 v51, v126, v127
v_cvt_pk_bf16_f32 v52, v128, v129
v_cvt_pk_bf16_f32 v53, v130, v131
v_cvt_pk_bf16_f32 v54, v132, v133
v_cvt_pk_bf16_f32 v55, v134, v135
v_cvt_pk_bf16_f32 v56, v136, v137
v_cvt_pk_bf16_f32 v57, v138, v139
v_cvt_pk_bf16_f32 v58, v140, v141
v_cvt_pk_bf16_f32 v59, v142, v143
ds_write_b64 v40, v[48:49] offset:0
ds_write_b64 v40, v[50:51] offset:1024
ds_write_b64 v40, v[52:53] offset:2048
ds_write_b64 v40, v[54:55] offset:8
ds_write_b64 v40, v[56:57] offset:1032
ds_write_b64 v40, v[58:59] offset:2056
s_add_u32 s85, s2, 2
s_and_b32 s85, s85, 3
s_lshl_b32 s85, s85, 15
s_add_u32 s85, s85, s93
s_add_u32 m0, s77, 0
s_add_u32 s94, s85, 0
buffer_load_dwordx4 v218, s[68:71], s94 offen offset:0 lds
s_add_u32 s94, s85, 3072
buffer_load_dwordx4 v219, s[68:71], s94 offen offset:1024 lds
s_add_u32 s94, s85, 6144
buffer_load_dwordx4 v218, s[68:71], s94 offen offset:2048 lds
s_add_u32 s94, s85, 9216
buffer_load_dwordx4 v219, s[68:71], s94 offen offset:3072 lds
s_add_u32 s79, s2, 0
s_and_b32 s79, s79, 3
s_lshl_b32 s79, s79, 13
s_add_u32 s79, s79, 131072
v_add_u32 v41, s79, v220
s_add_u32 s79, s2, 1
s_and_b32 s79, s79, 3
s_lshl_b32 s79, s79, 13
s_add_u32 s79, s79, 131072
v_add_u32 v42, s79, v220
s_add_u32 s79, s2, 2
s_and_b32 s79, s79, 3
s_lshl_b32 s79, s79, 13
s_add_u32 s79, s79, 131072
v_add_u32 v43, s79, v220
s_add_u32 s79, s2, 3
s_and_b32 s79, s79, 3
s_lshl_b32 s79, s79, 13
s_add_u32 s79, s79, 131072
v_add_u32 v44, s79, v220
s_waitcnt lgkmcnt(0)
s_barrier
ds_read_b128 a[48:51], v41 offset:0
ds_read_b128 a[64:67], v41 offset:1024
ds_read_b128 a[80:83], v41 offset:2048
ds_read_b128 a[52:55], v42 offset:0
ds_read_b128 a[68:71], v42 offset:1024
ds_read_b128 a[84:87], v42 offset:2048
ds_read_b128 a[56:59], v43 offset:0
ds_read_b128 a[72:75], v43 offset:1024
ds_read_b128 a[88:91], v43 offset:2048
ds_read_b128 a[60:63], v44 offset:0
ds_read_b128 a[76:79], v44 offset:1024
ds_read_b128 a[92:95], v44 offset:2048
s_add_u32 m0, s77, 4096
s_add_u32 s94, s85, 16384
buffer_load_dwordx4 v218, s[68:71], s94 offen offset:0 lds
s_add_u32 s94, s85, 19456
buffer_load_dwordx4 v219, s[68:71], s94 offen offset:1024 lds
s_add_u32 s94, s85, 22528
buffer_load_dwordx4 v218, s[68:71], s94 offen offset:2048 lds
s_add_u32 s94, s85, 25600
buffer_load_dwordx4 v219, s[68:71], s94 offen offset:3072 lds
s_waitcnt lgkmcnt(0)
v_accvgpr_read_b32 v120, a160
v_accvgpr_read_b32 v121, a161
v_accvgpr_read_b32 v122, a162
v_accvgpr_read_b32 v123, a163
v_accvgpr_read_b32 v124, a164
v_accvgpr_read_b32 v125, a165
v_accvgpr_read_b32 v126, a166
v_accvgpr_read_b32 v127, a167
v_accvgpr_read_b32 v128, a168
v_accvgpr_read_b32 v129, a169
v_accvgpr_read_b32 v130, a170
v_accvgpr_read_b32 v131, a171
v_accvgpr_read_b32 v132, a172
v_accvgpr_read_b32 v133, a173
v_accvgpr_read_b32 v134, a174
v_accvgpr_read_b32 v135, a175
v_accvgpr_read_b32 v136, a176
v_accvgpr_read_b32 v137, a177
v_accvgpr_read_b32 v138, a178
v_accvgpr_read_b32 v139, a179
v_accvgpr_read_b32 v140, a180
v_accvgpr_read_b32 v141, a181
v_accvgpr_read_b32 v142, a182
v_accvgpr_read_b32 v143, a183
v_accvgpr_read_b32 v144, a184
v_accvgpr_read_b32 v145, a185
v_accvgpr_read_b32 v146, a186
v_accvgpr_read_b32 v147, a187
v_accvgpr_read_b32 v148, a188
v_accvgpr_read_b32 v149, a189
v_accvgpr_read_b32 v150, a190
v_accvgpr_read_b32 v151, a191
v_accvgpr_read_b32 v152, a192
v_accvgpr_read_b32 v153, a193
v_accvgpr_read_b32 v154, a194
v_accvgpr_read_b32 v155, a195
v_accvgpr_read_b32 v156, a196
v_accvgpr_read_b32 v157, a197
v_accvgpr_read_b32 v158, a198
v_accvgpr_read_b32 v159, a199
v_accvgpr_read_b32 v160, a200
v_accvgpr_read_b32 v161, a201
v_accvgpr_read_b32 v162, a202
v_accvgpr_read_b32 v163, a203
v_accvgpr_read_b32 v164, a204
v_accvgpr_read_b32 v165, a205
v_accvgpr_read_b32 v166, a206
v_accvgpr_read_b32 v167, a207
v_accvgpr_read_b32 v168, a208
v_accvgpr_read_b32 v169, a209
v_accvgpr_read_b32 v170, a210
v_accvgpr_read_b32 v171, a211
v_accvgpr_read_b32 v172, a212
v_accvgpr_read_b32 v173, a213
v_accvgpr_read_b32 v174, a214
v_accvgpr_read_b32 v175, a215
v_accvgpr_read_b32 v176, a216
v_accvgpr_read_b32 v177, a217
v_accvgpr_read_b32 v178, a218
v_accvgpr_read_b32 v179, a219
v_accvgpr_read_b32 v180, a220
v_accvgpr_read_b32 v181, a221
v_accvgpr_read_b32 v182, a222
v_accvgpr_read_b32 v183, a223
v_accvgpr_read_b32 v184, a224
v_accvgpr_read_b32 v185, a225
v_accvgpr_read_b32 v186, a226
v_accvgpr_read_b32 v187, a227
v_accvgpr_read_b32 v188, a228
v_accvgpr_read_b32 v189, a229
v_accvgpr_read_b32 v190, a230
v_accvgpr_read_b32 v191, a231
v_accvgpr_read_b32 v192, a232
v_accvgpr_read_b32 v193, a233
v_accvgpr_read_b32 v194, a234
v_accvgpr_read_b32 v195, a235
v_accvgpr_read_b32 v196, a236
v_accvgpr_read_b32 v197, a237
v_accvgpr_read_b32 v198, a238
v_accvgpr_read_b32 v199, a239
v_accvgpr_read_b32 v200, a240
v_accvgpr_read_b32 v201, a241
v_accvgpr_read_b32 v202, a242
v_accvgpr_read_b32 v203, a243
v_accvgpr_read_b32 v204, a244
v_accvgpr_read_b32 v205, a245
v_accvgpr_read_b32 v206, a246
v_accvgpr_read_b32 v207, a247
v_accvgpr_read_b32 v208, a248
v_accvgpr_read_b32 v209, a249
v_accvgpr_read_b32 v210, a250
v_accvgpr_read_b32 v211, a251
v_accvgpr_read_b32 v212, a252
v_accvgpr_read_b32 v213, a253
v_accvgpr_read_b32 v214, a254
v_accvgpr_read_b32 v215, a255
ds_read_b64_tr_b16 a[128:129], v16 offset:16384
ds_read_b64_tr_b16 a[130:131], v16 offset:20480
ds_read_b64_tr_b16 a[132:133], v17 offset:16384
ds_read_b64_tr_b16 a[134:135], v17 offset:20480
ds_read_b64_tr_b16 a[136:137], v18 offset:16384
ds_read_b64_tr_b16 a[138:139], v18 offset:20480
ds_read_b64_tr_b16 a[140:141], v19 offset:16384
ds_read_b64_tr_b16 a[142:143], v19 offset:20480
ds_read_b64_tr_b16 a[144:145], v20 offset:16384
ds_read_b64_tr_b16 a[146:147], v20 offset:20480
ds_read_b64_tr_b16 a[148:149], v21 offset:16384
ds_read_b64_tr_b16 a[150:151], v21 offset:20480
ds_read_b64_tr_b16 a[152:153], v22 offset:16384
ds_read_b64_tr_b16 a[154:155], v22 offset:20480
ds_read_b64_tr_b16 a[156:157], v23 offset:16384
ds_read_b64_tr_b16 a[158:159], v23 offset:20480
s_waitcnt lgkmcnt(0)
v_mfma_f32_16x16x32_bf16 v[120:123], a[128:131], a[48:51], v[120:123]
v_mfma_f32_16x16x32_bf16 v[124:127], a[128:131], a[64:67], v[124:127]
v_mfma_f32_16x16x32_bf16 v[128:131], a[128:131], a[80:83], v[128:131]
s_add_u32 s85, s2, 3
s_and_b32 s85, s85, 3
s_lshl_b32 s85, s85, 15
s_add_u32 s85, s85, s93
s_add_u32 m0, s77, 8192
s_add_u32 s94, s85, 0
buffer_load_dwordx4 v218, s[68:71], s94 offen offset:0 lds
v_mfma_f32_16x16x32_bf16 v[132:135], a[132:135], a[48:51], v[132:135]
v_mfma_f32_16x16x32_bf16 v[136:139], a[132:135], a[64:67], v[136:139]
v_mfma_f32_16x16x32_bf16 v[140:143], a[132:135], a[80:83], v[140:143]
s_add_u32 s94, s85, 3072
buffer_load_dwordx4 v219, s[68:71], s94 offen offset:1024 lds
v_mfma_f32_16x16x32_bf16 v[144:147], a[136:139], a[48:51], v[144:147]
v_mfma_f32_16x16x32_bf16 v[148:151], a[136:139], a[64:67], v[148:151]
v_mfma_f32_16x16x32_bf16 v[152:155], a[136:139], a[80:83], v[152:155]
s_add_u32 s94, s85, 6144
buffer_load_dwordx4 v218, s[68:71], s94 offen offset:2048 lds
s_waitcnt vmcnt(11)
ds_read_b64_tr_b16 a[96:97], v16 offset:24576
ds_read_b64_tr_b16 a[98:99], v16 offset:28672
ds_read_b64_tr_b16 a[100:101], v17 offset:24576
ds_read_b64_tr_b16 a[102:103], v17 offset:28672
ds_read_b64_tr_b16 a[104:105], v18 offset:24576
ds_read_b64_tr_b16 a[106:107], v18 offset:28672
ds_read_b64_tr_b16 a[108:109], v19 offset:24576
ds_read_b64_tr_b16 a[110:111], v19 offset:28672
ds_read_b64_tr_b16 a[112:113], v20 offset:24576
ds_read_b64_tr_b16 a[114:115], v20 offset:28672
ds_read_b64_tr_b16 a[116:117], v21 offset:24576
ds_read_b64_tr_b16 a[118:119], v21 offset:28672
ds_read_b64_tr_b16 a[120:121], v22 offset:24576
ds_read_b64_tr_b16 a[122:123], v22 offset:28672
ds_read_b64_tr_b16 a[124:125], v23 offset:24576
ds_read_b64_tr_b16 a[126:127], v23 offset:28672
v_mfma_f32_16x16x32_bf16 v[156:159], a[140:143], a[48:51], v[156:159]
v_mfma_f32_16x16x32_bf16 v[160:163], a[140:143], a[64:67], v[160:163]
v_mfma_f32_16x16x32_bf16 v[164:167], a[140:143], a[80:83], v[164:167]
s_add_u32 s94, s85, 9216
buffer_load_dwordx4 v219, s[68:71], s94 offen offset:3072 lds
v_mfma_f32_16x16x32_bf16 v[168:171], a[144:147], a[48:51], v[168:171]
v_mfma_f32_16x16x32_bf16 v[172:175], a[144:147], a[64:67], v[172:175]
v_mfma_f32_16x16x32_bf16 v[176:179], a[144:147], a[80:83], v[176:179]
s_add_u32 m0, s77, 12288
s_add_u32 s94, s85, 16384
buffer_load_dwordx4 v218, s[68:71], s94 offen offset:0 lds
v_mfma_f32_16x16x32_bf16 v[180:183], a[148:151], a[48:51], v[180:183]
v_mfma_f32_16x16x32_bf16 v[184:187], a[148:151], a[64:67], v[184:187]
v_mfma_f32_16x16x32_bf16 v[188:191], a[148:151], a[80:83], v[188:191]
s_add_u32 s94, s85, 19456
buffer_load_dwordx4 v219, s[68:71], s94 offen offset:1024 lds
v_mfma_f32_16x16x32_bf16 v[192:195], a[152:155], a[48:51], v[192:195]
v_mfma_f32_16x16x32_bf16 v[196:199], a[152:155], a[64:67], v[196:199]
v_mfma_f32_16x16x32_bf16 v[200:203], a[152:155], a[80:83], v[200:203]
s_add_u32 s94, s85, 22528
buffer_load_dwordx4 v218, s[68:71], s94 offen offset:2048 lds
v_mfma_f32_16x16x32_bf16 v[204:207], a[156:159], a[48:51], v[204:207]
v_mfma_f32_16x16x32_bf16 v[208:211], a[156:159], a[64:67], v[208:211]
v_mfma_f32_16x16x32_bf16 v[212:215], a[156:159], a[80:83], v[212:215]
s_add_u32 s94, s85, 25600
buffer_load_dwordx4 v219, s[68:71], s94 offen offset:3072 lds
s_waitcnt lgkmcnt(0)
v_mfma_f32_16x16x32_bf16 v[120:123], a[96:99], a[52:55], v[120:123]
v_mfma_f32_16x16x32_bf16 v[124:127], a[96:99], a[68:71], v[124:127]
v_mfma_f32_16x16x32_bf16 v[128:131], a[96:99], a[84:87], v[128:131]
v_mfma_f32_16x16x32_bf16 v[132:135], a[100:103], a[52:55], v[132:135]
v_mfma_f32_16x16x32_bf16 v[136:139], a[100:103], a[68:71], v[136:139]
v_mfma_f32_16x16x32_bf16 v[140:143], a[100:103], a[84:87], v[140:143]
v_mfma_f32_16x16x32_bf16 v[144:147], a[104:107], a[52:55], v[144:147]
v_mfma_f32_16x16x32_bf16 v[148:151], a[104:107], a[68:71], v[148:151]
v_mfma_f32_16x16x32_bf16 v[152:155], a[104:107], a[84:87], v[152:155]
s_waitcnt vmcnt(8)
ds_read_b64_tr_b16 a[128:129], v16 offset:0
ds_read_b64_tr_b16 a[130:131], v16 offset:4096
ds_read_b64_tr_b16 a[132:133], v17 offset:0
ds_read_b64_tr_b16 a[134:135], v17 offset:4096
ds_read_b64_tr_b16 a[136:137], v18 offset:0
ds_read_b64_tr_b16 a[138:139], v18 offset:4096
ds_read_b64_tr_b16 a[140:141], v19 offset:0
ds_read_b64_tr_b16 a[142:143], v19 offset:4096
ds_read_b64_tr_b16 a[144:145], v20 offset:0
ds_read_b64_tr_b16 a[146:147], v20 offset:4096
ds_read_b64_tr_b16 a[148:149], v21 offset:0
ds_read_b64_tr_b16 a[150:151], v21 offset:4096
ds_read_b64_tr_b16 a[152:153], v22 offset:0
ds_read_b64_tr_b16 a[154:155], v22 offset:4096
ds_read_b64_tr_b16 a[156:157], v23 offset:0
ds_read_b64_tr_b16 a[158:159], v23 offset:4096
v_mfma_f32_16x16x32_bf16 v[156:159], a[108:111], a[52:55], v[156:159]
v_mfma_f32_16x16x32_bf16 v[160:163], a[108:111], a[68:71], v[160:163]
v_mfma_f32_16x16x32_bf16 v[164:167], a[108:111], a[84:87], v[164:167]
v_mfma_f32_16x16x32_bf16 v[168:171], a[112:115], a[52:55], v[168:171]
v_mfma_f32_16x16x32_bf16 v[172:175], a[112:115], a[68:71], v[172:175]
v_mfma_f32_16x16x32_bf16 v[176:179], a[112:115], a[84:87], v[176:179]
v_mfma_f32_16x16x32_bf16 v[180:183], a[116:119], a[52:55], v[180:183]
v_mfma_f32_16x16x32_bf16 v[184:187], a[116:119], a[68:71], v[184:187]
v_mfma_f32_16x16x32_bf16 v[188:191], a[116:119], a[84:87], v[188:191]
v_mfma_f32_16x16x32_bf16 v[192:195], a[120:123], a[52:55], v[192:195]
v_mfma_f32_16x16x32_bf16 v[196:199], a[120:123], a[68:71], v[196:199]
v_mfma_f32_16x16x32_bf16 v[200:203], a[120:123], a[84:87], v[200:203]
v_mfma_f32_16x16x32_bf16 v[204:207], a[124:127], a[52:55], v[204:207]
v_mfma_f32_16x16x32_bf16 v[208:211], a[124:127], a[68:71], v[208:211]
v_mfma_f32_16x16x32_bf16 v[212:215], a[124:127], a[84:87], v[212:215]
s_waitcnt lgkmcnt(0)
v_mfma_f32_16x16x32_bf16 v[120:123], a[128:131], a[56:59], v[120:123]
v_mfma_f32_16x16x32_bf16 v[124:127], a[128:131], a[72:75], v[124:127]
v_mfma_f32_16x16x32_bf16 v[128:131], a[128:131], a[88:91], v[128:131]
v_mfma_f32_16x16x32_bf16 v[132:135], a[132:135], a[56:59], v[132:135]
v_mfma_f32_16x16x32_bf16 v[136:139], a[132:135], a[72:75], v[136:139]
v_mfma_f32_16x16x32_bf16 v[140:143], a[132:135], a[88:91], v[140:143]
v_mfma_f32_16x16x32_bf16 v[144:147], a[136:139], a[56:59], v[144:147]
v_mfma_f32_16x16x32_bf16 v[148:151], a[136:139], a[72:75], v[148:151]
v_mfma_f32_16x16x32_bf16 v[152:155], a[136:139], a[88:91], v[152:155]
s_waitcnt vmcnt(0)
ds_read_b64_tr_b16 a[96:97], v16 offset:8192
ds_read_b64_tr_b16 a[98:99], v16 offset:12288
ds_read_b64_tr_b16 a[100:101], v17 offset:8192
ds_read_b64_tr_b16 a[102:103], v17 offset:12288
ds_read_b64_tr_b16 a[104:105], v18 offset:8192
ds_read_b64_tr_b16 a[106:107], v18 offset:12288
ds_read_b64_tr_b16 a[108:109], v19 offset:8192
ds_read_b64_tr_b16 a[110:111], v19 offset:12288
ds_read_b64_tr_b16 a[112:113], v20 offset:8192
ds_read_b64_tr_b16 a[114:115], v20 offset:12288
ds_read_b64_tr_b16 a[116:117], v21 offset:8192
ds_read_b64_tr_b16 a[118:119], v21 offset:12288
ds_read_b64_tr_b16 a[120:121], v22 offset:8192
ds_read_b64_tr_b16 a[122:123], v22 offset:12288
ds_read_b64_tr_b16 a[124:125], v23 offset:8192
ds_read_b64_tr_b16 a[126:127], v23 offset:12288
v_mfma_f32_16x16x32_bf16 v[156:159], a[140:143], a[56:59], v[156:159]
v_mfma_f32_16x16x32_bf16 v[160:163], a[140:143], a[72:75], v[160:163]
v_mfma_f32_16x16x32_bf16 v[164:167], a[140:143], a[88:91], v[164:167]
v_mfma_f32_16x16x32_bf16 v[168:171], a[144:147], a[56:59], v[168:171]
v_mfma_f32_16x16x32_bf16 v[172:175], a[144:147], a[72:75], v[172:175]
v_mfma_f32_16x16x32_bf16 v[176:179], a[144:147], a[88:91], v[176:179]
v_mfma_f32_16x16x32_bf16 v[180:183], a[148:151], a[56:59], v[180:183]
v_mfma_f32_16x16x32_bf16 v[184:187], a[148:151], a[72:75], v[184:187]
v_mfma_f32_16x16x32_bf16 v[188:191], a[148:151], a[88:91], v[188:191]
v_mfma_f32_16x16x32_bf16 v[192:195], a[152:155], a[56:59], v[192:195]
v_mfma_f32_16x16x32_bf16 v[196:199], a[152:155], a[72:75], v[196:199]
v_mfma_f32_16x16x32_bf16 v[200:203], a[152:155], a[88:91], v[200:203]
v_mfma_f32_16x16x32_bf16 v[204:207], a[156:159], a[56:59], v[204:207]
v_mfma_f32_16x16x32_bf16 v[208:211], a[156:159], a[72:75], v[208:211]
v_mfma_f32_16x16x32_bf16 v[212:215], a[156:159], a[88:91], v[212:215]
s_waitcnt lgkmcnt(0)
v_mfma_f32_16x16x32_bf16 v[120:123], a[96:99], a[60:63], v[120:123]
v_mfma_f32_16x16x32_bf16 v[124:127], a[96:99], a[76:79], v[124:127]
v_mfma_f32_16x16x32_bf16 v[128:131], a[96:99], a[92:95], v[128:131]
v_mfma_f32_16x16x32_bf16 v[132:135], a[100:103], a[60:63], v[132:135]
v_mfma_f32_16x16x32_bf16 v[136:139], a[100:103], a[76:79], v[136:139]
v_mfma_f32_16x16x32_bf16 v[140:143], a[100:103], a[92:95], v[140:143]
v_mfma_f32_16x16x32_bf16 v[144:147], a[104:107], a[60:63], v[144:147]
v_mfma_f32_16x16x32_bf16 v[148:151], a[104:107], a[76:79], v[148:151]
v_mfma_f32_16x16x32_bf16 v[152:155], a[104:107], a[92:95], v[152:155]
v_mfma_f32_16x16x32_bf16 v[156:159], a[108:111], a[60:63], v[156:159]
v_mfma_f32_16x16x32_bf16 v[160:163], a[108:111], a[76:79], v[160:163]
v_mfma_f32_16x16x32_bf16 v[164:167], a[108:111], a[92:95], v[164:167]
v_mfma_f32_16x16x32_bf16 v[168:171], a[112:115], a[60:63], v[168:171]
v_mfma_f32_16x16x32_bf16 v[172:175], a[112:115], a[76:79], v[172:175]
v_mfma_f32_16x16x32_bf16 v[176:179], a[112:115], a[92:95], v[176:179]
v_mfma_f32_16x16x32_bf16 v[180:183], a[116:119], a[60:63], v[180:183]
v_mfma_f32_16x16x32_bf16 v[184:187], a[116:119], a[76:79], v[184:187]
v_mfma_f32_16x16x32_bf16 v[188:191], a[116:119], a[92:95], v[188:191]
v_mfma_f32_16x16x32_bf16 v[192:195], a[120:123], a[60:63], v[192:195]
v_mfma_f32_16x16x32_bf16 v[196:199], a[120:123], a[76:79], v[196:199]
v_mfma_f32_16x16x32_bf16 v[200:203], a[120:123], a[92:95], v[200:203]
v_mfma_f32_16x16x32_bf16 v[204:207], a[124:127], a[60:63], v[204:207]
v_mfma_f32_16x16x32_bf16 v[208:211], a[124:127], a[76:79], v[208:211]
v_mfma_f32_16x16x32_bf16 v[212:215], a[124:127], a[92:95], v[212:215]
s_nop 7
v_cvt_pk_bf16_f32 v48, v120, v121
v_cvt_pk_bf16_f32 v49, v122, v123
v_cvt_pk_bf16_f32 v50, v132, v133
v_cvt_pk_bf16_f32 v51, v134, v135
v_cvt_pk_bf16_f32 v52, v144, v145
v_cvt_pk_bf16_f32 v53, v146, v147
v_cvt_pk_bf16_f32 v54, v156, v157
v_cvt_pk_bf16_f32 v55, v158, v159
v_cvt_pk_bf16_f32 v56, v168, v169
v_cvt_pk_bf16_f32 v57, v170, v171
v_cvt_pk_bf16_f32 v58, v180, v181
v_cvt_pk_bf16_f32 v59, v182, v183
v_cvt_pk_bf16_f32 v60, v192, v193
v_cvt_pk_bf16_f32 v61, v194, v195
v_cvt_pk_bf16_f32 v62, v204, v205
v_cvt_pk_bf16_f32 v63, v206, v207
v_cvt_pk_bf16_f32 v64, v124, v125
v_cvt_pk_bf16_f32 v65, v126, v127
v_cvt_pk_bf16_f32 v66, v136, v137
v_cvt_pk_bf16_f32 v67, v138, v139
v_cvt_pk_bf16_f32 v68, v148, v149
v_cvt_pk_bf16_f32 v69, v150, v151
v_cvt_pk_bf16_f32 v70, v160, v161
v_cvt_pk_bf16_f32 v71, v162, v163
v_cvt_pk_bf16_f32 v72, v172, v173
v_cvt_pk_bf16_f32 v73, v174, v175
v_cvt_pk_bf16_f32 v74, v184, v185
v_cvt_pk_bf16_f32 v75, v186, v187
v_cvt_pk_bf16_f32 v76, v196, v197
v_cvt_pk_bf16_f32 v77, v198, v199
v_cvt_pk_bf16_f32 v78, v208, v209
v_cvt_pk_bf16_f32 v79, v210, v211
v_cvt_pk_bf16_f32 v80, v128, v129
v_cvt_pk_bf16_f32 v81, v130, v131
v_cvt_pk_bf16_f32 v82, v140, v141
v_cvt_pk_bf16_f32 v83, v142, v143
v_cvt_pk_bf16_f32 v84, v152, v153
v_cvt_pk_bf16_f32 v85, v154, v155
v_cvt_pk_bf16_f32 v86, v164, v165
v_cvt_pk_bf16_f32 v87, v166, v167
v_cvt_pk_bf16_f32 v88, v176, v177
v_cvt_pk_bf16_f32 v89, v178, v179
v_cvt_pk_bf16_f32 v90, v188, v189
v_cvt_pk_bf16_f32 v91, v190, v191
v_cvt_pk_bf16_f32 v92, v200, v201
v_cvt_pk_bf16_f32 v93, v202, v203
v_cvt_pk_bf16_f32 v94, v212, v213
v_cvt_pk_bf16_f32 v95, v214, v215
s_mov_b32 s95, 0
buffer_store_dwordx4 v[48:51], v222, s[72:75], s95 offen offset:0 sc1
buffer_store_dwordx4 v[52:55], v222, s[72:75], s95 offen offset:1024 sc1
buffer_store_dwordx4 v[56:59], v222, s[72:75], s95 offen offset:2048 sc1
buffer_store_dwordx4 v[60:63], v222, s[72:75], s95 offen offset:3072 sc1
s_mov_b32 s95, 4096
buffer_store_dwordx4 v[64:67], v222, s[72:75], s95 offen offset:0 sc1
buffer_store_dwordx4 v[68:71], v222, s[72:75], s95 offen offset:1024 sc1
buffer_store_dwordx4 v[72:75], v222, s[72:75], s95 offen offset:2048 sc1
buffer_store_dwordx4 v[76:79], v222, s[72:75], s95 offen offset:3072 sc1
s_mov_b32 s95, 8192
buffer_store_dwordx4 v[80:83], v222, s[72:75], s95 offen offset:0 sc1
buffer_store_dwordx4 v[84:87], v222, s[72:75], s95 offen offset:1024 sc1
buffer_store_dwordx4 v[88:91], v222, s[72:75], s95 offen offset:2048 sc1
buffer_store_dwordx4 v[92:95], v222, s[72:75], s95 offen offset:3072 sc1
L_final:
s_load_dwordx4 s[28:31], s[0:1], 80
s_load_dwordx2 s[32:33], s[0:1], 96
s_lshl_b32 s79, s76, 6
v_add_u32 v1, s79, v0
s_bfe_u32 s80, s9, 0x50002
s_mul_i32 s80, s80, 192
v_add_u32 v3, s80, v1
v_lshlrev_b32 v2, 4, v3
v_lshrrev_b32 v5, 8, v3
v_mul_u32_u24 v5, 21846, v5
v_lshrrev_b32 v5, 16, v5
v_mul_u32_u24 v6, 768, v5
v_sub_u32 v6, v3, v6
v_lshrrev_b32 v7, 6, v6
v_and_b32 v8, 63, v6
v_lshrrev_b32 v9, 2, v7
v_and_b32 v10, 3, v7
v_add_u32 v11, v5, v10
v_lshlrev_b32 v11, 1, v11
v_and_b32 v12, 15, v8
v_lshl_add_u32 v12, v9, 4, v12
v_lshlrev_b32 v12, 11, v12
v_lshl_add_u32 v12, v5, 8, v12
v_lshrrev_b32 v13, 4, v8
v_lshl_add_u32 v12, v13, 3, v12
v_and_b32 v13, 7, v11
v_lshl_add_u32 v13, v13, 5, v12
v_add_u32 v11, 1, v11
v_and_b32 v11, 7, v11
v_lshl_add_u32 v14, v11, 5, v12
s_waitcnt lgkmcnt(0)
s_mov_b32 s40, s30
s_mov_b32 s41, s31
s_mov_b32 s42, 256
s_mov_b32 s43, 0x20000
v_mov_b32 v18, 0
buffer_load_dword v21, v18, s[40:43], 0 offen sc1
s_waitcnt vmcnt(0)
s_barrier
s_mov_b32 s36, s28
s_mov_b32 s37, s29
s_mov_b32 s38, 786432
s_mov_b32 s39, 0x20000
s_cmp_lg_u32 s76, 0
s_cbranch_scc1 L_pd
s_mov_b64 exec, 1
v_mov_b32 v15, 0
v_mov_b32 v16, 1
buffer_store_dword v16, v15, s[4:7], s9 offen sc1
s_mov_b64 exec, -1
s_mov_b32 s81, 8000
L_cpoll:
v_readfirstlane_b32 s80, v21
s_nop 3
s_cmp_eq_u32 s80, 256
s_cbranch_scc1 L_cpok
s_sleep 2
buffer_load_dword v21, v18, s[40:43], 0 offen sc1
s_waitcnt vmcnt(0)
s_sub_u32 s81, s81, 1
s_cmp_lg_u32 s81, 0
s_cbranch_scc1 L_cpoll
L_cpok:
v_and_b32 v17, 15, v0
v_lshlrev_b32 v17, 2, v17
s_and_b32 s80, s9, -128
s_mov_b32 s81, 8000
L_poll:
buffer_load_dword v20, v17, s[4:7], s80 offen sc1
s_waitcnt vmcnt(0)
v_cmp_eq_u32 vcc, 1, v20
s_nop 1
s_cmp_eq_u64 vcc, -1
s_cbranch_scc1 L_pd
s_sub_u32 s81, s81, 1
s_cmp_lg_u32 s81, 0
s_cbranch_scc1 L_poll
L_pd:
s_barrier
s_cmp_eq_u32 s76, 3
s_cbranch_scc1 L_rd
s_lshr_b32 s79, s9, 7
s_mul_i32 s80, s79, 786432
s_add_u32 s44, s32, s80
s_addc_u32 s45, s33, 0
s_mov_b32 s46, 786432
s_mov_b32 s47, 0x20000
s_mov_b32 s48, 0
buffer_load_dwordx4 v[48:51], v2, s[44:47], s48 offen sc1
s_mov_b32 s48, 49152
buffer_load_dwordx4 v[52:55], v2, s[44:47], s48 offen sc1
s_mov_b32 s48, 98304
buffer_load_dwordx4 v[56:59], v2, s[44:47], s48 offen sc1
s_mov_b32 s48, 147456
buffer_load_dwordx4 v[60:63], v2, s[44:47], s48 offen sc1
s_mov_b32 s48, 196608
buffer_load_dwordx4 v[64:67], v2, s[44:47], s48 offen sc1
s_mov_b32 s48, 245760
buffer_load_dwordx4 v[68:71], v2, s[44:47], s48 offen sc1
s_mov_b32 s48, 294912
buffer_load_dwordx4 v[72:75], v2, s[44:47], s48 offen sc1
s_mov_b32 s48, 344064
buffer_load_dwordx4 v[76:79], v2, s[44:47], s48 offen sc1
s_mov_b32 s48, 393216
buffer_load_dwordx4 v[80:83], v2, s[44:47], s48 offen sc1
s_mov_b32 s48, 442368
buffer_load_dwordx4 v[84:87], v2, s[44:47], s48 offen sc1
s_mov_b32 s48, 491520
buffer_load_dwordx4 v[88:91], v2, s[44:47], s48 offen sc1
s_mov_b32 s48, 540672
buffer_load_dwordx4 v[92:95], v2, s[44:47], s48 offen sc1
s_mov_b32 s48, 589824
buffer_load_dwordx4 v[96:99], v2, s[44:47], s48 offen sc1
s_mov_b32 s48, 638976
buffer_load_dwordx4 v[100:103], v2, s[44:47], s48 offen sc1
s_mov_b32 s48, 688128
buffer_load_dwordx4 v[104:107], v2, s[44:47], s48 offen sc1
s_mov_b32 s48, 737280
buffer_load_dwordx4 v[108:111], v2, s[44:47], s48 offen sc1
s_and_b32 s49, s79, 7
s_mul_i32 s49, s49, 98304
s_lshr_b32 s50, s79, 3
s_lshl_b32 s50, s50, 10
s_add_u32 s49, s49, s50
v_mov_b32 v20, 0
v_mov_b32 v21, 0
v_mov_b32 v22, 0
v_mov_b32 v23, 0
v_mov_b32 v24, 0
v_mov_b32 v25, 0
v_mov_b32 v26, 0
v_mov_b32 v27, 0
s_waitcnt vmcnt(15)
v_lshlrev_b32 v28, 16, v48
v_and_b32 v29, 0xffff0000, v48
v_add_f32 v20, v20, v28
v_add_f32 v21, v21, v29
v_lshlrev_b32 v28, 16, v49
v_and_b32 v29, 0xffff0000, v49
v_add_f32 v22, v22, v28
v_add_f32 v23, v23, v29
v_lshlrev_b32 v28, 16, v50
v_and_b32 v29, 0xffff0000, v50
v_add_f32 v24, v24, v28
v_add_f32 v25, v25, v29
v_lshlrev_b32 v28, 16, v51
v_and_b32 v29, 0xffff0000, v51
v_add_f32 v26, v26, v28
v_add_f32 v27, v27, v29
s_waitcnt vmcnt(14)
v_lshlrev_b32 v28, 16, v52
v_and_b32 v29, 0xffff0000, v52
v_add_f32 v20, v20, v28
v_add_f32 v21, v21, v29
v_lshlrev_b32 v28, 16, v53
v_and_b32 v29, 0xffff0000, v53
v_add_f32 v22, v22, v28
v_add_f32 v23, v23, v29
v_lshlrev_b32 v28, 16, v54
v_and_b32 v29, 0xffff0000, v54
v_add_f32 v24, v24, v28
v_add_f32 v25, v25, v29
v_lshlrev_b32 v28, 16, v55
v_and_b32 v29, 0xffff0000, v55
v_add_f32 v26, v26, v28
v_add_f32 v27, v27, v29
s_waitcnt vmcnt(13)
v_lshlrev_b32 v28, 16, v56
v_and_b32 v29, 0xffff0000, v56
v_add_f32 v20, v20, v28
v_add_f32 v21, v21, v29
v_lshlrev_b32 v28, 16, v57
v_and_b32 v29, 0xffff0000, v57
v_add_f32 v22, v22, v28
v_add_f32 v23, v23, v29
v_lshlrev_b32 v28, 16, v58
v_and_b32 v29, 0xffff0000, v58
v_add_f32 v24, v24, v28
v_add_f32 v25, v25, v29
v_lshlrev_b32 v28, 16, v59
v_and_b32 v29, 0xffff0000, v59
v_add_f32 v26, v26, v28
v_add_f32 v27, v27, v29
s_waitcnt vmcnt(12)
v_lshlrev_b32 v28, 16, v60
v_and_b32 v29, 0xffff0000, v60
v_add_f32 v20, v20, v28
v_add_f32 v21, v21, v29
v_lshlrev_b32 v28, 16, v61
v_and_b32 v29, 0xffff0000, v61
v_add_f32 v22, v22, v28
v_add_f32 v23, v23, v29
v_lshlrev_b32 v28, 16, v62
v_and_b32 v29, 0xffff0000, v62
v_add_f32 v24, v24, v28
v_add_f32 v25, v25, v29
v_lshlrev_b32 v28, 16, v63
v_and_b32 v29, 0xffff0000, v63
v_add_f32 v26, v26, v28
v_add_f32 v27, v27, v29
s_waitcnt vmcnt(11)
v_lshlrev_b32 v28, 16, v64
v_and_b32 v29, 0xffff0000, v64
v_add_f32 v20, v20, v28
v_add_f32 v21, v21, v29
v_lshlrev_b32 v28, 16, v65
v_and_b32 v29, 0xffff0000, v65
v_add_f32 v22, v22, v28
v_add_f32 v23, v23, v29
v_lshlrev_b32 v28, 16, v66
v_and_b32 v29, 0xffff0000, v66
v_add_f32 v24, v24, v28
v_add_f32 v25, v25, v29
v_lshlrev_b32 v28, 16, v67
v_and_b32 v29, 0xffff0000, v67
v_add_f32 v26, v26, v28
v_add_f32 v27, v27, v29
s_waitcnt vmcnt(10)
v_lshlrev_b32 v28, 16, v68
v_and_b32 v29, 0xffff0000, v68
v_add_f32 v20, v20, v28
v_add_f32 v21, v21, v29
v_lshlrev_b32 v28, 16, v69
v_and_b32 v29, 0xffff0000, v69
v_add_f32 v22, v22, v28
v_add_f32 v23, v23, v29
v_lshlrev_b32 v28, 16, v70
v_and_b32 v29, 0xffff0000, v70
v_add_f32 v24, v24, v28
v_add_f32 v25, v25, v29
v_lshlrev_b32 v28, 16, v71
v_and_b32 v29, 0xffff0000, v71
v_add_f32 v26, v26, v28
v_add_f32 v27, v27, v29
s_waitcnt vmcnt(9)
v_lshlrev_b32 v28, 16, v72
v_and_b32 v29, 0xffff0000, v72
v_add_f32 v20, v20, v28
v_add_f32 v21, v21, v29
v_lshlrev_b32 v28, 16, v73
v_and_b32 v29, 0xffff0000, v73
v_add_f32 v22, v22, v28
v_add_f32 v23, v23, v29
v_lshlrev_b32 v28, 16, v74
v_and_b32 v29, 0xffff0000, v74
v_add_f32 v24, v24, v28
v_add_f32 v25, v25, v29
v_lshlrev_b32 v28, 16, v75
v_and_b32 v29, 0xffff0000, v75
v_add_f32 v26, v26, v28
v_add_f32 v27, v27, v29
s_waitcnt vmcnt(8)
v_lshlrev_b32 v28, 16, v76
v_and_b32 v29, 0xffff0000, v76
v_add_f32 v20, v20, v28
v_add_f32 v21, v21, v29
v_lshlrev_b32 v28, 16, v77
v_and_b32 v29, 0xffff0000, v77
v_add_f32 v22, v22, v28
v_add_f32 v23, v23, v29
v_lshlrev_b32 v28, 16, v78
v_and_b32 v29, 0xffff0000, v78
v_add_f32 v24, v24, v28
v_add_f32 v25, v25, v29
v_lshlrev_b32 v28, 16, v79
v_and_b32 v29, 0xffff0000, v79
v_add_f32 v26, v26, v28
v_add_f32 v27, v27, v29
s_waitcnt vmcnt(7)
v_lshlrev_b32 v28, 16, v80
v_and_b32 v29, 0xffff0000, v80
v_add_f32 v20, v20, v28
v_add_f32 v21, v21, v29
v_lshlrev_b32 v28, 16, v81
v_and_b32 v29, 0xffff0000, v81
v_add_f32 v22, v22, v28
v_add_f32 v23, v23, v29
v_lshlrev_b32 v28, 16, v82
v_and_b32 v29, 0xffff0000, v82
v_add_f32 v24, v24, v28
v_add_f32 v25, v25, v29
v_lshlrev_b32 v28, 16, v83
v_and_b32 v29, 0xffff0000, v83
v_add_f32 v26, v26, v28
v_add_f32 v27, v27, v29
s_waitcnt vmcnt(6)
v_lshlrev_b32 v28, 16, v84
v_and_b32 v29, 0xffff0000, v84
v_add_f32 v20, v20, v28
v_add_f32 v21, v21, v29
v_lshlrev_b32 v28, 16, v85
v_and_b32 v29, 0xffff0000, v85
v_add_f32 v22, v22, v28
v_add_f32 v23, v23, v29
v_lshlrev_b32 v28, 16, v86
v_and_b32 v29, 0xffff0000, v86
v_add_f32 v24, v24, v28
v_add_f32 v25, v25, v29
v_lshlrev_b32 v28, 16, v87
v_and_b32 v29, 0xffff0000, v87
v_add_f32 v26, v26, v28
v_add_f32 v27, v27, v29
s_waitcnt vmcnt(5)
v_lshlrev_b32 v28, 16, v88
v_and_b32 v29, 0xffff0000, v88
v_add_f32 v20, v20, v28
v_add_f32 v21, v21, v29
v_lshlrev_b32 v28, 16, v89
v_and_b32 v29, 0xffff0000, v89
v_add_f32 v22, v22, v28
v_add_f32 v23, v23, v29
v_lshlrev_b32 v28, 16, v90
v_and_b32 v29, 0xffff0000, v90
v_add_f32 v24, v24, v28
v_add_f32 v25, v25, v29
v_lshlrev_b32 v28, 16, v91
v_and_b32 v29, 0xffff0000, v91
v_add_f32 v26, v26, v28
v_add_f32 v27, v27, v29
s_waitcnt vmcnt(4)
v_lshlrev_b32 v28, 16, v92
v_and_b32 v29, 0xffff0000, v92
v_add_f32 v20, v20, v28
v_add_f32 v21, v21, v29
v_lshlrev_b32 v28, 16, v93
v_and_b32 v29, 0xffff0000, v93
v_add_f32 v22, v22, v28
v_add_f32 v23, v23, v29
v_lshlrev_b32 v28, 16, v94
v_and_b32 v29, 0xffff0000, v94
v_add_f32 v24, v24, v28
v_add_f32 v25, v25, v29
v_lshlrev_b32 v28, 16, v95
v_and_b32 v29, 0xffff0000, v95
v_add_f32 v26, v26, v28
v_add_f32 v27, v27, v29
s_waitcnt vmcnt(3)
v_lshlrev_b32 v28, 16, v96
v_and_b32 v29, 0xffff0000, v96
v_add_f32 v20, v20, v28
v_add_f32 v21, v21, v29
v_lshlrev_b32 v28, 16, v97
v_and_b32 v29, 0xffff0000, v97
v_add_f32 v22, v22, v28
v_add_f32 v23, v23, v29
v_lshlrev_b32 v28, 16, v98
v_and_b32 v29, 0xffff0000, v98
v_add_f32 v24, v24, v28
v_add_f32 v25, v25, v29
v_lshlrev_b32 v28, 16, v99
v_and_b32 v29, 0xffff0000, v99
v_add_f32 v26, v26, v28
v_add_f32 v27, v27, v29
s_waitcnt vmcnt(2)
v_lshlrev_b32 v28, 16, v100
v_and_b32 v29, 0xffff0000, v100
v_add_f32 v20, v20, v28
v_add_f32 v21, v21, v29
v_lshlrev_b32 v28, 16, v101
v_and_b32 v29, 0xffff0000, v101
v_add_f32 v22, v22, v28
v_add_f32 v23, v23, v29
v_lshlrev_b32 v28, 16, v102
v_and_b32 v29, 0xffff0000, v102
v_add_f32 v24, v24, v28
v_add_f32 v25, v25, v29
v_lshlrev_b32 v28, 16, v103
v_and_b32 v29, 0xffff0000, v103
v_add_f32 v26, v26, v28
v_add_f32 v27, v27, v29
s_waitcnt vmcnt(1)
v_lshlrev_b32 v28, 16, v104
v_and_b32 v29, 0xffff0000, v104
v_add_f32 v20, v20, v28
v_add_f32 v21, v21, v29
v_lshlrev_b32 v28, 16, v105
v_and_b32 v29, 0xffff0000, v105
v_add_f32 v22, v22, v28
v_add_f32 v23, v23, v29
v_lshlrev_b32 v28, 16, v106
v_and_b32 v29, 0xffff0000, v106
v_add_f32 v24, v24, v28
v_add_f32 v25, v25, v29
v_lshlrev_b32 v28, 16, v107
v_and_b32 v29, 0xffff0000, v107
v_add_f32 v26, v26, v28
v_add_f32 v27, v27, v29
s_waitcnt vmcnt(0)
v_lshlrev_b32 v28, 16, v108
v_and_b32 v29, 0xffff0000, v108
v_add_f32 v20, v20, v28
v_add_f32 v21, v21, v29
v_lshlrev_b32 v28, 16, v109
v_and_b32 v29, 0xffff0000, v109
v_add_f32 v22, v22, v28
v_add_f32 v23, v23, v29
v_lshlrev_b32 v28, 16, v110
v_and_b32 v29, 0xffff0000, v110
v_add_f32 v24, v24, v28
v_add_f32 v25, v25, v29
v_lshlrev_b32 v28, 16, v111
v_and_b32 v29, 0xffff0000, v111
v_add_f32 v26, v26, v28
v_add_f32 v27, v27, v29
v_cvt_pk_bf16_f32 v30, v20, v21
v_cvt_pk_bf16_f32 v31, v22, v23
v_cvt_pk_bf16_f32 v32, v24, v25
v_cvt_pk_bf16_f32 v33, v26, v27
buffer_store_dwordx2 v[30:31], v13, s[36:39], s49 offen
buffer_store_dwordx2 v[32:33], v14, s[36:39], s49 offen
L_rd:
s_waitcnt vmcnt(0)
L_end:
s_endpgm
L_rescale0:
v_mov_b32 v44, v36
v_mov_b32 v45, v37
v_mov_b32 v46, v38
s_nop 0
v_permlane32_swap_b32 v36, v44
v_permlane32_swap_b32 v37, v45
v_permlane32_swap_b32 v38, v46
s_nop 0
v_max_f32 v36, v36, v44
v_max_f32 v37, v37, v45
v_max_f32 v38, v38, v46
v_mov_b32 v44, v36
v_mov_b32 v45, v37
v_mov_b32 v46, v38
s_nop 0
v_permlane16_swap_b32 v36, v44
v_permlane16_swap_b32 v37, v45
v_permlane16_swap_b32 v38, v46
s_nop 0
v_max_f32 v36, v36, v44
v_max_f32 v37, v37, v45
v_max_f32 v38, v38, v46
v_max_f32 v36, s88, v36
v_max_f32 v37, s88, v37
v_max_f32 v38, s88, v38
v_add_f32 v30, v30, v36
v_max_f32 v40, 0, v36
v_sub_f32 v40, 0, v40
v_add_f32 v32, v32, v37
v_max_f32 v41, 0, v37
v_sub_f32 v41, 0, v41
v_add_f32 v34, v34, v38
v_max_f32 v42, 0, v38
v_sub_f32 v42, 0, v42
v_exp_f32 v40, v40
v_exp_f32 v41, v41
v_exp_f32 v42, v42
v_sub_f32 v48, v48, v36
v_sub_f32 v49, v49, v36
v_sub_f32 v50, v50, v36
v_sub_f32 v51, v51, v36
v_sub_f32 v52, v52, v37
v_sub_f32 v53, v53, v37
v_sub_f32 v54, v54, v37
v_sub_f32 v55, v55, v37
v_sub_f32 v56, v56, v38
v_sub_f32 v57, v57, v38
v_sub_f32 v58, v58, v38
v_sub_f32 v59, v59, v38
v_sub_f32 v60, v60, v36
v_sub_f32 v61, v61, v36
v_sub_f32 v62, v62, v36
v_sub_f32 v63, v63, v36
v_sub_f32 v64, v64, v37
v_sub_f32 v65, v65, v37
v_sub_f32 v66, v66, v37
v_sub_f32 v67, v67, v37
v_sub_f32 v68, v68, v38
v_sub_f32 v69, v69, v38
v_sub_f32 v70, v70, v38
v_sub_f32 v71, v71, v38
v_mul_f32 v31, v31, v40
v_mul_f32 v33, v33, v41
v_mul_f32 v35, v35, v42
v_mul_f32 v120, v120, v40
v_mul_f32 v121, v121, v40
v_mul_f32 v122, v122, v40
v_mul_f32 v123, v123, v40
v_mul_f32 v124, v124, v41
v_mul_f32 v125, v125, v41
v_mul_f32 v126, v126, v41
v_mul_f32 v127, v127, v41
v_mul_f32 v128, v128, v42
v_mul_f32 v129, v129, v42
v_mul_f32 v130, v130, v42
v_mul_f32 v131, v131, v42
v_mul_f32 v132, v132, v40
v_mul_f32 v133, v133, v40
v_mul_f32 v134, v134, v40
v_mul_f32 v135, v135, v40
v_mul_f32 v136, v136, v41
v_mul_f32 v137, v137, v41
v_mul_f32 v138, v138, v41
v_mul_f32 v139, v139, v41
v_mul_f32 v140, v140, v42
v_mul_f32 v141, v141, v42
v_mul_f32 v142, v142, v42
v_mul_f32 v143, v143, v42
v_mul_f32 v144, v144, v40
v_mul_f32 v145, v145, v40
v_mul_f32 v146, v146, v40
v_mul_f32 v147, v147, v40
v_mul_f32 v148, v148, v41
v_mul_f32 v149, v149, v41
v_mul_f32 v150, v150, v41
v_mul_f32 v151, v151, v41
v_mul_f32 v152, v152, v42
v_mul_f32 v153, v153, v42
v_mul_f32 v154, v154, v42
v_mul_f32 v155, v155, v42
v_mul_f32 v156, v156, v40
v_mul_f32 v157, v157, v40
v_mul_f32 v158, v158, v40
v_mul_f32 v159, v159, v40
v_mul_f32 v160, v160, v41
v_mul_f32 v161, v161, v41
v_mul_f32 v162, v162, v41
v_mul_f32 v163, v163, v41
v_mul_f32 v164, v164, v42
v_mul_f32 v165, v165, v42
v_mul_f32 v166, v166, v42
v_mul_f32 v167, v167, v42
v_mul_f32 v168, v168, v40
v_mul_f32 v169, v169, v40
v_mul_f32 v170, v170, v40
v_mul_f32 v171, v171, v40
v_mul_f32 v172, v172, v41
v_mul_f32 v173, v173, v41
v_mul_f32 v174, v174, v41
v_mul_f32 v175, v175, v41
v_mul_f32 v176, v176, v42
v_mul_f32 v177, v177, v42
v_mul_f32 v178, v178, v42
v_mul_f32 v179, v179, v42
v_mul_f32 v180, v180, v40
v_mul_f32 v181, v181, v40
v_mul_f32 v182, v182, v40
v_mul_f32 v183, v183, v40
v_mul_f32 v184, v184, v41
v_mul_f32 v185, v185, v41
v_mul_f32 v186, v186, v41
v_mul_f32 v187, v187, v41
v_mul_f32 v188, v188, v42
v_mul_f32 v189, v189, v42
v_mul_f32 v190, v190, v42
v_mul_f32 v191, v191, v42
v_mul_f32 v192, v192, v40
v_mul_f32 v193, v193, v40
v_mul_f32 v194, v194, v40
v_mul_f32 v195, v195, v40
v_mul_f32 v196, v196, v41
v_mul_f32 v197, v197, v41
v_mul_f32 v198, v198, v41
v_mul_f32 v199, v199, v41
v_mul_f32 v200, v200, v42
v_mul_f32 v201, v201, v42
v_mul_f32 v202, v202, v42
v_mul_f32 v203, v203, v42
v_mul_f32 v204, v204, v40
v_mul_f32 v205, v205, v40
v_mul_f32 v206, v206, v40
v_mul_f32 v207, v207, v40
v_mul_f32 v208, v208, v41
v_mul_f32 v209, v209, v41
v_mul_f32 v210, v210, v41
v_mul_f32 v211, v211, v41
v_mul_f32 v212, v212, v42
v_mul_f32 v213, v213, v42
v_mul_f32 v214, v214, v42
v_mul_f32 v215, v215, v42
s_mov_b32 s87, 0x41000000
s_mov_b32 s88, 0
s_setpc_b64 s[90:91]
L_rescale1:
v_mov_b32 v44, v36
v_mov_b32 v45, v37
v_mov_b32 v46, v38
s_nop 0
v_permlane32_swap_b32 v36, v44
v_permlane32_swap_b32 v37, v45
v_permlane32_swap_b32 v38, v46
s_nop 0
v_max_f32 v36, v36, v44
v_max_f32 v37, v37, v45
v_max_f32 v38, v38, v46
v_mov_b32 v44, v36
v_mov_b32 v45, v37
v_mov_b32 v46, v38
s_nop 0
v_permlane16_swap_b32 v36, v44
v_permlane16_swap_b32 v37, v45
v_permlane16_swap_b32 v38, v46
s_nop 0
v_max_f32 v36, v36, v44
v_max_f32 v37, v37, v45
v_max_f32 v38, v38, v46
v_max_f32 v36, s88, v36
v_max_f32 v37, s88, v37
v_max_f32 v38, s88, v38
v_add_f32 v30, v30, v36
v_max_f32 v40, 0, v36
v_sub_f32 v40, 0, v40
v_add_f32 v32, v32, v37
v_max_f32 v41, 0, v37
v_sub_f32 v41, 0, v41
v_add_f32 v34, v34, v38
v_max_f32 v42, 0, v38
v_sub_f32 v42, 0, v42
v_exp_f32 v40, v40
v_exp_f32 v41, v41
v_exp_f32 v42, v42
v_sub_f32 v72, v72, v36
v_sub_f32 v73, v73, v36
v_sub_f32 v74, v74, v36
v_sub_f32 v75, v75, v36
v_sub_f32 v76, v76, v37
v_sub_f32 v77, v77, v37
v_sub_f32 v78, v78, v37
v_sub_f32 v79, v79, v37
v_sub_f32 v80, v80, v38
v_sub_f32 v81, v81, v38
v_sub_f32 v82, v82, v38
v_sub_f32 v83, v83, v38
v_sub_f32 v84, v84, v36
v_sub_f32 v85, v85, v36
v_sub_f32 v86, v86, v36
v_sub_f32 v87, v87, v36
v_sub_f32 v88, v88, v37
v_sub_f32 v89, v89, v37
v_sub_f32 v90, v90, v37
v_sub_f32 v91, v91, v37
v_sub_f32 v92, v92, v38
v_sub_f32 v93, v93, v38
v_sub_f32 v94, v94, v38
v_sub_f32 v95, v95, v38
v_mul_f32 v31, v31, v40
v_mul_f32 v33, v33, v41
v_mul_f32 v35, v35, v42
v_mul_f32 v120, v120, v40
v_mul_f32 v121, v121, v40
v_mul_f32 v122, v122, v40
v_mul_f32 v123, v123, v40
v_mul_f32 v124, v124, v41
v_mul_f32 v125, v125, v41
v_mul_f32 v126, v126, v41
v_mul_f32 v127, v127, v41
v_mul_f32 v128, v128, v42
v_mul_f32 v129, v129, v42
v_mul_f32 v130, v130, v42
v_mul_f32 v131, v131, v42
v_mul_f32 v132, v132, v40
v_mul_f32 v133, v133, v40
v_mul_f32 v134, v134, v40
v_mul_f32 v135, v135, v40
v_mul_f32 v136, v136, v41
v_mul_f32 v137, v137, v41
v_mul_f32 v138, v138, v41
v_mul_f32 v139, v139, v41
v_mul_f32 v140, v140, v42
v_mul_f32 v141, v141, v42
v_mul_f32 v142, v142, v42
v_mul_f32 v143, v143, v42
v_mul_f32 v144, v144, v40
v_mul_f32 v145, v145, v40
v_mul_f32 v146, v146, v40
v_mul_f32 v147, v147, v40
v_mul_f32 v148, v148, v41
v_mul_f32 v149, v149, v41
v_mul_f32 v150, v150, v41
v_mul_f32 v151, v151, v41
v_mul_f32 v152, v152, v42
v_mul_f32 v153, v153, v42
v_mul_f32 v154, v154, v42
v_mul_f32 v155, v155, v42
v_mul_f32 v156, v156, v40
v_mul_f32 v157, v157, v40
v_mul_f32 v158, v158, v40
v_mul_f32 v159, v159, v40
v_mul_f32 v160, v160, v41
v_mul_f32 v161, v161, v41
v_mul_f32 v162, v162, v41
v_mul_f32 v163, v163, v41
v_mul_f32 v164, v164, v42
v_mul_f32 v165, v165, v42
v_mul_f32 v166, v166, v42
v_mul_f32 v167, v167, v42
v_mul_f32 v168, v168, v40
v_mul_f32 v169, v169, v40
v_mul_f32 v170, v170, v40
v_mul_f32 v171, v171, v40
v_mul_f32 v172, v172, v41
v_mul_f32 v173, v173, v41
v_mul_f32 v174, v174, v41
v_mul_f32 v175, v175, v41
v_mul_f32 v176, v176, v42
v_mul_f32 v177, v177, v42
v_mul_f32 v178, v178, v42
v_mul_f32 v179, v179, v42
v_mul_f32 v180, v180, v40
v_mul_f32 v181, v181, v40
v_mul_f32 v182, v182, v40
v_mul_f32 v183, v183, v40
v_mul_f32 v184, v184, v41
v_mul_f32 v185, v185, v41
v_mul_f32 v186, v186, v41
v_mul_f32 v187, v187, v41
v_mul_f32 v188, v188, v42
v_mul_f32 v189, v189, v42
v_mul_f32 v190, v190, v42
v_mul_f32 v191, v191, v42
v_mul_f32 v192, v192, v40
v_mul_f32 v193, v193, v40
v_mul_f32 v194, v194, v40
v_mul_f32 v195, v195, v40
v_mul_f32 v196, v196, v41
v_mul_f32 v197, v197, v41
v_mul_f32 v198, v198, v41
v_mul_f32 v199, v199, v41
v_mul_f32 v200, v200, v42
v_mul_f32 v201, v201, v42
v_mul_f32 v202, v202, v42
v_mul_f32 v203, v203, v42
v_mul_f32 v204, v204, v40
v_mul_f32 v205, v205, v40
v_mul_f32 v206, v206, v40
v_mul_f32 v207, v207, v40
v_mul_f32 v208, v208, v41
v_mul_f32 v209, v209, v41
v_mul_f32 v210, v210, v41
v_mul_f32 v211, v211, v41
v_mul_f32 v212, v212, v42
v_mul_f32 v213, v213, v42
v_mul_f32 v214, v214, v42
v_mul_f32 v215, v215, v42
s_mov_b32 s87, 0x41000000
s_mov_b32 s88, 0
s_setpc_b64 s[90:91]
L_rescaleJ1:
v_mov_b32 v44, v36
v_mov_b32 v45, v37
v_mov_b32 v46, v38
s_nop 0
v_permlane32_swap_b32 v36, v44
v_permlane32_swap_b32 v37, v45
v_permlane32_swap_b32 v38, v46
s_nop 0
v_max_f32 v36, v36, v44
v_max_f32 v37, v37, v45
v_max_f32 v38, v38, v46
v_mov_b32 v44, v36
v_mov_b32 v45, v37
v_mov_b32 v46, v38
s_nop 0
v_permlane16_swap_b32 v36, v44
v_permlane16_swap_b32 v37, v45
v_permlane16_swap_b32 v38, v46
s_nop 0
v_max_f32 v36, v36, v44
v_max_f32 v37, v37, v45
v_max_f32 v38, v38, v46
v_max_f32 v36, s48, v36
v_max_f32 v37, s48, v37
v_max_f32 v38, s48, v38
v_add_f32 v224, v224, v36
v_max_f32 v40, 0, v36
v_sub_f32 v40, 0, v40
v_add_f32 v226, v226, v37
v_max_f32 v41, 0, v37
v_sub_f32 v41, 0, v41
v_add_f32 v228, v228, v38
v_max_f32 v42, 0, v38
v_sub_f32 v42, 0, v42
v_exp_f32 v40, v40
v_exp_f32 v41, v41
v_exp_f32 v42, v42
v_sub_f32 v72, v72, v36
v_sub_f32 v73, v73, v36
v_sub_f32 v74, v74, v36
v_sub_f32 v75, v75, v36
v_sub_f32 v76, v76, v37
v_sub_f32 v77, v77, v37
v_sub_f32 v78, v78, v37
v_sub_f32 v79, v79, v37
v_sub_f32 v80, v80, v38
v_sub_f32 v81, v81, v38
v_sub_f32 v82, v82, v38
v_sub_f32 v83, v83, v38
v_sub_f32 v84, v84, v36
v_sub_f32 v85, v85, v36
v_sub_f32 v86, v86, v36
v_sub_f32 v87, v87, v36
v_sub_f32 v88, v88, v37
v_sub_f32 v89, v89, v37
v_sub_f32 v90, v90, v37
v_sub_f32 v91, v91, v37
v_sub_f32 v92, v92, v38
v_sub_f32 v93, v93, v38
v_sub_f32 v94, v94, v38
v_sub_f32 v95, v95, v38
v_mul_f32 v225, v225, v40
v_mul_f32 v227, v227, v41
v_mul_f32 v229, v229, v42
v_accvgpr_read_b32 v230, a160
v_accvgpr_read_b32 v231, a161
v_accvgpr_read_b32 v232, a162
v_accvgpr_read_b32 v233, a163
v_accvgpr_read_b32 v234, a164
v_accvgpr_read_b32 v235, a165
v_accvgpr_read_b32 v236, a166
v_accvgpr_read_b32 v237, a167
v_accvgpr_read_b32 v238, a168
v_accvgpr_read_b32 v239, a169
v_accvgpr_read_b32 v240, a170
v_accvgpr_read_b32 v241, a171
v_accvgpr_read_b32 v242, a172
v_accvgpr_read_b32 v243, a173
v_accvgpr_read_b32 v244, a174
v_accvgpr_read_b32 v245, a175
v_accvgpr_read_b32 v246, a176
v_accvgpr_read_b32 v247, a177
v_accvgpr_read_b32 v248, a178
v_accvgpr_read_b32 v249, a179
v_accvgpr_read_b32 v250, a180
v_accvgpr_read_b32 v251, a181
v_accvgpr_read_b32 v252, a182
v_accvgpr_read_b32 v253, a183
v_mul_f32 v230, v230, v40
v_mul_f32 v231, v231, v40
v_mul_f32 v232, v232, v40
v_mul_f32 v233, v233, v40
v_mul_f32 v234, v234, v41
v_mul_f32 v235, v235, v41
v_mul_f32 v236, v236, v41
v_mul_f32 v237, v237, v41
v_mul_f32 v238, v238, v42
v_mul_f32 v239, v239, v42
v_mul_f32 v240, v240, v42
v_mul_f32 v241, v241, v42
v_mul_f32 v242, v242, v40
v_mul_f32 v243, v243, v40
v_mul_f32 v244, v244, v40
v_mul_f32 v245, v245, v40
v_mul_f32 v246, v246, v41
v_mul_f32 v247, v247, v41
v_mul_f32 v248, v248, v41
v_mul_f32 v249, v249, v41
v_mul_f32 v250, v250, v42
v_mul_f32 v251, v251, v42
v_mul_f32 v252, v252, v42
v_mul_f32 v253, v253, v42
v_accvgpr_write_b32 a160, v230
v_accvgpr_write_b32 a161, v231
v_accvgpr_write_b32 a162, v232
v_accvgpr_write_b32 a163, v233
v_accvgpr_write_b32 a164, v234
v_accvgpr_write_b32 a165, v235
v_accvgpr_write_b32 a166, v236
v_accvgpr_write_b32 a167, v237
v_accvgpr_write_b32 a168, v238
v_accvgpr_write_b32 a169, v239
v_accvgpr_write_b32 a170, v240
v_accvgpr_write_b32 a171, v241
v_accvgpr_write_b32 a172, v242
v_accvgpr_write_b32 a173, v243
v_accvgpr_write_b32 a174, v244
v_accvgpr_write_b32 a175, v245
v_accvgpr_write_b32 a176, v246
v_accvgpr_write_b32 a177, v247
v_accvgpr_write_b32 a178, v248
v_accvgpr_write_b32 a179, v249
v_accvgpr_write_b32 a180, v250
v_accvgpr_write_b32 a181, v251
v_accvgpr_write_b32 a182, v252
v_accvgpr_write_b32 a183, v253
v_accvgpr_read_b32 v230, a184
v_accvgpr_read_b32 v231, a185
v_accvgpr_read_b32 v232, a186
v_accvgpr_read_b32 v233, a187
v_accvgpr_read_b32 v234, a188
v_accvgpr_read_b32 v235, a189
v_accvgpr_read_b32 v236, a190
v_accvgpr_read_b32 v237, a191
v_accvgpr_read_b32 v238, a192
v_accvgpr_read_b32 v239, a193
v_accvgpr_read_b32 v240, a194
v_accvgpr_read_b32 v241, a195
v_accvgpr_read_b32 v242, a196
v_accvgpr_read_b32 v243, a197
v_accvgpr_read_b32 v244, a198
v_accvgpr_read_b32 v245, a199
v_accvgpr_read_b32 v246, a200
v_accvgpr_read_b32 v247, a201
v_accvgpr_read_b32 v248, a202
v_accvgpr_read_b32 v249, a203
v_accvgpr_read_b32 v250, a204
v_accvgpr_read_b32 v251, a205
v_accvgpr_read_b32 v252, a206
v_accvgpr_read_b32 v253, a207
v_mul_f32 v230, v230, v40
v_mul_f32 v231, v231, v40
v_mul_f32 v232, v232, v40
v_mul_f32 v233, v233, v40
v_mul_f32 v234, v234, v41
v_mul_f32 v235, v235, v41
v_mul_f32 v236, v236, v41
v_mul_f32 v237, v237, v41
v_mul_f32 v238, v238, v42
v_mul_f32 v239, v239, v42
v_mul_f32 v240, v240, v42
v_mul_f32 v241, v241, v42
v_mul_f32 v242, v242, v40
v_mul_f32 v243, v243, v40
v_mul_f32 v244, v244, v40
v_mul_f32 v245, v245, v40
v_mul_f32 v246, v246, v41
v_mul_f32 v247, v247, v41
v_mul_f32 v248, v248, v41
v_mul_f32 v249, v249, v41
v_mul_f32 v250, v250, v42
v_mul_f32 v251, v251, v42
v_mul_f32 v252, v252, v42
v_mul_f32 v253, v253, v42
v_accvgpr_write_b32 a184, v230
v_accvgpr_write_b32 a185, v231
v_accvgpr_write_b32 a186, v232
v_accvgpr_write_b32 a187, v233
v_accvgpr_write_b32 a188, v234
v_accvgpr_write_b32 a189, v235
v_accvgpr_write_b32 a190, v236
v_accvgpr_write_b32 a191, v237
v_accvgpr_write_b32 a192, v238
v_accvgpr_write_b32 a193, v239
v_accvgpr_write_b32 a194, v240
v_accvgpr_write_b32 a195, v241
v_accvgpr_write_b32 a196, v242
v_accvgpr_write_b32 a197, v243
v_accvgpr_write_b32 a198, v244
v_accvgpr_write_b32 a199, v245
v_accvgpr_write_b32 a200, v246
v_accvgpr_write_b32 a201, v247
v_accvgpr_write_b32 a202, v248
v_accvgpr_write_b32 a203, v249
v_accvgpr_write_b32 a204, v250
v_accvgpr_write_b32 a205, v251
v_accvgpr_write_b32 a206, v252
v_accvgpr_write_b32 a207, v253
v_accvgpr_read_b32 v230, a208
v_accvgpr_read_b32 v231, a209
v_accvgpr_read_b32 v232, a210
v_accvgpr_read_b32 v233, a211
v_accvgpr_read_b32 v234, a212
v_accvgpr_read_b32 v235, a213
v_accvgpr_read_b32 v236, a214
v_accvgpr_read_b32 v237, a215
v_accvgpr_read_b32 v238, a216
v_accvgpr_read_b32 v239, a217
v_accvgpr_read_b32 v240, a218
v_accvgpr_read_b32 v241, a219
v_accvgpr_read_b32 v242, a220
v_accvgpr_read_b32 v243, a221
v_accvgpr_read_b32 v244, a222
v_accvgpr_read_b32 v245, a223
v_accvgpr_read_b32 v246, a224
v_accvgpr_read_b32 v247, a225
v_accvgpr_read_b32 v248, a226
v_accvgpr_read_b32 v249, a227
v_accvgpr_read_b32 v250, a228
v_accvgpr_read_b32 v251, a229
v_accvgpr_read_b32 v252, a230
v_accvgpr_read_b32 v253, a231
v_mul_f32 v230, v230, v40
v_mul_f32 v231, v231, v40
v_mul_f32 v232, v232, v40
v_mul_f32 v233, v233, v40
v_mul_f32 v234, v234, v41
v_mul_f32 v235, v235, v41
v_mul_f32 v236, v236, v41
v_mul_f32 v237, v237, v41
v_mul_f32 v238, v238, v42
v_mul_f32 v239, v239, v42
v_mul_f32 v240, v240, v42
v_mul_f32 v241, v241, v42
v_mul_f32 v242, v242, v40
v_mul_f32 v243, v243, v40
v_mul_f32 v244, v244, v40
v_mul_f32 v245, v245, v40
v_mul_f32 v246, v246, v41
v_mul_f32 v247, v247, v41
v_mul_f32 v248, v248, v41
v_mul_f32 v249, v249, v41
v_mul_f32 v250, v250, v42
v_mul_f32 v251, v251, v42
v_mul_f32 v252, v252, v42
v_mul_f32 v253, v253, v42
v_accvgpr_write_b32 a208, v230
v_accvgpr_write_b32 a209, v231
v_accvgpr_write_b32 a210, v232
v_accvgpr_write_b32 a211, v233
v_accvgpr_write_b32 a212, v234
v_accvgpr_write_b32 a213, v235
v_accvgpr_write_b32 a214, v236
v_accvgpr_write_b32 a215, v237
v_accvgpr_write_b32 a216, v238
v_accvgpr_write_b32 a217, v239
v_accvgpr_write_b32 a218, v240
v_accvgpr_write_b32 a219, v241
v_accvgpr_write_b32 a220, v242
v_accvgpr_write_b32 a221, v243
v_accvgpr_write_b32 a222, v244
v_accvgpr_write_b32 a223, v245
v_accvgpr_write_b32 a224, v246
v_accvgpr_write_b32 a225, v247
v_accvgpr_write_b32 a226, v248
v_accvgpr_write_b32 a227, v249
v_accvgpr_write_b32 a228, v250
v_accvgpr_write_b32 a229, v251
v_accvgpr_write_b32 a230, v252
v_accvgpr_write_b32 a231, v253
v_accvgpr_read_b32 v230, a232
v_accvgpr_read_b32 v231, a233
v_accvgpr_read_b32 v232, a234
v_accvgpr_read_b32 v233, a235
v_accvgpr_read_b32 v234, a236
v_accvgpr_read_b32 v235, a237
v_accvgpr_read_b32 v236, a238
v_accvgpr_read_b32 v237, a239
v_accvgpr_read_b32 v238, a240
v_accvgpr_read_b32 v239, a241
v_accvgpr_read_b32 v240, a242
v_accvgpr_read_b32 v241, a243
v_accvgpr_read_b32 v242, a244
v_accvgpr_read_b32 v243, a245
v_accvgpr_read_b32 v244, a246
v_accvgpr_read_b32 v245, a247
v_accvgpr_read_b32 v246, a248
v_accvgpr_read_b32 v247, a249
v_accvgpr_read_b32 v248, a250
v_accvgpr_read_b32 v249, a251
v_accvgpr_read_b32 v250, a252
v_accvgpr_read_b32 v251, a253
v_accvgpr_read_b32 v252, a254
v_accvgpr_read_b32 v253, a255
v_mul_f32 v230, v230, v40
v_mul_f32 v231, v231, v40
v_mul_f32 v232, v232, v40
v_mul_f32 v233, v233, v40
v_mul_f32 v234, v234, v41
v_mul_f32 v235, v235, v41
v_mul_f32 v236, v236, v41
v_mul_f32 v237, v237, v41
v_mul_f32 v238, v238, v42
v_mul_f32 v239, v239, v42
v_mul_f32 v240, v240, v42
v_mul_f32 v241, v241, v42
v_mul_f32 v242, v242, v40
v_mul_f32 v243, v243, v40
v_mul_f32 v244, v244, v40
v_mul_f32 v245, v245, v40
v_mul_f32 v246, v246, v41
v_mul_f32 v247, v247, v41
v_mul_f32 v248, v248, v41
v_mul_f32 v249, v249, v41
v_mul_f32 v250, v250, v42
v_mul_f32 v251, v251, v42
v_mul_f32 v252, v252, v42
v_mul_f32 v253, v253, v42
v_accvgpr_write_b32 a232, v230
v_accvgpr_write_b32 a233, v231
v_accvgpr_write_b32 a234, v232
v_accvgpr_write_b32 a235, v233
v_accvgpr_write_b32 a236, v234
v_accvgpr_write_b32 a237, v235
v_accvgpr_write_b32 a238, v236
v_accvgpr_write_b32 a239, v237
v_accvgpr_write_b32 a240, v238
v_accvgpr_write_b32 a241, v239
v_accvgpr_write_b32 a242, v240
v_accvgpr_write_b32 a243, v241
v_accvgpr_write_b32 a244, v242
v_accvgpr_write_b32 a245, v243
v_accvgpr_write_b32 a246, v244
v_accvgpr_write_b32 a247, v245
v_accvgpr_write_b32 a248, v246
v_accvgpr_write_b32 a249, v247
v_accvgpr_write_b32 a250, v248
v_accvgpr_write_b32 a251, v249
v_accvgpr_write_b32 a252, v250
v_accvgpr_write_b32 a253, v251
v_accvgpr_write_b32 a254, v252
v_accvgpr_write_b32 a255, v253
s_mov_b32 s11, 0x41000000
s_mov_b32 s48, 0
s_setpc_b64 s[90:91]
.section .rodata,"a"
.p2align 6
.amdhsa_kernel concat_heads__gqa_block_cached__mha_block_cached__near_ridge_kernel
  .amdhsa_next_free_vgpr 512
  .amdhsa_next_free_sgpr 102
  .amdhsa_accum_offset 256
  .amdhsa_group_segment_fixed_size 0
  .amdhsa_kernarg_size 104
  .amdhsa_user_sgpr_count 2
  .amdhsa_user_sgpr_kernarg_segment_ptr 1
  .amdhsa_system_sgpr_workgroup_id_x 1
  .amdhsa_float_denorm_mode_32 3
  .amdhsa_float_denorm_mode_16_64 3
.end_amdhsa_kernel
```
